```python
import torch

def _softmax(x, axis=-1):
    return torch.softmax(x, dim=axis)
def _gelu(x):
    return torch.nn.functional.gelu(x, approximate="tanh")
def _silu(x):
    return torch.nn.functional.silu(x)
def _sigmoid(x):
    return torch.sigmoid(x)
def _layernorm(x, axis=-1, eps=1e-5):
    m = x.mean(dim=axis, keepdim=True)
    v = x.var(dim=axis, keepdim=True, unbiased=False)
    return (x - m) / torch.sqrt(v + eps)
def _scatter_add(tgt, idx, src, axis=0):
    return tgt.clone().index_add_(axis, idx, src)
def _segment_sum(src, seg, n):
    out = torch.zeros((n,) + src.shape[1:], dtype=src.dtype)
    return out.index_add_(0, seg, src)
def _pad(x, pw):
    flat = tuple(v for pair in reversed(pw) for v in pair)
    return torch.nn.functional.pad(x, flat)

kernel_name = 'interleave_layers__softmax_full_mha__mixer_s_mlp__prompt'

def setup_inputs():

    _w = (lambda a: (lambda t: t.to(torch.bfloat16) if t.is_floating_point() else t)(torch.as_tensor(a)))
    def _A_setup():
        B, S, D = 1, 2048, 512
        return {
            "x": _w((lambda *s: torch.randn(*s, dtype=torch.bfloat16) * 0.05)(B, S, D)),
            "wqkv": _w((lambda *s: torch.randn(*s, dtype=torch.bfloat16) * 0.05)(D, 3 * D)),
            "wo": _w((lambda *s: torch.randn(*s, dtype=torch.bfloat16) * 0.05)(D, D)),
        }
    _A_in = _A_setup()

    def _B_setup():
        B, S, D, F = 1, 2048, 512, 1792
        return {
            "x":  _w((lambda *s: torch.randn(*s, dtype=torch.bfloat16) * 0.05)(B, S, D)),
            "w1": _w((lambda *s: torch.randn(*s, dtype=torch.bfloat16) * 0.8)(D, D) * (D ** -0.5)),
            "w2": _w((lambda *s: torch.randn(*s, dtype=torch.bfloat16) * 0.8)(D, D) * (D ** -0.5)),
            "w3": _w((lambda *s: torch.randn(*s, dtype=torch.bfloat16) * 0.8)(D, F) * (D ** -0.5)),
            "w4": _w((lambda *s: torch.randn(*s, dtype=torch.bfloat16) * 0.8)(F, D) * (F ** -0.5)),
        }
    _B_in = _B_setup()

    return {
        "A_x": _A_in["x"],
        "A_wqkv": _A_in["wqkv"],
        "A_wo": _A_in["wo"],
        "B_x": _B_in["x"],
        "B_w1": _B_in["w1"],
        "B_w2": _B_in["w2"],
        "B_w3": _B_in["w3"],
        "B_w4": _B_in["w4"],
    }

def reference(A_x, A_wqkv, A_wo, B_x, B_w1, B_w2, B_w3, B_w4):
    def _A_ref(x, wqkv, wo):
        B, S, D = x.shape
        H = 32; Dh = D // H
        qkv = (lambda x, *d: x.permute(*d))((x @ wqkv).reshape(B, S, 3, H, Dh), 2, 0, 3, 1, 4)
        q, k, v = qkv[0], qkv[1], qkv[2]
        scale = Dh ** -0.5
        scores = torch.einsum("bhqd,bhkd->bhqk", q, k) * scale
        p = _softmax(scores, axis=-1)
        o = torch.einsum("bhqk,bhkd->bhqd", p, v)
        return (lambda x, *d: x.permute(*d))(o, 0, 2, 1, 3).reshape(B, S, D) @ wo

    def _B_ref(x, w1, w2, w3, w4):
        B, S, D = x.shape
        h = _gelu(_layernorm(x, axis=-1) @ w1)
        c = D // 4
        g0 = _pad(h[:, :, 0*c:1*c], ((0, 0), (1, 0), (0, 0)))[:, :S, :]
        g1 = _pad(h[:, :, 1*c:2*c], ((0, 0), (0, 1), (0, 0)))[:, 1:, :]
        g2 = _pad(h[:, :, 2*c:3*c], ((0, 0), (2, 0), (0, 0)))[:, :S, :]
        g3 = _pad(h[:, :, 3*c:   ], ((0, 0), (0, 2), (0, 0)))[:, 2:, :]
        hs = torch.concatenate([g0, g1, g2, g3], axis=-1) @ w2
        x1 = x + hs
        h2 = _gelu(_layernorm(x1, axis=-1) @ w3) @ w4
        return x1 + h2

    x = A_x
    x = x + _A_ref(_layernorm(x, axis=-1), A_wqkv, A_wo)
    x = x + _B_ref(_layernorm(x, axis=-1), B_w1, B_w2, B_w3, B_w4)
    x = x + _A_ref(_layernorm(x, axis=-1), A_wqkv, A_wo)
    x = x + _B_ref(_layernorm(x, axis=-1), B_w1, B_w2, B_w3, B_w4)
    return x
```

```asm
; @launch grid=(256,1,1) block=(512,1,1) lds=163840
.amdgcn_target "amdgcn-amd-amdhsa--gfx950"
.text
.globl interleave_layers__softmax_full_mha__mixer_s_mlp__prompt_kernel
.p2align 8
.type interleave_layers__softmax_full_mha__mixer_s_mlp__prompt_kernel,@function
interleave_layers__softmax_full_mha__mixer_s_mlp__prompt_kernel:
    s_cmp_ge_u32 s2, 256
    s_cbranch_scc1 L_END
    s_load_dwordx2 s[8:9], s[0:1], 0
    s_load_dwordx8 s[56:63], s[0:1], 0
    s_load_dwordx8 s[64:71], s[0:1], 32
    s_load_dwordx4 s[72:75], s[0:1], 64
    s_load_dwordx2 s[76:77], s[0:1], 80
    v_and_b32 v1, 63, v0
    v_lshrrev_b32 v2, 6, v0
    s_and_b32 s44, s2, 7
    s_lshr_b32 s45, s2, 3
    v_readfirstlane_b32 s48, v2
    s_lshr_b32 s46, s45, 3
    s_and_b32 s47, s45, 7
    s_lshl_b32 s51, s44, 3
    s_lshl_b32 s3, s46, 1
    s_add_u32 s51, s51, s3
    v_lshrrev_b32 v20, 3, v1
    s_lshl_b32 s3, s48, 3
    v_add_u32 v20, s3, v20
    v_and_b32 v21, 7, v1
    v_lshlrev_b32 v22, 10, v20
    v_lshlrev_b32 v23, 4, v21
    v_add_u32 v22, v22, v23
    s_lshl_b32 s3, s51, 15
    s_mov_b32 s10, 2097152
    s_mov_b32 s11, 0x00020000
    s_waitcnt lgkmcnt(0)
    buffer_load_dwordx4 v[32:35], v22, s[8:11], s3 offen offset:0
    buffer_load_dwordx4 v[36:39], v22, s[8:11], s3 offen offset:128
    buffer_load_dwordx4 v[40:43], v22, s[8:11], s3 offen offset:256
    buffer_load_dwordx4 v[44:47], v22, s[8:11], s3 offen offset:384
    buffer_load_dwordx4 v[48:51], v22, s[8:11], s3 offen offset:512
    buffer_load_dwordx4 v[52:55], v22, s[8:11], s3 offen offset:640
    buffer_load_dwordx4 v[56:59], v22, s[8:11], s3 offen offset:768
    buffer_load_dwordx4 v[60:63], v22, s[8:11], s3 offen offset:896
    v_mov_b32 v2, 0
    v_mov_b32 v3, 0
    v_mov_b32 v4, 0
    v_mov_b32 v5, 0
    v_mov_b32 v6, 0
    v_mov_b32 v7, 0
    v_mov_b32 v8, 0
    v_mov_b32 v9, 0
    v_mov_b32 v10, 0
    v_mov_b32 v11, 0
    v_mov_b32 v12, 0
    v_mov_b32 v13, 0
    v_mov_b32 v14, 0
    v_mov_b32 v15, 0
    v_mov_b32 v16, 0
    v_mov_b32 v17, 0
    v_mov_b32 v18, 0
    v_mov_b32 v19, 0
    s_mov_b32 s20, s58
    s_mov_b32 s21, s59
    s_mov_b32 s22, 1572864
    s_mov_b32 s23, 0x00020000
    s_mov_b32 s24, s60
    s_mov_b32 s25, s61
    s_mov_b32 s26, 524288
    s_mov_b32 s27, 0x00020000
    s_mov_b32 s28, s64
    s_mov_b32 s29, s65
    s_mov_b32 s30, 524288
    s_mov_b32 s31, 0x00020000
    s_mov_b32 s32, s66
    s_mov_b32 s33, s67
    s_mov_b32 s34, 524288
    s_mov_b32 s35, 0x00020000
    s_mov_b32 s36, s68
    s_mov_b32 s37, s69
    s_mov_b32 s38, 1835008
    s_mov_b32 s39, 0x00020000
    s_mov_b32 s40, s70
    s_mov_b32 s41, s71
    s_mov_b32 s42, 1835008
    s_mov_b32 s43, 0x00020000
    s_mov_b32 s12, s72
    s_mov_b32 s13, s73
    s_mov_b32 s14, 2097152
    s_mov_b32 s15, 0x00020000
    s_mov_b32 s16, s74
    s_mov_b32 s17, s75
    s_mov_b32 s18, 256
    s_mov_b32 s19, 0x00020000
    s_mov_b32 s4, s76
    s_mov_b32 s5, s77
    s_mov_b32 s6, 268435456
    s_mov_b32 s7, 0x00020000
    s_lshl_b32 s54, s47, 7
    s_mul_i32 s55, s47, 448
    s_mov_b32 s49, 0
    s_mov_b32 s87, 0
    s_mov_b32 s50, 1048576
    s_mov_b32 s52, 0
    s_mov_b32 s53, 0
    s_mov_b32 s66, 0x0000ffff
    s_mov_b32 s67, 0x0000ffff
    s_mov_b32 s82, 0x3dd2d3e8
    s_mov_b32 s83, 0x3dd2d3e8
    s_mov_b32 s84, 1.0
    s_mov_b32 s85, 1.0
    s_mov_b32 s96, -1
    s_mov_b32 s97, 0
    s_cmp_lg_u32 s48, 2
    s_cbranch_scc1 Lnotw_1
    s_mul_i32 s3, s2, 6144
    v_min_u32 v26, 47, v1
    v_lshlrev_b32 v26, 7, v26
    buffer_load_dword v27, v26, s[20:23], s3 offen
Lnotw_1:
    s_cmp_lg_u32 s48, 1
    s_cbranch_scc1 Lnotw_2
    s_lshl_b32 s57, s44, 8
    s_lshl_b32 s58, s45, 2
    s_add_u32 s57, s57, s58
    v_mov_b32 v26, 0
    s_mov_b64 s[92:93], exec
    s_mov_b64 exec, 1
    buffer_store_dword v26, v26, s[4:7], s57 offen sc1
    s_lshl_b32 s57, s44, 5
    s_add_u32 s57, s57, s45
    s_lshl_b32 s57, s57, 7
    s_add_u32 s57, s57, 32768
    buffer_store_dword v26, v26, s[4:7], s57 offen sc1
    s_mov_b64 exec, s[92:93]
Lnotw_2:
    s_cmp_ge_u32 s48, 6
    s_cbranch_scc1 L_PRO_LW
    s_cmp_ge_u32 s48, 4
    s_cbranch_scc1 L_PRO_LA
    s_and_b32 s74, s48, 1
    s_lshr_b32 s75, s48, 1
    v_lshlrev_b32 v7, 4, v1
    s_mul_i32 s3, s74, 33280
    v_add_u32 v2, s3, v7
    v_lshrrev_b32 v100, 5, v1
    v_bfe_u32 v101, v1, 2, 2
    v_lshlrev_b32 v102, 2, v100
    v_add_u32 v102, v102, v101
    v_bfe_u32 v103, v1, 4, 1
    v_bfe_u32 v104, v1, 1, 1
    v_lshlrev_b32 v105, 1, v103
    v_add_u32 v105, v105, v104
    s_lshl_b32 s3, s75, 2
    v_add_u32 v105, s3, v105
    v_and_b32 v106, 2, v101
    v_lshlrev_b32 v106, 1, v106
    v_xor_b32 v105, v105, v106
    v_lshlrev_b32 v105, 4, v105
    v_and_b32 v106, 1, v1
    v_lshlrev_b32 v106, 3, v106
    v_lshlrev_b32 v107, 7, v102
    v_add3_u32 v3, v107, v105, v106
    v_add_u32 v3, 66560, v3
    v_add_u32 v4, 0x10000, v3
    s_lshl_b32 s3, s75, 12
    s_add_u32 s3, s3, 66560
    v_add_u32 v5, s3, v7
    v_add_u32 v6, 0x10000, v5
    v_and_b32 v101, 31, v1
    s_lshl_b32 s3, s74, 5
    v_add_u32 v102, s3, v101
    v_lshlrev_b32 v8, 10, v102
    v_lshlrev_b32 v103, 3, v100
    v_add_u32 v8, v8, v103
    s_lshl_b32 s3, s75, 6
    v_add_u32 v8, s3, v8
    v_lshlrev_b32 v9, 3, v101
    v_mov_b32 v103, 268435456
    v_cmp_gt_u32 vcc, 32, v1
    s_nop 1
    v_cndmask_b32 v9, v103, v9, vcc
    v_lshlrev_b32 v10, 4, v100
    v_lshlrev_b32 v11, 2, v101
    v_lshlrev_b32 v12, 2, v102
    v_add_u32 v12, 156672, v12
    s_lshl_b32 s3, s74, 7
    v_lshlrev_b32 v13, 4, v100
    v_add_u32 v13, s3, v13
    v_add_u32 v13, 156672, v13
    v_bfe_u32 v103, v1, 4, 1
    v_lshlrev_b32 v14, 16, v103
    v_lshlrev_b32 v103, 8, v100
    v_and_b32 v104, 15, v1
    v_lshlrev_b32 v104, 4, v104
    v_add3_u32 v14, v14, v103, v104
    s_waitcnt vmcnt(0)
    s_cmp_lg_u32 s48, 1
    s_cbranch_scc1 Lnotw_3
    s_getreg_b32 s56, hwreg(HW_REG_XCC_ID, 0, 4)
    s_and_b32 s56, s56, 7
    s_lshl_b32 s56, s56, 3
    s_lshl_b64 s[58:59], 1, s56
    v_mov_b32 v26, s58
    v_mov_b32 v27, s59
    s_lshl_b32 s57, s44, 5
    s_add_u32 s57, s57, 0
    v_mov_b32 v28, s57
    s_mov_b64 s[92:93], exec
    s_mov_b64 exec, 1
    buffer_atomic_add_x2 v[26:27], v28, s[16:19], 0 offen sc1
    s_mov_b64 exec, s[92:93]
Lnotw_3:
    s_branch L_PRO_COMMON
L_PRO_LA:
    s_sub_u32 s74, s48, 4
    s_mul_i32 s76, s74, 33280
    v_lshlrev_b32 v13, 4, v1
    s_lshl_b32 s3, s74, 15
    v_add_u32 v2, s3, v13
    s_mul_i32 s3, s74, 114688
    v_add_u32 v3, s3, v13
    s_add_u32 s59, s51, s74
    s_lshl_b32 s59, s59, 5
    v_and_b32 v101, 31, v1
    v_add_u32 v101, s59, v101
    v_lshrrev_b32 v102, 5, v1
    v_lshlrev_b32 v102, 9, v102
    v_mov_b32 v106, 268435456
    v_add_u32 v103, -1, v101
    v_lshrrev_b32 v104, 5, v103
    v_lshlrev_b32 v104, 15, v104
    v_and_b32 v105, 31, v103
    v_lshlrev_b32 v105, 4, v105
    v_add3_u32 v4, v104, v105, v102
    v_cmp_gt_u32 vcc, 0x800, v103
    s_nop 1
    v_cndmask_b32 v4, v106, v4, vcc
    v_add_u32 v103, 1, v101
    v_lshrrev_b32 v104, 5, v103
    v_lshlrev_b32 v104, 15, v104
    v_and_b32 v105, 31, v103
    v_lshlrev_b32 v105, 4, v105
    v_add3_u32 v5, v104, v105, v102
    v_cmp_gt_u32 vcc, 0x800, v103
    s_nop 1
    v_cndmask_b32 v5, v106, v5, vcc
    v_add_u32 v103, -2, v101
    v_lshrrev_b32 v104, 5, v103
    v_lshlrev_b32 v104, 15, v104
    v_and_b32 v105, 31, v103
    v_lshlrev_b32 v105, 4, v105
    v_add3_u32 v6, v104, v105, v102
    v_cmp_gt_u32 vcc, 0x800, v103
    s_nop 1
    v_cndmask_b32 v6, v106, v6, vcc
    v_add_u32 v103, 2, v101
    v_lshrrev_b32 v104, 5, v103
    v_lshlrev_b32 v104, 15, v104
    v_and_b32 v105, 31, v103
    v_lshlrev_b32 v105, 4, v105
    v_add3_u32 v7, v104, v105, v102
    v_cmp_gt_u32 vcc, 0x800, v103
    s_nop 1
    v_cndmask_b32 v7, v106, v7, vcc
    v_and_b32 v101, 31, v1
    v_lshlrev_b32 v8, 3, v101
    v_lshrrev_b32 v103, 5, v1
    v_lshlrev_b32 v103, 11, v103
    v_add_u32 v8, v8, v103
    s_lshl_b32 s3, s74, 12
    v_add_u32 v8, s3, v8
    s_lshl_b32 s3, s74, 5
    v_add_u32 v9, s3, v101
    v_lshlrev_b32 v9, 2, v9
    v_add_u32 v9, 156672, v9
    v_lshlrev_b32 v102, 2, v101
    s_lshl_b32 s3, s44, 8
    v_add_u32 v10, s3, v102
    v_lshrrev_b32 v103, 2, v101
    v_lshlrev_b32 v103, 12, v103
    v_and_b32 v104, 3, v101
    v_lshlrev_b32 v104, 10, v104
    s_lshr_b32 s3, s45, 2
    s_lshl_b32 s3, s3, 7
    s_add_u32 s3, s3, 32768
    v_add3_u32 v11, v103, v104, s3
    s_mov_b32 s72, 0
    s_mov_b32 s73, 0
    s_mov_b32 s60, s44
    s_mov_b32 s61, 0
    s_cmp_lg_u32 s46, 0
    s_cbranch_scc1 L5a_4
    s_cmp_eq_u32 s44, 0
    s_cbranch_scc1 L5b_5
    s_sub_u32 s60, s44, 1
    s_mov_b32 s61, 3072
    s_mov_b32 s72, 0xff
    s_branch L5b_5
L5a_4:
    s_cmp_lg_u32 s46, 3
    s_cbranch_scc1 L5b_5
    s_cmp_eq_u32 s44, 7
    s_cbranch_scc1 L5b_5
    s_add_u32 s60, s44, 1
    s_mov_b32 s72, 0xff
L5b_5:
    s_lshl_b32 s60, s60, 12
    s_add_u32 s60, s60, s61
    s_add_u32 s60, s60, 32768
    v_and_b32 v101, 7, v1
    v_lshlrev_b32 v101, 7, v101
    v_add_u32 v12, s60, v101
    s_lshl_b32 s3, s46, 3
    s_lshl_b32 s68, 0xff, s3
    s_mov_b32 s69, 0
    s_lshl_b64 s[64:65], 0xffffff, s3
    s_lshr_b64 s[64:65], s[64:65], 8
    s_mov_b32 s70, s64
    s_mov_b32 s71, 0
    s_waitcnt vmcnt(0)
    s_branch L_PRO_COMMON
L_PRO_LW:
    s_sub_u32 s74, s48, 6
    s_lshl_b32 s76, s74, 12
    s_add_u32 s76, s76, 66560
    v_lshrrev_b32 v101, 3, v1
    v_and_b32 v102, 2, v101
    v_lshlrev_b32 v102, 1, v102
    v_and_b32 v103, 7, v1
    v_xor_b32 v103, v103, v102
    v_lshlrev_b32 v103, 4, v103
    s_lshl_b32 s3, s74, 5
    v_add_u32 v101, s3, v101
    v_mul_u32_u24 v2, 1024, v101
    v_add_u32 v2, v2, v103
    v_mul_u32_u24 v3, 3072, v101
    v_add_u32 v3, v3, v103
    v_mul_u32_u24 v4, 3584, v101
    v_add_u32 v4, v4, v103
    v_mov_b32 v7, v101
    v_mov_b32 v8, v103
    v_lshlrev_b32 v6, 4, v1
    s_mul_i32 s77, s47, 851968
    s_lshl_b32 s56, s74, 12
    s_add_u32 s77, s77, s56
    s_add_u32 s77, s77, 37748736
    s_sub_u32 s80, s77, s56
    s_cmp_eq_u32 s74, 0
    s_cselect_b32 s81, s46, 4
    v_and_b32 v104, 31, v1
    v_lshlrev_b32 v104, 7, v104
    s_lshl_b32 s56, s47, 12
    s_add_u32 s56, s56, 32768
    v_add_u32 v9, s56, v104
    v_lshrrev_b32 v100, 5, v1
    v_lshlrev_b32 v100, 15, v100
    v_and_b32 v101, 31, v1
    v_lshlrev_b32 v101, 7, v101
    v_add_u32 v13, v100, v101
    v_bfe_u32 v100, v1, 2, 1
    v_lshlrev_b32 v100, 12, v100
    v_and_b32 v101, 3, v1
    v_lshlrev_b32 v101, 7, v101
    v_add_u32 v14, v100, v101
    v_lshlrev_b32 v15, 7, v1
    v_min_u32 v100, 47, v1
    v_add_u32 v100, 64, v100
    v_lshlrev_b32 v16, 7, v100
    v_lshrrev_b32 v100, 3, v1
    v_lshlrev_b32 v100, 15, v100
    v_and_b32 v101, 7, v1
    v_lshlrev_b32 v101, 7, v101
    v_add_u32 v17, v100, v101
    v_lshrrev_b32 v100, 4, v1
    v_lshlrev_b32 v100, 16, v100
    v_bfe_u32 v102, v1, 3, 1
    v_lshlrev_b32 v102, 10, v102
    v_add3_u32 v18, v100, v102, v101
    v_lshrrev_b32 v100, 5, v1
    v_bfe_u32 v101, v1, 2, 2
    v_lshlrev_b32 v100, 2, v100
    v_add_u32 v100, v100, v101
    v_lshlrev_b32 v100, 6, v100
    v_bfe_u32 v101, v1, 4, 1
    v_lshlrev_b32 v101, 5, v101
    v_and_b32 v102, 3, v1
    v_lshlrev_b32 v12, 4, v102
    v_lshlrev_b32 v102, 3, v102
    v_add3_u32 v10, v100, v101, v102
    v_add_u32 v10, s76, v10
    v_lshrrev_b32 v11, 2, v1
    v_add_u32 v29, s76, v6
    v_add_u32 v30, 0x10000, v29
    v_lshrrev_b32 v101, 2, v1
    v_add_u32 v101, s3, v101
    v_mul_u32_u24 v5, 3584, v101
    v_and_b32 v102, 3, v1
    v_lshlrev_b32 v102, 4, v102
    v_add_u32 v5, v5, v102
    s_waitcnt vmcnt(0)
    s_add_u32 s56, s54, 0
    s_add_u32 m0, s76, 57344
    s_nop 0
    buffer_load_dwordx4 v3, s[20:23], s56 offen lds
    s_add_u32 m0, s76, 58368
    s_add_u32 s56, s56, 24576
    buffer_load_dwordx4 v3, s[20:23], s56 offen lds
    s_add_u32 m0, s76, 59392
    s_add_u32 s56, s56, 24576
    buffer_load_dwordx4 v3, s[20:23], s56 offen lds
    s_add_u32 m0, s76, 60416
    s_add_u32 s56, s56, 24576
    buffer_load_dwordx4 v3, s[20:23], s56 offen lds
    s_add_u32 s56, s54, 196608
    s_add_u32 m0, s76, 65536
    s_nop 0
    buffer_load_dwordx4 v3, s[20:23], s56 offen lds
    s_add_u32 m0, s76, 66560
    s_add_u32 s56, s56, 24576
    buffer_load_dwordx4 v3, s[20:23], s56 offen lds
    s_add_u32 m0, s76, 67584
    s_add_u32 s56, s56, 24576
    buffer_load_dwordx4 v3, s[20:23], s56 offen lds
    s_add_u32 m0, s76, 68608
    s_add_u32 s56, s56, 24576
    buffer_load_dwordx4 v3, s[20:23], s56 offen lds
    s_add_u32 s56, s54, 393216
    s_add_u32 m0, s76, 73728
    s_nop 0
    buffer_load_dwordx4 v3, s[20:23], s56 offen lds
    s_add_u32 m0, s76, 74752
    s_add_u32 s56, s56, 24576
    buffer_load_dwordx4 v3, s[20:23], s56 offen lds
    s_add_u32 m0, s76, 75776
    s_add_u32 s56, s56, 24576
    buffer_load_dwordx4 v3, s[20:23], s56 offen lds
    s_add_u32 m0, s76, 76800
    s_add_u32 s56, s56, 24576
    buffer_load_dwordx4 v3, s[20:23], s56 offen lds
    s_add_u32 s56, s54, 589824
    s_add_u32 m0, s76, 81920
    s_nop 0
    buffer_load_dwordx4 v3, s[20:23], s56 offen lds
    s_add_u32 m0, s76, 82944
    s_add_u32 s56, s56, 24576
    buffer_load_dwordx4 v3, s[20:23], s56 offen lds
    s_add_u32 m0, s76, 83968
    s_add_u32 s56, s56, 24576
    buffer_load_dwordx4 v3, s[20:23], s56 offen lds
    s_add_u32 m0, s76, 84992
    s_add_u32 s56, s56, 24576
    buffer_load_dwordx4 v3, s[20:23], s56 offen lds
L_PRO_COMMON:
    v_lshlrev_b32 v64, 16, v32
    v_and_b32 v65, 0xffff0000, v32
    v_lshlrev_b32 v66, 16, v33
    v_and_b32 v67, 0xffff0000, v33
    v_lshlrev_b32 v68, 16, v34
    v_and_b32 v69, 0xffff0000, v34
    v_lshlrev_b32 v70, 16, v35
    v_and_b32 v71, 0xffff0000, v35
    v_lshlrev_b32 v72, 16, v36
    v_and_b32 v73, 0xffff0000, v36
    v_lshlrev_b32 v74, 16, v37
    v_and_b32 v75, 0xffff0000, v37
    v_lshlrev_b32 v76, 16, v38
    v_and_b32 v77, 0xffff0000, v38
    v_lshlrev_b32 v78, 16, v39
    v_and_b32 v79, 0xffff0000, v39
    v_lshlrev_b32 v80, 16, v40
    v_and_b32 v81, 0xffff0000, v40
    v_lshlrev_b32 v82, 16, v41
    v_and_b32 v83, 0xffff0000, v41
    v_lshlrev_b32 v84, 16, v42
    v_and_b32 v85, 0xffff0000, v42
    v_lshlrev_b32 v86, 16, v43
    v_and_b32 v87, 0xffff0000, v43
    v_lshlrev_b32 v88, 16, v44
    v_and_b32 v89, 0xffff0000, v44
    v_lshlrev_b32 v90, 16, v45
    v_and_b32 v91, 0xffff0000, v45
    v_lshlrev_b32 v92, 16, v46
    v_and_b32 v93, 0xffff0000, v46
    v_lshlrev_b32 v94, 16, v47
    v_and_b32 v95, 0xffff0000, v47
    v_lshlrev_b32 v96, 16, v48
    v_and_b32 v97, 0xffff0000, v48
    v_lshlrev_b32 v98, 16, v49
    v_and_b32 v99, 0xffff0000, v49
    v_lshlrev_b32 v100, 16, v50
    v_and_b32 v101, 0xffff0000, v50
    v_lshlrev_b32 v102, 16, v51
    v_and_b32 v103, 0xffff0000, v51
    v_lshlrev_b32 v104, 16, v52
    v_and_b32 v105, 0xffff0000, v52
    v_lshlrev_b32 v106, 16, v53
    v_and_b32 v107, 0xffff0000, v53
    v_lshlrev_b32 v108, 16, v54
    v_and_b32 v109, 0xffff0000, v54
    v_lshlrev_b32 v110, 16, v55
    v_and_b32 v111, 0xffff0000, v55
    v_lshlrev_b32 v112, 16, v56
    v_and_b32 v113, 0xffff0000, v56
    v_lshlrev_b32 v114, 16, v57
    v_and_b32 v115, 0xffff0000, v57
    v_lshlrev_b32 v116, 16, v58
    v_and_b32 v117, 0xffff0000, v58
    v_lshlrev_b32 v118, 16, v59
    v_and_b32 v119, 0xffff0000, v59
    v_lshlrev_b32 v120, 16, v60
    v_and_b32 v121, 0xffff0000, v60
    v_lshlrev_b32 v122, 16, v61
    v_and_b32 v123, 0xffff0000, v61
    v_lshlrev_b32 v124, 16, v62
    v_and_b32 v125, 0xffff0000, v62
    v_lshlrev_b32 v126, 16, v63
    v_and_b32 v127, 0xffff0000, v63
    v_pk_add_f32 v[128:129], v[64:65], v[66:67]
    v_pk_mul_f32 v[130:131], v[64:65], v[64:65]
    v_pk_fma_f32 v[130:131], v[66:67], v[66:67], v[130:131]
    v_pk_add_f32 v[128:129], v[128:129], v[68:69]
    v_pk_fma_f32 v[130:131], v[68:69], v[68:69], v[130:131]
    v_pk_add_f32 v[128:129], v[128:129], v[70:71]
    v_pk_fma_f32 v[130:131], v[70:71], v[70:71], v[130:131]
    v_pk_add_f32 v[128:129], v[128:129], v[72:73]
    v_pk_fma_f32 v[130:131], v[72:73], v[72:73], v[130:131]
    v_pk_add_f32 v[128:129], v[128:129], v[74:75]
    v_pk_fma_f32 v[130:131], v[74:75], v[74:75], v[130:131]
    v_pk_add_f32 v[128:129], v[128:129], v[76:77]
    v_pk_fma_f32 v[130:131], v[76:77], v[76:77], v[130:131]
    v_pk_add_f32 v[128:129], v[128:129], v[78:79]
    v_pk_fma_f32 v[130:131], v[78:79], v[78:79], v[130:131]
    v_pk_add_f32 v[128:129], v[128:129], v[80:81]
    v_pk_fma_f32 v[130:131], v[80:81], v[80:81], v[130:131]
    v_pk_add_f32 v[128:129], v[128:129], v[82:83]
    v_pk_fma_f32 v[130:131], v[82:83], v[82:83], v[130:131]
    v_pk_add_f32 v[128:129], v[128:129], v[84:85]
    v_pk_fma_f32 v[130:131], v[84:85], v[84:85], v[130:131]
    v_pk_add_f32 v[128:129], v[128:129], v[86:87]
    v_pk_fma_f32 v[130:131], v[86:87], v[86:87], v[130:131]
    v_pk_add_f32 v[128:129], v[128:129], v[88:89]
    v_pk_fma_f32 v[130:131], v[88:89], v[88:89], v[130:131]
    v_pk_add_f32 v[128:129], v[128:129], v[90:91]
    v_pk_fma_f32 v[130:131], v[90:91], v[90:91], v[130:131]
    v_pk_add_f32 v[128:129], v[128:129], v[92:93]
    v_pk_fma_f32 v[130:131], v[92:93], v[92:93], v[130:131]
    v_pk_add_f32 v[128:129], v[128:129], v[94:95]
    v_pk_fma_f32 v[130:131], v[94:95], v[94:95], v[130:131]
    v_pk_add_f32 v[128:129], v[128:129], v[96:97]
    v_pk_fma_f32 v[130:131], v[96:97], v[96:97], v[130:131]
    v_pk_add_f32 v[128:129], v[128:129], v[98:99]
    v_pk_fma_f32 v[130:131], v[98:99], v[98:99], v[130:131]
    v_pk_add_f32 v[128:129], v[128:129], v[100:101]
    v_pk_fma_f32 v[130:131], v[100:101], v[100:101], v[130:131]
    v_pk_add_f32 v[128:129], v[128:129], v[102:103]
    v_pk_fma_f32 v[130:131], v[102:103], v[102:103], v[130:131]
    v_pk_add_f32 v[128:129], v[128:129], v[104:105]
    v_pk_fma_f32 v[130:131], v[104:105], v[104:105], v[130:131]
    v_pk_add_f32 v[128:129], v[128:129], v[106:107]
    v_pk_fma_f32 v[130:131], v[106:107], v[106:107], v[130:131]
    v_pk_add_f32 v[128:129], v[128:129], v[108:109]
    v_pk_fma_f32 v[130:131], v[108:109], v[108:109], v[130:131]
    v_pk_add_f32 v[128:129], v[128:129], v[110:111]
    v_pk_fma_f32 v[130:131], v[110:111], v[110:111], v[130:131]
    v_pk_add_f32 v[128:129], v[128:129], v[112:113]
    v_pk_fma_f32 v[130:131], v[112:113], v[112:113], v[130:131]
    v_pk_add_f32 v[128:129], v[128:129], v[114:115]
    v_pk_fma_f32 v[130:131], v[114:115], v[114:115], v[130:131]
    v_pk_add_f32 v[128:129], v[128:129], v[116:117]
    v_pk_fma_f32 v[130:131], v[116:117], v[116:117], v[130:131]
    v_pk_add_f32 v[128:129], v[128:129], v[118:119]
    v_pk_fma_f32 v[130:131], v[118:119], v[118:119], v[130:131]
    v_pk_add_f32 v[128:129], v[128:129], v[120:121]
    v_pk_fma_f32 v[130:131], v[120:121], v[120:121], v[130:131]
    v_pk_add_f32 v[128:129], v[128:129], v[122:123]
    v_pk_fma_f32 v[130:131], v[122:123], v[122:123], v[130:131]
    v_pk_add_f32 v[128:129], v[128:129], v[124:125]
    v_pk_fma_f32 v[130:131], v[124:125], v[124:125], v[130:131]
    v_pk_add_f32 v[128:129], v[128:129], v[126:127]
    v_pk_fma_f32 v[130:131], v[126:127], v[126:127], v[130:131]
    v_add_f32 v128, v128, v129
    v_add_f32 v130, v130, v131
    s_nop 0
    v_add_f32_dpp v129, v128, v128 quad_perm:[1,0,3,2] row_mask:0xf bank_mask:0xf
    v_add_f32_dpp v131, v130, v130 quad_perm:[1,0,3,2] row_mask:0xf bank_mask:0xf
    v_mov_b32 v128, v129
    v_mov_b32 v130, v131
    s_nop 0
    v_add_f32_dpp v129, v128, v128 quad_perm:[2,3,0,1] row_mask:0xf bank_mask:0xf
    v_add_f32_dpp v131, v130, v130 quad_perm:[2,3,0,1] row_mask:0xf bank_mask:0xf
    v_mov_b32 v128, v129
    v_mov_b32 v130, v131
    s_nop 0
    v_add_f32_dpp v129, v128, v128 row_half_mirror row_mask:0xf bank_mask:0xf
    v_add_f32_dpp v131, v130, v130 row_half_mirror row_mask:0xf bank_mask:0xf
    v_mov_b32 v128, v129
    v_mov_b32 v130, v131
    v_mul_f32 v128, 0x3b000000, v128
    v_mul_f32 v130, 0x3b000000, v130
    v_fma_f32 v130, -v128, v128, v130
    v_max_f32 v130, 0, v130
    v_add_f32 v130, 0x3727c5ac, v130
    v_rsq_f32 v130, v130
    s_nop 0
    v_mul_f32 v131, v128, v130
    v_sub_f32 v131, 0, v131
    v_pk_fma_f32 v[64:65], v[64:65], v[130:131], v[130:131] op_sel:[0,0,1] op_sel_hi:[1,0,1]
    v_pk_fma_f32 v[66:67], v[66:67], v[130:131], v[130:131] op_sel:[0,0,1] op_sel_hi:[1,0,1]
    v_pk_fma_f32 v[68:69], v[68:69], v[130:131], v[130:131] op_sel:[0,0,1] op_sel_hi:[1,0,1]
    v_pk_fma_f32 v[70:71], v[70:71], v[130:131], v[130:131] op_sel:[0,0,1] op_sel_hi:[1,0,1]
    v_pk_fma_f32 v[72:73], v[72:73], v[130:131], v[130:131] op_sel:[0,0,1] op_sel_hi:[1,0,1]
    v_pk_fma_f32 v[74:75], v[74:75], v[130:131], v[130:131] op_sel:[0,0,1] op_sel_hi:[1,0,1]
    v_pk_fma_f32 v[76:77], v[76:77], v[130:131], v[130:131] op_sel:[0,0,1] op_sel_hi:[1,0,1]
    v_pk_fma_f32 v[78:79], v[78:79], v[130:131], v[130:131] op_sel:[0,0,1] op_sel_hi:[1,0,1]
    v_pk_fma_f32 v[80:81], v[80:81], v[130:131], v[130:131] op_sel:[0,0,1] op_sel_hi:[1,0,1]
    v_pk_fma_f32 v[82:83], v[82:83], v[130:131], v[130:131] op_sel:[0,0,1] op_sel_hi:[1,0,1]
    v_pk_fma_f32 v[84:85], v[84:85], v[130:131], v[130:131] op_sel:[0,0,1] op_sel_hi:[1,0,1]
    v_pk_fma_f32 v[86:87], v[86:87], v[130:131], v[130:131] op_sel:[0,0,1] op_sel_hi:[1,0,1]
    v_pk_fma_f32 v[88:89], v[88:89], v[130:131], v[130:131] op_sel:[0,0,1] op_sel_hi:[1,0,1]
    v_pk_fma_f32 v[90:91], v[90:91], v[130:131], v[130:131] op_sel:[0,0,1] op_sel_hi:[1,0,1]
    v_pk_fma_f32 v[92:93], v[92:93], v[130:131], v[130:131] op_sel:[0,0,1] op_sel_hi:[1,0,1]
    v_pk_fma_f32 v[94:95], v[94:95], v[130:131], v[130:131] op_sel:[0,0,1] op_sel_hi:[1,0,1]
    v_pk_fma_f32 v[96:97], v[96:97], v[130:131], v[130:131] op_sel:[0,0,1] op_sel_hi:[1,0,1]
    v_pk_fma_f32 v[98:99], v[98:99], v[130:131], v[130:131] op_sel:[0,0,1] op_sel_hi:[1,0,1]
    v_pk_fma_f32 v[100:101], v[100:101], v[130:131], v[130:131] op_sel:[0,0,1] op_sel_hi:[1,0,1]
    v_pk_fma_f32 v[102:103], v[102:103], v[130:131], v[130:131] op_sel:[0,0,1] op_sel_hi:[1,0,1]
    v_pk_fma_f32 v[104:105], v[104:105], v[130:131], v[130:131] op_sel:[0,0,1] op_sel_hi:[1,0,1]
    v_pk_fma_f32 v[106:107], v[106:107], v[130:131], v[130:131] op_sel:[0,0,1] op_sel_hi:[1,0,1]
    v_pk_fma_f32 v[108:109], v[108:109], v[130:131], v[130:131] op_sel:[0,0,1] op_sel_hi:[1,0,1]
    v_pk_fma_f32 v[110:111], v[110:111], v[130:131], v[130:131] op_sel:[0,0,1] op_sel_hi:[1,0,1]
    v_pk_fma_f32 v[112:113], v[112:113], v[130:131], v[130:131] op_sel:[0,0,1] op_sel_hi:[1,0,1]
    v_pk_fma_f32 v[114:115], v[114:115], v[130:131], v[130:131] op_sel:[0,0,1] op_sel_hi:[1,0,1]
    v_pk_fma_f32 v[116:117], v[116:117], v[130:131], v[130:131] op_sel:[0,0,1] op_sel_hi:[1,0,1]
    v_pk_fma_f32 v[118:119], v[118:119], v[130:131], v[130:131] op_sel:[0,0,1] op_sel_hi:[1,0,1]
    v_pk_fma_f32 v[120:121], v[120:121], v[130:131], v[130:131] op_sel:[0,0,1] op_sel_hi:[1,0,1]
    v_pk_fma_f32 v[122:123], v[122:123], v[130:131], v[130:131] op_sel:[0,0,1] op_sel_hi:[1,0,1]
    v_pk_fma_f32 v[124:125], v[124:125], v[130:131], v[130:131] op_sel:[0,0,1] op_sel_hi:[1,0,1]
    v_pk_fma_f32 v[126:127], v[126:127], v[130:131], v[130:131] op_sel:[0,0,1] op_sel_hi:[1,0,1]
    v_cvt_pk_bf16_f32 v32, v64, v65
    v_cvt_pk_bf16_f32 v33, v66, v67
    v_cvt_pk_bf16_f32 v34, v68, v69
    v_cvt_pk_bf16_f32 v35, v70, v71
    v_cvt_pk_bf16_f32 v36, v72, v73
    v_cvt_pk_bf16_f32 v37, v74, v75
    v_cvt_pk_bf16_f32 v38, v76, v77
    v_cvt_pk_bf16_f32 v39, v78, v79
    v_cvt_pk_bf16_f32 v40, v80, v81
    v_cvt_pk_bf16_f32 v41, v82, v83
    v_cvt_pk_bf16_f32 v42, v84, v85
    v_cvt_pk_bf16_f32 v43, v86, v87
    v_cvt_pk_bf16_f32 v44, v88, v89
    v_cvt_pk_bf16_f32 v45, v90, v91
    v_cvt_pk_bf16_f32 v46, v92, v93
    v_cvt_pk_bf16_f32 v47, v94, v95
    v_cvt_pk_bf16_f32 v48, v96, v97
    v_cvt_pk_bf16_f32 v49, v98, v99
    v_cvt_pk_bf16_f32 v50, v100, v101
    v_cvt_pk_bf16_f32 v51, v102, v103
    v_cvt_pk_bf16_f32 v52, v104, v105
    v_cvt_pk_bf16_f32 v53, v106, v107
    v_cvt_pk_bf16_f32 v54, v108, v109
    v_cvt_pk_bf16_f32 v55, v110, v111
    v_cvt_pk_bf16_f32 v56, v112, v113
    v_cvt_pk_bf16_f32 v57, v114, v115
    v_cvt_pk_bf16_f32 v58, v116, v117
    v_cvt_pk_bf16_f32 v59, v118, v119
    v_cvt_pk_bf16_f32 v60, v120, v121
    v_cvt_pk_bf16_f32 v61, v122, v123
    v_cvt_pk_bf16_f32 v62, v124, v125
    v_cvt_pk_bf16_f32 v63, v126, v127
    v_lshrrev_b32 v22, 5, v20
    v_mul_u32_u24 v22, 33280, v22
    v_lshrrev_b32 v23, 1, v21
    v_mul_u32_u24 v23, 1040, v23
    v_add_u32 v22, v22, v23
    v_and_b32 v23, 31, v20
    v_lshlrev_b32 v23, 4, v23
    v_add_u32 v22, v22, v23
    v_and_b32 v23, 1, v21
    v_lshlrev_b32 v23, 3, v23
    v_add_u32 v22, v22, v23
    ds_write_b64 v22, v[32:33] offset:0
    ds_write_b64 v22, v[34:35] offset:512
    ds_write_b64 v22, v[36:37] offset:4160
    ds_write_b64 v22, v[38:39] offset:4672
    ds_write_b64 v22, v[40:41] offset:8320
    ds_write_b64 v22, v[42:43] offset:8832
    ds_write_b64 v22, v[44:45] offset:12480
    ds_write_b64 v22, v[46:47] offset:12992
    ds_write_b64 v22, v[48:49] offset:16640
    ds_write_b64 v22, v[50:51] offset:17152
    ds_write_b64 v22, v[52:53] offset:20800
    ds_write_b64 v22, v[54:55] offset:21312
    ds_write_b64 v22, v[56:57] offset:24960
    ds_write_b64 v22, v[58:59] offset:25472
    ds_write_b64 v22, v[60:61] offset:29120
    ds_write_b64 v22, v[62:63] offset:29632
    v_lshlrev_b32 v24, 2, v1
    v_add_u32 v24, 156672, v24
    v_mov_b32 v25, 0
    v_mov_b32 v26, 1.0
    ds_write_b32 v24, v25 offset:1280
    ds_write_b32 v24, v26 offset:1536
    s_waitcnt lgkmcnt(0)
    s_cmp_ge_u32 s48, 6
    s_cbranch_scc1 L_LW
    s_cmp_ge_u32 s48, 4
    s_cbranch_scc1 L_LA
L_C:
    s_mul_i32 s100, s47, 64
    s_mul_i32 s63, s75, 32
    s_add_u32 s100, s100, s63
    s_lshl_b32 s62, s100, 2
    s_add_u32 s62, s62, 65536
    s_cmp_eq_u32 s49, 0
    s_cselect_b32 s62, 268435456, s62
    buffer_load_dwordx4 v[80:83], v10, s[4:7], s62 offen offset:0 sc1
    buffer_load_dwordx4 v[84:87], v10, s[4:7], s62 offen offset:32 sc1
    buffer_load_dwordx4 v[88:91], v10, s[4:7], s62 offen offset:64 sc1
    buffer_load_dwordx4 v[92:95], v10, s[4:7], s62 offen offset:96 sc1
    s_lshl_b32 s98, s47, 2
    s_lshl_b32 s56, s75, 1
    s_add_u32 s98, s98, s56
    s_lshl_b32 s98, s98, 6
    s_add_u32 s98, s98, s51
    s_add_u32 s98, s98, s74
    s_lshl_b32 s98, s98, 10
    s_add_u32 s98, s98, s50
    s_mul_i32 s99, s49, 24117248
    s_add_u32 s99, s99, s98
    s_barrier
    ds_read_b64_tr_b16 v[48:49], v3 offset:57344
    ds_read_b64_tr_b16 v[50:51], v3 offset:58368
    ds_read_b128 v[128:131], v2 offset:0
    ds_read_b64_tr_b16 v[52:53], v3 offset:59392
    ds_read_b64_tr_b16 v[54:55], v3 offset:60416
    ds_read_b128 v[132:135], v2 offset:1040
    ds_read_b64_tr_b16 v[56:57], v3 offset:61440
    ds_read_b64_tr_b16 v[58:59], v3 offset:62464
    ds_read_b128 v[136:139], v2 offset:2080
    ds_read_b64_tr_b16 v[60:61], v3 offset:63488
    ds_read_b64_tr_b16 v[62:63], v3 offset:64512
    ds_read_b128 v[140:143], v2 offset:3120
    s_barrier
    s_waitcnt lgkmcnt(3)
    v_mfma_f32_32x32x16_bf16 v[16:31], v[48:51], v[128:131], 0
    ds_read_b64_tr_b16 v[64:65], v4 offset:0
    ds_read_b64_tr_b16 v[66:67], v4 offset:1024
    ds_read_b128 v[144:147], v2 offset:4160
    v_mfma_f32_32x32x16_bf16 v[16:31], v[52:55], v[132:135], v[16:31]
    ds_read_b64_tr_b16 v[68:69], v4 offset:2048
    ds_read_b64_tr_b16 v[70:71], v4 offset:3072
    ds_read_b128 v[148:151], v2 offset:5200
    v_mfma_f32_32x32x16_bf16 v[16:31], v[56:59], v[136:139], v[16:31]
    ds_read_b64_tr_b16 v[72:73], v4 offset:4096
    ds_read_b64_tr_b16 v[74:75], v4 offset:5120
    ds_read_b128 v[152:155], v2 offset:6240
    s_waitcnt lgkmcnt(9)
    v_mfma_f32_32x32x16_bf16 v[16:31], v[60:63], v[140:143], v[16:31]
    ds_read_b64_tr_b16 v[76:77], v4 offset:6144
    ds_read_b64_tr_b16 v[78:79], v4 offset:7168
    ds_read_b128 v[156:159], v2 offset:7280
    s_barrier
    s_waitcnt lgkmcnt(3)
    v_mfma_f32_32x32x16_bf16 v[16:31], v[64:67], v[144:147], v[16:31]
    ds_read_b64_tr_b16 v[48:49], v4 offset:8192
    ds_read_b64_tr_b16 v[50:51], v4 offset:9216
    ds_read_b128 v[160:163], v2 offset:8320
    v_mfma_f32_32x32x16_bf16 v[16:31], v[68:71], v[148:151], v[16:31]
    ds_read_b64_tr_b16 v[52:53], v4 offset:10240
    ds_read_b64_tr_b16 v[54:55], v4 offset:11264
    ds_read_b128 v[164:167], v2 offset:9360
    v_mfma_f32_32x32x16_bf16 v[16:31], v[72:75], v[152:155], v[16:31]
    ds_read_b64_tr_b16 v[56:57], v4 offset:12288
    ds_read_b64_tr_b16 v[58:59], v4 offset:13312
    ds_read_b128 v[168:171], v2 offset:10400
    s_waitcnt lgkmcnt(9)
    v_mfma_f32_32x32x16_bf16 v[16:31], v[76:79], v[156:159], v[16:31]
    ds_read_b64_tr_b16 v[60:61], v4 offset:14336
    ds_read_b64_tr_b16 v[62:63], v4 offset:15360
    ds_read_b128 v[172:175], v2 offset:11440
    s_barrier
    s_waitcnt lgkmcnt(3)
    v_mfma_f32_32x32x16_bf16 v[16:31], v[48:51], v[160:163], v[16:31]
    ds_read_b64_tr_b16 v[64:65], v4 offset:16384
    ds_read_b64_tr_b16 v[66:67], v4 offset:17408
    ds_read_b128 v[176:179], v2 offset:12480
    v_mfma_f32_32x32x16_bf16 v[16:31], v[52:55], v[164:167], v[16:31]
    ds_read_b64_tr_b16 v[68:69], v4 offset:18432
    ds_read_b64_tr_b16 v[70:71], v4 offset:19456
    ds_read_b128 v[180:183], v2 offset:13520
    v_mfma_f32_32x32x16_bf16 v[16:31], v[56:59], v[168:171], v[16:31]
    ds_read_b64_tr_b16 v[72:73], v4 offset:20480
    ds_read_b64_tr_b16 v[74:75], v4 offset:21504
    ds_read_b128 v[184:187], v2 offset:14560
    s_waitcnt lgkmcnt(9)
    v_mfma_f32_32x32x16_bf16 v[16:31], v[60:63], v[172:175], v[16:31]
    ds_read_b64_tr_b16 v[76:77], v4 offset:22528
    ds_read_b64_tr_b16 v[78:79], v4 offset:23552
    ds_read_b128 v[188:191], v2 offset:15600
    s_barrier
    s_waitcnt lgkmcnt(3)
    v_mfma_f32_32x32x16_bf16 v[16:31], v[64:67], v[176:179], v[16:31]
    ds_read_b64_tr_b16 v[48:49], v3 offset:0
    ds_read_b64_tr_b16 v[50:51], v3 offset:1024
    ds_read_b128 v[192:195], v2 offset:16640
    v_mfma_f32_32x32x16_bf16 v[16:31], v[68:71], v[180:183], v[16:31]
    ds_read_b64_tr_b16 v[52:53], v3 offset:2048
    ds_read_b64_tr_b16 v[54:55], v3 offset:3072
    ds_read_b128 v[196:199], v2 offset:17680
    v_mfma_f32_32x32x16_bf16 v[16:31], v[72:75], v[184:187], v[16:31]
    ds_read_b64_tr_b16 v[56:57], v3 offset:4096
    ds_read_b64_tr_b16 v[58:59], v3 offset:5120
    ds_read_b128 v[200:203], v2 offset:18720
    s_waitcnt lgkmcnt(9)
    v_mfma_f32_32x32x16_bf16 v[16:31], v[76:79], v[188:191], v[16:31]
    ds_read_b64_tr_b16 v[60:61], v3 offset:6144
    ds_read_b64_tr_b16 v[62:63], v3 offset:7168
    ds_read_b128 v[204:207], v2 offset:19760
    s_barrier
    s_waitcnt lgkmcnt(3)
    v_mfma_f32_32x32x16_bf16 v[16:31], v[48:51], v[192:195], v[16:31]
    ds_read_b64_tr_b16 v[64:65], v3 offset:8192
    ds_read_b64_tr_b16 v[66:67], v3 offset:9216
    ds_read_b128 v[208:211], v2 offset:20800
    v_mfma_f32_32x32x16_bf16 v[16:31], v[52:55], v[196:199], v[16:31]
    ds_read_b64_tr_b16 v[68:69], v3 offset:10240
    ds_read_b64_tr_b16 v[70:71], v3 offset:11264
    ds_read_b128 v[212:215], v2 offset:21840
    v_mfma_f32_32x32x16_bf16 v[16:31], v[56:59], v[200:203], v[16:31]
    ds_read_b64_tr_b16 v[72:73], v3 offset:12288
    ds_read_b64_tr_b16 v[74:75], v3 offset:13312
    ds_read_b128 v[216:219], v2 offset:22880
    s_waitcnt lgkmcnt(9)
    v_mfma_f32_32x32x16_bf16 v[16:31], v[60:63], v[204:207], v[16:31]
    ds_read_b64_tr_b16 v[76:77], v3 offset:14336
    ds_read_b64_tr_b16 v[78:79], v3 offset:15360
    ds_read_b128 v[220:223], v2 offset:23920
    s_barrier
    s_waitcnt lgkmcnt(3)
    v_mfma_f32_32x32x16_bf16 v[16:31], v[64:67], v[208:211], v[16:31]
    ds_read_b64_tr_b16 v[48:49], v3 offset:16384
    ds_read_b64_tr_b16 v[50:51], v3 offset:17408
    ds_read_b128 v[224:227], v2 offset:24960
    v_mfma_f32_32x32x16_bf16 v[16:31], v[68:71], v[212:215], v[16:31]
    ds_read_b64_tr_b16 v[52:53], v3 offset:18432
    ds_read_b64_tr_b16 v[54:55], v3 offset:19456
    ds_read_b128 v[228:231], v2 offset:26000
    v_mfma_f32_32x32x16_bf16 v[16:31], v[72:75], v[216:219], v[16:31]
    ds_read_b64_tr_b16 v[56:57], v3 offset:20480
    ds_read_b64_tr_b16 v[58:59], v3 offset:21504
    ds_read_b128 v[232:235], v2 offset:27040
    s_waitcnt lgkmcnt(9)
    v_mfma_f32_32x32x16_bf16 v[16:31], v[76:79], v[220:223], v[16:31]
    ds_read_b64_tr_b16 v[60:61], v3 offset:22528
    ds_read_b64_tr_b16 v[62:63], v3 offset:23552
    ds_read_b128 v[236:239], v2 offset:28080
    s_barrier
    ds_read_b32 v126, v12 offset:1280
    ds_read_b32 v127, v12 offset:1536
    s_waitcnt lgkmcnt(5)
    v_mfma_f32_32x32x16_bf16 v[16:31], v[48:51], v[224:227], v[16:31]
    ds_read_b64_tr_b16 v[64:65], v3 offset:24576
    ds_read_b64_tr_b16 v[66:67], v3 offset:25600
    ds_read_b128 v[240:243], v2 offset:29120
    v_mfma_f32_32x32x16_bf16 v[16:31], v[52:55], v[228:231], v[16:31]
    ds_read_b64_tr_b16 v[68:69], v3 offset:26624
    ds_read_b64_tr_b16 v[70:71], v3 offset:27648
    ds_read_b128 v[244:247], v2 offset:30160
    v_mfma_f32_32x32x16_bf16 v[16:31], v[56:59], v[232:235], v[16:31]
    ds_read_b64_tr_b16 v[72:73], v3 offset:28672
    ds_read_b64_tr_b16 v[74:75], v3 offset:29696
    ds_read_b128 v[248:251], v2 offset:31200
    s_waitcnt lgkmcnt(11)
    v_mfma_f32_32x32x16_bf16 v[16:31], v[60:63], v[236:239], v[16:31]
    ds_read_b64_tr_b16 v[76:77], v3 offset:30720
    ds_read_b64_tr_b16 v[78:79], v3 offset:31744
    ds_read_b128 v[252:255], v2 offset:32240
    s_barrier
    s_waitcnt lgkmcnt(3)
    v_mfma_f32_32x32x16_bf16 v[16:31], v[64:67], v[240:243], v[16:31]
    ds_read_b64_tr_b16 v[48:49], v3 offset:32768
    ds_read_b64_tr_b16 v[50:51], v3 offset:33792
    v_mfma_f32_32x32x16_bf16 v[16:31], v[68:71], v[244:247], v[16:31]
    ds_read_b64_tr_b16 v[52:53], v3 offset:34816
    ds_read_b64_tr_b16 v[54:55], v3 offset:35840
    v_mfma_f32_32x32x16_bf16 v[16:31], v[72:75], v[248:251], v[16:31]
    ds_read_b64_tr_b16 v[56:57], v3 offset:36864
    ds_read_b64_tr_b16 v[58:59], v3 offset:37888
    s_waitcnt lgkmcnt(6)
    v_mfma_f32_32x32x16_bf16 v[16:31], v[76:79], v[252:255], v[16:31]
    ds_read_b64_tr_b16 v[60:61], v3 offset:38912
    ds_read_b64_tr_b16 v[62:63], v3 offset:39936
    s_barrier
    s_waitcnt lgkmcnt(2)
    v_mfma_f32_32x32x16_bf16 v[32:47], v[48:51], v[128:131], 0
    ds_read_b64_tr_b16 v[64:65], v3 offset:40960
    s_waitcnt vmcnt(0)
    ds_read_b64_tr_b16 v[66:67], v3 offset:41984
    v_mov_b32 v112, v126
    v_mfma_f32_32x32x16_bf16 v[32:47], v[52:55], v[132:135], v[32:47]
    ds_read_b64_tr_b16 v[68:69], v3 offset:43008
    v_mul_f32 v113, 0x3eb8aa3b, v127
    ds_read_b64_tr_b16 v[70:71], v3 offset:44032
    v_fma_f32 v96, v80, v112, v16
    v_mfma_f32_32x32x16_bf16 v[32:47], v[56:59], v[136:139], v[32:47]
    ds_read_b64_tr_b16 v[72:73], v3 offset:45056
    v_fma_f32 v97, v81, v112, v17
    ds_read_b64_tr_b16 v[74:75], v3 offset:46080
    v_fma_f32 v98, v82, v112, v18
    s_waitcnt lgkmcnt(6)
    v_mfma_f32_32x32x16_bf16 v[32:47], v[60:63], v[140:143], v[32:47]
    ds_read_b64_tr_b16 v[76:77], v3 offset:47104
    v_fma_f32 v99, v83, v112, v19
    ds_read_b64_tr_b16 v[78:79], v3 offset:48128
    v_fma_f32 v100, v84, v112, v20
    s_barrier
    s_waitcnt lgkmcnt(2)
    v_mfma_f32_32x32x16_bf16 v[32:47], v[64:67], v[144:147], v[32:47]
    ds_read_b64_tr_b16 v[48:49], v3 offset:49152
    v_fma_f32 v101, v85, v112, v21
    ds_read_b64_tr_b16 v[50:51], v3 offset:50176
    v_fma_f32 v102, v86, v112, v22
    v_mfma_f32_32x32x16_bf16 v[32:47], v[68:71], v[148:151], v[32:47]
    ds_read_b64_tr_b16 v[52:53], v3 offset:51200
    v_fma_f32 v103, v87, v112, v23
    ds_read_b64_tr_b16 v[54:55], v3 offset:52224
    v_fma_f32 v104, v88, v112, v24
    v_mfma_f32_32x32x16_bf16 v[32:47], v[72:75], v[152:155], v[32:47]
    ds_read_b64_tr_b16 v[56:57], v3 offset:53248
    v_fma_f32 v105, v89, v112, v25
    ds_read_b64_tr_b16 v[58:59], v3 offset:54272
    v_fma_f32 v106, v90, v112, v26
    s_waitcnt lgkmcnt(6)
    v_mfma_f32_32x32x16_bf16 v[32:47], v[76:79], v[156:159], v[32:47]
    ds_read_b64_tr_b16 v[60:61], v3 offset:55296
    v_fma_f32 v107, v91, v112, v27
    ds_read_b64_tr_b16 v[62:63], v3 offset:56320
    v_fma_f32 v108, v92, v112, v28
    s_barrier
    s_waitcnt lgkmcnt(2)
    v_mfma_f32_32x32x16_bf16 v[32:47], v[48:51], v[160:163], v[32:47]
    ds_read_b64_tr_b16 v[64:65], v3 offset:57344
    v_fma_f32 v109, v93, v112, v29
    ds_read_b64_tr_b16 v[66:67], v3 offset:58368
    v_fma_f32 v110, v94, v112, v30
    v_mfma_f32_32x32x16_bf16 v[32:47], v[52:55], v[164:167], v[32:47]
    ds_read_b64_tr_b16 v[68:69], v3 offset:59392
    v_fma_f32 v111, v95, v112, v31
    ds_read_b64_tr_b16 v[70:71], v3 offset:60416
    v_mul_f32 v96, v96, v113
    v_mfma_f32_32x32x16_bf16 v[32:47], v[56:59], v[168:171], v[32:47]
    ds_read_b64_tr_b16 v[72:73], v3 offset:61440
    v_mul_f32 v97, v97, v113
    ds_read_b64_tr_b16 v[74:75], v3 offset:62464
    v_mul_f32 v98, v98, v113
    s_waitcnt lgkmcnt(6)
    v_mfma_f32_32x32x16_bf16 v[32:47], v[60:63], v[172:175], v[32:47]
    ds_read_b64_tr_b16 v[76:77], v3 offset:63488
    v_mul_f32 v99, v99, v113
    ds_read_b64_tr_b16 v[78:79], v3 offset:64512
    v_mul_f32 v100, v100, v113
    s_barrier
    s_waitcnt lgkmcnt(2)
    v_mfma_f32_32x32x16_bf16 v[32:47], v[64:67], v[176:179], v[32:47]
    ds_read_b64_tr_b16 v[48:49], v4 offset:0
    v_mul_f32 v101, v101, v113
    ds_read_b64_tr_b16 v[50:51], v4 offset:1024
    v_mul_f32 v102, v102, v113
    v_mfma_f32_32x32x16_bf16 v[32:47], v[68:71], v[180:183], v[32:47]
    ds_read_b64_tr_b16 v[52:53], v4 offset:2048
    v_mul_f32 v103, v103, v113
    ds_read_b64_tr_b16 v[54:55], v4 offset:3072
    v_mul_f32 v104, v104, v113
    v_mfma_f32_32x32x16_bf16 v[32:47], v[72:75], v[184:187], v[32:47]
    ds_read_b64_tr_b16 v[56:57], v4 offset:4096
    v_mul_f32 v105, v105, v113
    ds_read_b64_tr_b16 v[58:59], v4 offset:5120
    v_mul_f32 v106, v106, v113
    s_waitcnt lgkmcnt(6)
    v_mfma_f32_32x32x16_bf16 v[32:47], v[76:79], v[188:191], v[32:47]
    ds_read_b64_tr_b16 v[60:61], v4 offset:6144
    v_mul_f32 v107, v107, v113
    ds_read_b64_tr_b16 v[62:63], v4 offset:7168
    v_mul_f32 v108, v108, v113
    s_barrier
    s_waitcnt lgkmcnt(2)
    v_mfma_f32_32x32x16_bf16 v[32:47], v[48:51], v[192:195], v[32:47]
    ds_read_b64_tr_b16 v[64:65], v4 offset:8192
    v_mul_f32 v109, v109, v113
    ds_read_b64_tr_b16 v[66:67], v4 offset:9216
    v_mul_f32 v110, v110, v113
    v_mfma_f32_32x32x16_bf16 v[32:47], v[52:55], v[196:199], v[32:47]
    ds_read_b64_tr_b16 v[68:69], v4 offset:10240
    v_mul_f32 v111, v111, v113
    ds_read_b64_tr_b16 v[70:71], v4 offset:11264
    s_lshl_b32 s62, s100, 2
    v_mfma_f32_32x32x16_bf16 v[32:47], v[56:59], v[200:203], v[32:47]
    ds_read_b64_tr_b16 v[72:73], v4 offset:12288
    s_add_u32 s62, s62, 67584
    ds_read_b64_tr_b16 v[74:75], v4 offset:13312
    s_cmp_eq_u32 s49, 0
    s_cselect_b32 s62, 268435456, s62
    s_waitcnt lgkmcnt(6)
    v_mfma_f32_32x32x16_bf16 v[32:47], v[60:63], v[204:207], v[32:47]
    ds_read_b64_tr_b16 v[76:77], v4 offset:14336
    buffer_load_dwordx4 v[80:83], v10, s[4:7], s62 offen offset:0 sc1
    ds_read_b64_tr_b16 v[78:79], v4 offset:15360
    buffer_load_dwordx4 v[84:87], v10, s[4:7], s62 offen offset:32 sc1
    s_barrier
    s_waitcnt lgkmcnt(2)
    v_mfma_f32_32x32x16_bf16 v[32:47], v[64:67], v[208:211], v[32:47]
    ds_read_b64_tr_b16 v[48:49], v4 offset:16384
    buffer_load_dwordx4 v[88:91], v10, s[4:7], s62 offen offset:64 sc1
    ds_read_b64_tr_b16 v[50:51], v4 offset:17408
    buffer_load_dwordx4 v[92:95], v10, s[4:7], s62 offen offset:96 sc1
    v_mfma_f32_32x32x16_bf16 v[32:47], v[68:71], v[212:215], v[32:47]
    ds_read_b64_tr_b16 v[52:53], v4 offset:18432
    v_cvt_pk_bf16_f32 v116, v96, v97
    ds_read_b64_tr_b16 v[54:55], v4 offset:19456
    v_cvt_pk_bf16_f32 v117, v98, v99
    v_mfma_f32_32x32x16_bf16 v[32:47], v[72:75], v[216:219], v[32:47]
    ds_read_b64_tr_b16 v[56:57], v4 offset:20480
    v_cvt_pk_bf16_f32 v118, v100, v101
    ds_read_b64_tr_b16 v[58:59], v4 offset:21504
    v_cvt_pk_bf16_f32 v119, v102, v103
    s_waitcnt lgkmcnt(6)
    v_mfma_f32_32x32x16_bf16 v[32:47], v[76:79], v[220:223], v[32:47]
    ds_read_b64_tr_b16 v[60:61], v4 offset:22528
    v_cvt_pk_bf16_f32 v120, v104, v105
    ds_read_b64_tr_b16 v[62:63], v4 offset:23552
    v_cvt_pk_bf16_f32 v121, v106, v107
    s_barrier
    s_waitcnt lgkmcnt(2)
    v_mfma_f32_32x32x16_bf16 v[32:47], v[48:51], v[224:227], v[32:47]
    ds_read_b64_tr_b16 v[64:65], v3 offset:0
    v_cvt_pk_bf16_f32 v122, v108, v109
    ds_read_b64_tr_b16 v[66:67], v3 offset:1024
    v_cvt_pk_bf16_f32 v123, v110, v111
    v_mfma_f32_32x32x16_bf16 v[32:47], v[52:55], v[228:231], v[32:47]
    ds_read_b64_tr_b16 v[68:69], v3 offset:2048
    s_add_u32 s56, s98, 0
    s_add_u32 s57, s56, 65536
    ds_read_b64_tr_b16 v[70:71], v3 offset:3072
    s_cmp_eq_u32 s52, 0
    s_cbranch_scc1 Lst_safe_6
    buffer_store_dwordx4 v[116:119], v7, s[4:7], s56 offen
    buffer_store_dwordx4 v[120:123], v7, s[4:7], s57 offen
    s_branch Lst_done_7
Lst_safe_6:
    buffer_store_dwordx4 v[116:119], v7, s[4:7], s56 offen sc1
    buffer_store_dwordx4 v[120:123], v7, s[4:7], s57 offen sc1
Lst_done_7:
    v_mfma_f32_32x32x16_bf16 v[32:47], v[56:59], v[232:235], v[32:47]
    ds_read_b64_tr_b16 v[72:73], v3 offset:4096
    ds_read_b64_tr_b16 v[74:75], v3 offset:5120
    s_waitcnt lgkmcnt(6)
    v_mfma_f32_32x32x16_bf16 v[32:47], v[60:63], v[236:239], v[32:47]
    ds_read_b64_tr_b16 v[76:77], v3 offset:6144
    ds_read_b64_tr_b16 v[78:79], v3 offset:7168
    s_barrier
    s_waitcnt lgkmcnt(2)
    v_mfma_f32_32x32x16_bf16 v[32:47], v[64:67], v[240:243], v[32:47]
    ds_read_b64_tr_b16 v[48:49], v3 offset:8192
    ds_read_b64_tr_b16 v[50:51], v3 offset:9216
    v_mfma_f32_32x32x16_bf16 v[32:47], v[68:71], v[244:247], v[32:47]
    ds_read_b64_tr_b16 v[52:53], v3 offset:10240
    ds_read_b64_tr_b16 v[54:55], v3 offset:11264
    v_mfma_f32_32x32x16_bf16 v[32:47], v[72:75], v[248:251], v[32:47]
    ds_read_b64_tr_b16 v[56:57], v3 offset:12288
    ds_read_b64_tr_b16 v[58:59], v3 offset:13312
    s_waitcnt lgkmcnt(6)
    v_mfma_f32_32x32x16_bf16 v[32:47], v[76:79], v[252:255], v[32:47]
    ds_read_b64_tr_b16 v[60:61], v3 offset:14336
    ds_read_b64_tr_b16 v[62:63], v3 offset:15360
    s_barrier
    s_waitcnt lgkmcnt(2)
    v_mfma_f32_32x32x16_bf16 v[16:31], v[128:131], v[48:51], 0
    ds_read_b64_tr_b16 v[64:65], v3 offset:16384
    s_waitcnt vmcnt(2)
    ds_read_b64_tr_b16 v[66:67], v3 offset:17408
    s_nop 3
    v_fma_f32 v96, v80, v126, v32
    v_mfma_f32_32x32x16_bf16 v[16:31], v[132:135], v[52:55], v[16:31]
    ds_read_b64_tr_b16 v[68:69], v3 offset:18432
    v_fma_f32 v97, v81, v126, v33
    ds_read_b64_tr_b16 v[70:71], v3 offset:19456
    v_fma_f32 v98, v82, v126, v34
    v_mfma_f32_32x32x16_bf16 v[16:31], v[136:139], v[56:59], v[16:31]
    ds_read_b64_tr_b16 v[72:73], v3 offset:20480
    v_fma_f32 v99, v83, v126, v35
    ds_read_b64_tr_b16 v[74:75], v3 offset:21504
    v_fma_f32 v100, v84, v126, v36
    s_waitcnt lgkmcnt(6)
    v_mfma_f32_32x32x16_bf16 v[16:31], v[140:143], v[60:63], v[16:31]
    ds_read_b64_tr_b16 v[76:77], v3 offset:22528
    v_fma_f32 v101, v85, v126, v37
    ds_read_b64_tr_b16 v[78:79], v3 offset:23552
    v_fma_f32 v102, v86, v126, v38
    s_barrier
    s_waitcnt lgkmcnt(2)
    v_mfma_f32_32x32x16_bf16 v[16:31], v[144:147], v[64:67], v[16:31]
    ds_read_b64_tr_b16 v[48:49], v3 offset:24576
    v_fma_f32 v103, v87, v126, v39
    ds_read_b64_tr_b16 v[50:51], v3 offset:25600
    v_fma_f32 v104, v88, v126, v40
    v_mfma_f32_32x32x16_bf16 v[16:31], v[148:151], v[68:71], v[16:31]
    ds_read_b64_tr_b16 v[52:53], v3 offset:26624
    v_fma_f32 v105, v89, v126, v41
    ds_read_b64_tr_b16 v[54:55], v3 offset:27648
    v_fma_f32 v106, v90, v126, v42
    v_mfma_f32_32x32x16_bf16 v[16:31], v[152:155], v[72:75], v[16:31]
    ds_read_b64_tr_b16 v[56:57], v3 offset:28672
    v_fma_f32 v107, v91, v126, v43
    ds_read_b64_tr_b16 v[58:59], v3 offset:29696
    v_fma_f32 v108, v92, v126, v44
    s_waitcnt lgkmcnt(6)
    v_mfma_f32_32x32x16_bf16 v[16:31], v[156:159], v[76:79], v[16:31]
    ds_read_b64_tr_b16 v[60:61], v3 offset:30720
    v_fma_f32 v109, v93, v126, v45
    ds_read_b64_tr_b16 v[62:63], v3 offset:31744
    v_fma_f32 v110, v94, v126, v46
    s_barrier
    s_waitcnt lgkmcnt(2)
    v_mfma_f32_32x32x16_bf16 v[16:31], v[160:163], v[48:51], v[16:31]
    ds_read_b64_tr_b16 v[64:65], v3 offset:32768
    v_fma_f32 v111, v95, v126, v47
    ds_read_b64_tr_b16 v[66:67], v3 offset:33792
    v_mul_f32 v96, v96, v127
    v_mfma_f32_32x32x16_bf16 v[16:31], v[164:167], v[52:55], v[16:31]
    ds_read_b64_tr_b16 v[68:69], v3 offset:34816
    v_mul_f32 v97, v97, v127
    ds_read_b64_tr_b16 v[70:71], v3 offset:35840
    v_mul_f32 v98, v98, v127
    v_mfma_f32_32x32x16_bf16 v[16:31], v[168:171], v[56:59], v[16:31]
    ds_read_b64_tr_b16 v[72:73], v3 offset:36864
    v_mul_f32 v99, v99, v127
    ds_read_b64_tr_b16 v[74:75], v3 offset:37888
    v_mul_f32 v100, v100, v127
    s_waitcnt lgkmcnt(6)
    v_mfma_f32_32x32x16_bf16 v[16:31], v[172:175], v[60:63], v[16:31]
    ds_read_b64_tr_b16 v[76:77], v3 offset:38912
    v_mul_f32 v101, v101, v127
    ds_read_b64_tr_b16 v[78:79], v3 offset:39936
    v_mul_f32 v102, v102, v127
    s_barrier
    s_waitcnt lgkmcnt(2)
    v_mfma_f32_32x32x16_bf16 v[16:31], v[176:179], v[64:67], v[16:31]
    ds_read_b64_tr_b16 v[48:49], v3 offset:40960
    v_mul_f32 v103, v103, v127
    ds_read_b64_tr_b16 v[50:51], v3 offset:41984
    v_mul_f32 v104, v104, v127
    v_mfma_f32_32x32x16_bf16 v[16:31], v[180:183], v[68:71], v[16:31]
    ds_read_b64_tr_b16 v[52:53], v3 offset:43008
    v_mul_f32 v105, v105, v127
    ds_read_b64_tr_b16 v[54:55], v3 offset:44032
    v_mul_f32 v106, v106, v127
    v_mfma_f32_32x32x16_bf16 v[16:31], v[184:187], v[72:75], v[16:31]
    ds_read_b64_tr_b16 v[56:57], v3 offset:45056
    v_mul_f32 v107, v107, v127
    ds_read_b64_tr_b16 v[58:59], v3 offset:46080
    v_mul_f32 v108, v108, v127
    s_waitcnt lgkmcnt(6)
    v_mfma_f32_32x32x16_bf16 v[16:31], v[188:191], v[76:79], v[16:31]
    ds_read_b64_tr_b16 v[60:61], v3 offset:47104
    v_mul_f32 v109, v109, v127
    ds_read_b64_tr_b16 v[62:63], v3 offset:48128
    v_mul_f32 v110, v110, v127
    s_barrier
    s_waitcnt lgkmcnt(2)
    v_mfma_f32_32x32x16_bf16 v[16:31], v[192:195], v[48:51], v[16:31]
    ds_read_b64_tr_b16 v[64:65], v3 offset:49152
    v_mul_f32 v111, v111, v127
    ds_read_b64_tr_b16 v[66:67], v3 offset:50176
    s_lshl_b32 s62, s100, 2
    v_mfma_f32_32x32x16_bf16 v[16:31], v[196:199], v[52:55], v[16:31]
    ds_read_b64_tr_b16 v[68:69], v3 offset:51200
    s_add_u32 s62, s62, 69632
    ds_read_b64_tr_b16 v[70:71], v3 offset:52224
    s_cmp_eq_u32 s49, 0
    s_cselect_b32 s62, 268435456, s62
    v_mfma_f32_32x32x16_bf16 v[16:31], v[200:203], v[56:59], v[16:31]
    ds_read_b64_tr_b16 v[72:73], v3 offset:53248
    buffer_load_dword v15, v11, s[4:7], s62 offen sc1
    ds_read_b64_tr_b16 v[74:75], v3 offset:54272
    v_cvt_pk_bf16_f32 v116, v96, v97
    s_waitcnt lgkmcnt(6)
    v_mfma_f32_32x32x16_bf16 v[16:31], v[204:207], v[60:63], v[16:31]
    ds_read_b64_tr_b16 v[76:77], v3 offset:55296
    v_cvt_pk_bf16_f32 v117, v98, v99
    ds_read_b64_tr_b16 v[78:79], v3 offset:56320
    v_cvt_pk_bf16_f32 v118, v100, v101
    s_barrier
    s_waitcnt lgkmcnt(2)
    v_mfma_f32_32x32x16_bf16 v[16:31], v[208:211], v[64:67], v[16:31]
    ds_read_b64_tr_b16 v[48:49], v3 offset:57344
    v_cvt_pk_bf16_f32 v119, v102, v103
    ds_read_b64_tr_b16 v[50:51], v3 offset:58368
    v_cvt_pk_bf16_f32 v120, v104, v105
    v_mfma_f32_32x32x16_bf16 v[16:31], v[212:215], v[68:71], v[16:31]
    ds_read_b64_tr_b16 v[52:53], v3 offset:59392
    v_cvt_pk_bf16_f32 v121, v106, v107
    ds_read_b64_tr_b16 v[54:55], v3 offset:60416
    v_cvt_pk_bf16_f32 v122, v108, v109
    v_mfma_f32_32x32x16_bf16 v[16:31], v[216:219], v[72:75], v[16:31]
    ds_read_b64_tr_b16 v[56:57], v3 offset:61440
    v_cvt_pk_bf16_f32 v123, v110, v111
    ds_read_b64_tr_b16 v[58:59], v3 offset:62464
    s_add_u32 s56, s99, 2097152
    s_add_u32 s57, s56, 65536
    s_waitcnt lgkmcnt(6)
    v_mfma_f32_32x32x16_bf16 v[16:31], v[220:223], v[76:79], v[16:31]
    ds_read_b64_tr_b16 v[60:61], v3 offset:63488
    buffer_store_dwordx4 v[116:119], v7, s[4:7], s56 offen sc1
    ds_read_b64_tr_b16 v[62:63], v3 offset:64512
    buffer_store_dwordx4 v[120:123], v7, s[4:7], s57 offen sc1
    s_barrier
    s_waitcnt lgkmcnt(2)
    v_mfma_f32_32x32x16_bf16 v[16:31], v[224:227], v[48:51], v[16:31]
    ds_read_b64_tr_b16 v[64:65], v4 offset:0
    ds_read_b64_tr_b16 v[66:67], v4 offset:1024
    v_mfma_f32_32x32x16_bf16 v[16:31], v[228:231], v[52:55], v[16:31]
    ds_read_b64_tr_b16 v[68:69], v4 offset:2048
    ds_read_b64_tr_b16 v[70:71], v4 offset:3072
    v_mfma_f32_32x32x16_bf16 v[16:31], v[232:235], v[56:59], v[16:31]
    ds_read_b64_tr_b16 v[72:73], v4 offset:4096
    ds_read_b64_tr_b16 v[74:75], v4 offset:5120
    s_waitcnt lgkmcnt(6)
    v_mfma_f32_32x32x16_bf16 v[16:31], v[236:239], v[60:63], v[16:31]
    ds_read_b64_tr_b16 v[76:77], v4 offset:6144
    ds_read_b64_tr_b16 v[78:79], v4 offset:7168
    s_waitcnt lgkmcnt(2)
    v_mfma_f32_32x32x16_bf16 v[16:31], v[240:243], v[64:67], v[16:31]
    v_mfma_f32_32x32x16_bf16 v[16:31], v[244:247], v[68:71], v[16:31]
    v_mfma_f32_32x32x16_bf16 v[16:31], v[248:251], v[72:75], v[16:31]
    s_waitcnt lgkmcnt(0)
    v_mfma_f32_32x32x16_bf16 v[16:31], v[252:255], v[76:79], v[16:31]
    ds_read_b128 v[80:83], v13 offset:1280
    ds_read_b128 v[48:51], v13 offset:1536
    ds_read_b128 v[84:87], v13 offset:1312
    ds_read_b128 v[52:55], v13 offset:1568
    ds_read_b128 v[88:91], v13 offset:1344
    ds_read_b128 v[56:59], v13 offset:1600
    ds_read_b128 v[92:95], v13 offset:1376
    ds_read_b128 v[60:63], v13 offset:1632
    s_waitcnt vmcnt(2) lgkmcnt(0)
    v_mov_b32 v112, v15
    s_nop 1
    v_pk_fma_f32 v[96:97], v[80:81], v[112:113], v[16:17] op_sel_hi:[1,0,1]
    v_pk_fma_f32 v[98:99], v[82:83], v[112:113], v[18:19] op_sel_hi:[1,0,1]
    v_pk_fma_f32 v[100:101], v[84:85], v[112:113], v[20:21] op_sel_hi:[1,0,1]
    v_pk_fma_f32 v[102:103], v[86:87], v[112:113], v[22:23] op_sel_hi:[1,0,1]
    v_pk_fma_f32 v[104:105], v[88:89], v[112:113], v[24:25] op_sel_hi:[1,0,1]
    v_pk_fma_f32 v[106:107], v[90:91], v[112:113], v[26:27] op_sel_hi:[1,0,1]
    v_pk_fma_f32 v[108:109], v[92:93], v[112:113], v[28:29] op_sel_hi:[1,0,1]
    v_pk_fma_f32 v[110:111], v[94:95], v[112:113], v[30:31] op_sel_hi:[1,0,1]
    v_pk_mul_f32 v[96:97], v[96:97], v[48:49]
    v_pk_mul_f32 v[98:99], v[98:99], v[50:51]
    v_pk_mul_f32 v[100:101], v[100:101], v[52:53]
    v_pk_mul_f32 v[102:103], v[102:103], v[54:55]
    v_pk_mul_f32 v[104:105], v[104:105], v[56:57]
    v_pk_mul_f32 v[106:107], v[106:107], v[58:59]
    v_pk_mul_f32 v[108:109], v[108:109], v[60:61]
    v_pk_mul_f32 v[110:111], v[110:111], v[62:63]
    v_cvt_pk_bf16_f32 v116, v96, v97
    v_cvt_pk_bf16_f32 v117, v98, v99
    v_cvt_pk_bf16_f32 v118, v100, v101
    v_cvt_pk_bf16_f32 v119, v102, v103
    v_cvt_pk_bf16_f32 v120, v104, v105
    v_cvt_pk_bf16_f32 v121, v106, v107
    v_cvt_pk_bf16_f32 v122, v108, v109
    v_cvt_pk_bf16_f32 v123, v110, v111
    s_add_u32 s56, s99, 4194304
    buffer_store_dwordx4 v[116:119], v14, s[4:7], s56 offen sc1
    buffer_store_dwordx4 v[120:123], v14, s[4:7], s56 offen offset:512 sc1
    s_waitcnt vmcnt(0)
    s_barrier
    v_lshlrev_b32 v24, 4, v1
    v_lshrrev_b32 v172, 5, v1
    v_lshlrev_b32 v172, 8, v172
    v_and_b32 v173, 15, v1
    v_lshlrev_b32 v173, 4, v173
    v_add_u32 v25, v172, v173
    v_and_b32 v172, 27, v1
    v_cmp_eq_u32 vcc, 16, v172
    v_mov_b32 v173, 49168
    v_mov_b32 v174, 49152
    v_cndmask_b32 v173, v173, v174, vcc
    v_and_b32 v172, 16, v1
    v_cmp_eq_u32 vcc, 0, v172
    s_nop 1
    v_cndmask_b32 v21, v173, v25, vcc
    v_add_u32 v174, 16384, v25
    v_cndmask_b32 v23, v173, v174, vcc
    v_add_u32 v174, 32768, v25
    v_cndmask_b32 v26, v173, v174, vcc
    s_cmp_lg_u32 s48, 0
    s_cbranch_scc1 Lnotw_8
    v_lshrrev_b32 v172, 1, v1
    v_lshlrev_b32 v172, 9, v172
    v_and_b32 v173, 1, v1
    v_lshlrev_b32 v174, 4, v173
    v_add3_u32 v172, v172, v174, 0
    v_add_u32 v172, 57344, v172
    v_cmp_eq_u32 vcc, 0, v173
    v_mov_b32 v174, 0x3f803f80
    s_nop 0
    v_cndmask_b32 v176, 0, v174, vcc
    v_mov_b32 v177, v176
    v_mov_b32 v178, v176
    v_mov_b32 v179, v176
    s_mov_b64 s[92:93], exec
    s_mov_b64 exec, s[96:97]
    ds_write_b128 v172, v[176:179]
    s_mov_b64 exec, s[92:93]
Lnotw_8:
    v_mov_b32 v44, 0
    v_mov_b32 v52, 0
    v_mov_b32 v45, 0
    v_mov_b32 v53, 0
    v_mov_b32 v46, 0
    v_mov_b32 v54, 0
    v_mov_b32 v47, 0
    v_mov_b32 v55, 0
    v_mov_b32 v48, 0
    v_mov_b32 v56, 0
    v_mov_b32 v49, 0
    v_mov_b32 v57, 0
    v_mov_b32 v50, 0
    v_mov_b32 v58, 0
    v_mov_b32 v51, 0
    v_mov_b32 v59, 0
    v_mov_b32 v140, 0
    v_mov_b32 v141, 0
    v_mov_b32 v142, 0
    v_mov_b32 v143, 0
    v_mov_b32 v144, 0
    v_mov_b32 v145, 0
    v_mov_b32 v146, 0
    v_mov_b32 v147, 0
    v_mov_b32 v148, 0
    v_mov_b32 v149, 0
    v_mov_b32 v150, 0
    v_mov_b32 v151, 0
    v_mov_b32 v152, 0
    v_mov_b32 v153, 0
    v_mov_b32 v154, 0
    v_mov_b32 v155, 0
    v_mov_b32 v124, 0
    v_mov_b32 v125, 0
    v_mov_b32 v126, 0
    v_mov_b32 v127, 0
    v_mov_b32 v128, 0
    v_mov_b32 v129, 0
    v_mov_b32 v130, 0
    v_mov_b32 v131, 0
    v_mov_b32 v156, 0
    v_mov_b32 v157, 0
    v_mov_b32 v158, 0
    v_mov_b32 v159, 0
    v_mov_b32 v160, 0
    v_mov_b32 v161, 0
    v_mov_b32 v162, 0
    v_mov_b32 v163, 0
    v_mov_b32 v164, 0
    v_mov_b32 v165, 0
    v_mov_b32 v166, 0
    v_mov_b32 v167, 0
    v_mov_b32 v168, 0
    v_mov_b32 v169, 0
    v_mov_b32 v170, 0
    v_mov_b32 v171, 0
    v_mov_b32 v132, 0
    v_mov_b32 v133, 0
    v_mov_b32 v134, 0
    v_mov_b32 v135, 0
    v_mov_b32 v136, 0
    v_mov_b32 v137, 0
    v_mov_b32 v138, 0
    v_mov_b32 v139, 0
    v_mov_b32 v172, 159360
    v_mov_b32 v173, 0
    ds_write_b32 v172, v173
    v_mov_b32 v20, v24
    s_lshl_b32 s3, s48, 11
    s_add_u32 s3, s3, 49152
    v_add_u32 v174, s3, v24
    s_waitcnt lgkmcnt(0)
    s_barrier
    ds_read_b128 v[28:31], v174
    ds_read_b128 v[32:35], v174 offset:1024
    ds_read_b128 v[36:39], v20
    ds_read_b128 v[40:43], v20 offset:1024
    ds_read_b128 v[44:47], v21 offset:8192
    ds_read_b128 v[48:51], v21 offset:8704
    v_mov_b32 v172, 159364
    ds_read_b32 v173, v172
    s_waitcnt lgkmcnt(0)
    v_readfirstlane_b32 s52, v173
    v_mfma_f32_32x32x16_bf16 v[60:75], v[36:39], v[28:31], 0
    v_mfma_f32_32x32x16_bf16 v[92:107], v[36:39], v[32:35], 0
    v_mfma_f32_32x32x16_bf16 v[76:91], v[40:43], v[28:31], 0
    v_mfma_f32_32x32x16_bf16 v[108:123], v[40:43], v[32:35], 0
    ds_read_b128 v[36:39], v20 offset:2048
    s_mov_b32 s81, 0
    s_mov_b32 s78, 0
L_ATT_LOOP:
    s_add_u32 s56, s78, 1
    s_cmp_eq_u32 s56, 3
    s_cselect_b32 s78, 0, s56
    s_lshl_b32 s57, s78, 14
    v_add_u32 v22, s57, v24
    s_waitcnt lgkmcnt(0)
    v_exp_f32 v60, v60
    v_exp_f32 v61, v61
    v_exp_f32 v62, v62
    v_cvt_pk_bf16_f32 v124, v60, v61
    v_exp_f32 v63, v63
    v_mfma_f32_32x32x16_bf16 v[156:171], v[56:59], v[136:139], v[156:171]
    ds_read_b128 v[40:43], v20 offset:3072
    ds_read_b128 v[52:55], v21 offset:9216
    ds_read_b128 v[56:59], v21 offset:9728
    v_exp_f32 v64, v64
    v_cvt_pk_bf16_f32 v125, v62, v63
    v_exp_f32 v65, v65
    v_exp_f32 v66, v66
    v_cvt_pk_bf16_f32 v126, v64, v65
    v_exp_f32 v67, v67
    v_exp_f32 v68, v68
    v_cvt_pk_bf16_f32 v127, v66, v67
    v_exp_f32 v69, v69
    v_exp_f32 v70, v70
    v_mfma_f32_32x32x16_bf16 v[140:155], v[44:47], v[124:127], v[140:155]
    v_cvt_pk_bf16_f32 v128, v68, v69
    v_exp_f32 v71, v71
    v_exp_f32 v72, v72
    v_cvt_pk_bf16_f32 v129, v70, v71
    v_exp_f32 v73, v73
    v_exp_f32 v74, v74
    v_exp_f32 v75, v75
    v_cvt_pk_bf16_f32 v130, v72, v73
    v_cvt_pk_bf16_f32 v131, v74, v75
    v_mfma_f32_32x32x16_bf16 v[60:75], v[36:39], v[28:31], 0
    v_exp_f32 v92, v92
    v_exp_f32 v93, v93
    v_exp_f32 v94, v94
    v_cvt_pk_bf16_f32 v132, v92, v93
    v_exp_f32 v95, v95
    v_mfma_f32_32x32x16_bf16 v[140:155], v[48:51], v[128:131], v[140:155]
    v_exp_f32 v96, v96
    v_cvt_pk_bf16_f32 v133, v94, v95
    v_exp_f32 v97, v97
    v_exp_f32 v98, v98
    v_cvt_pk_bf16_f32 v134, v96, v97
    v_exp_f32 v99, v99
    v_exp_f32 v100, v100
    v_cvt_pk_bf16_f32 v135, v98, v99
    v_exp_f32 v101, v101
    v_exp_f32 v102, v102
    v_mfma_f32_32x32x16_bf16 v[156:171], v[44:47], v[132:135], v[156:171]
    v_cvt_pk_bf16_f32 v136, v100, v101
    v_exp_f32 v103, v103
    v_exp_f32 v104, v104
    v_cvt_pk_bf16_f32 v137, v102, v103
    v_exp_f32 v105, v105
    v_exp_f32 v106, v106
    v_exp_f32 v107, v107
    v_cvt_pk_bf16_f32 v138, v104, v105
    v_cvt_pk_bf16_f32 v139, v106, v107
    v_mfma_f32_32x32x16_bf16 v[92:107], v[36:39], v[32:35], 0
    s_waitcnt lgkmcnt(0)
    v_exp_f32 v76, v76
    v_exp_f32 v77, v77
    v_exp_f32 v78, v78
    v_cvt_pk_bf16_f32 v124, v76, v77
    v_exp_f32 v79, v79
    v_mfma_f32_32x32x16_bf16 v[156:171], v[48:51], v[136:139], v[156:171]
    ds_read_b128 v[36:39], v20 offset:4096
    ds_read_b128 v[44:47], v21 offset:10240
    ds_read_b128 v[48:51], v21 offset:10752
    v_exp_f32 v80, v80
    v_cvt_pk_bf16_f32 v125, v78, v79
    v_exp_f32 v81, v81
    v_exp_f32 v82, v82
    v_cvt_pk_bf16_f32 v126, v80, v81
    v_exp_f32 v83, v83
    v_exp_f32 v84, v84
    v_cvt_pk_bf16_f32 v127, v82, v83
    v_exp_f32 v85, v85
    v_exp_f32 v86, v86
    v_mfma_f32_32x32x16_bf16 v[140:155], v[52:55], v[124:127], v[140:155]
    v_cvt_pk_bf16_f32 v128, v84, v85
    v_exp_f32 v87, v87
    v_exp_f32 v88, v88
    v_cvt_pk_bf16_f32 v129, v86, v87
    v_exp_f32 v89, v89
    v_exp_f32 v90, v90
    v_exp_f32 v91, v91
    v_cvt_pk_bf16_f32 v130, v88, v89
    v_cvt_pk_bf16_f32 v131, v90, v91
    v_mfma_f32_32x32x16_bf16 v[76:91], v[40:43], v[28:31], 0
    v_exp_f32 v108, v108
    v_exp_f32 v109, v109
    v_exp_f32 v110, v110
    v_cvt_pk_bf16_f32 v132, v108, v109
    v_exp_f32 v111, v111
    v_mfma_f32_32x32x16_bf16 v[140:155], v[56:59], v[128:131], v[140:155]
    v_exp_f32 v112, v112
    v_cvt_pk_bf16_f32 v133, v110, v111
    v_exp_f32 v113, v113
    v_exp_f32 v114, v114
    v_cvt_pk_bf16_f32 v134, v112, v113
    v_exp_f32 v115, v115
    v_exp_f32 v116, v116
    v_cvt_pk_bf16_f32 v135, v114, v115
    v_exp_f32 v117, v117
    v_exp_f32 v118, v118
    v_mfma_f32_32x32x16_bf16 v[156:171], v[52:55], v[132:135], v[156:171]
    v_cvt_pk_bf16_f32 v136, v116, v117
    v_exp_f32 v119, v119
    v_exp_f32 v120, v120
    v_cvt_pk_bf16_f32 v137, v118, v119
    v_exp_f32 v121, v121
    v_exp_f32 v122, v122
    v_exp_f32 v123, v123
    v_cvt_pk_bf16_f32 v138, v120, v121
    v_cvt_pk_bf16_f32 v139, v122, v123
    v_mfma_f32_32x32x16_bf16 v[108:123], v[40:43], v[32:35], 0
    s_waitcnt lgkmcnt(0)
    v_exp_f32 v60, v60
    v_exp_f32 v61, v61
    v_exp_f32 v62, v62
    v_cvt_pk_bf16_f32 v124, v60, v61
    v_exp_f32 v63, v63
    v_mfma_f32_32x32x16_bf16 v[156:171], v[56:59], v[136:139], v[156:171]
    ds_read_b128 v[40:43], v20 offset:5120
    ds_read_b128 v[52:55], v21 offset:11264
    ds_read_b128 v[56:59], v21 offset:11776
    v_exp_f32 v64, v64
    v_cvt_pk_bf16_f32 v125, v62, v63
    v_exp_f32 v65, v65
    v_exp_f32 v66, v66
    v_cvt_pk_bf16_f32 v126, v64, v65
    v_exp_f32 v67, v67
    v_exp_f32 v68, v68
    v_cvt_pk_bf16_f32 v127, v66, v67
    v_exp_f32 v69, v69
    v_exp_f32 v70, v70
    v_mfma_f32_32x32x16_bf16 v[140:155], v[44:47], v[124:127], v[140:155]
    v_cvt_pk_bf16_f32 v128, v68, v69
    v_exp_f32 v71, v71
    v_exp_f32 v72, v72
    v_cvt_pk_bf16_f32 v129, v70, v71
    v_exp_f32 v73, v73
    v_exp_f32 v74, v74
    v_exp_f32 v75, v75
    v_cvt_pk_bf16_f32 v130, v72, v73
    v_cvt_pk_bf16_f32 v131, v74, v75
    v_mfma_f32_32x32x16_bf16 v[60:75], v[36:39], v[28:31], 0
    v_exp_f32 v92, v92
    v_exp_f32 v93, v93
    v_exp_f32 v94, v94
    v_cvt_pk_bf16_f32 v132, v92, v93
    v_exp_f32 v95, v95
    v_mfma_f32_32x32x16_bf16 v[140:155], v[48:51], v[128:131], v[140:155]
    v_exp_f32 v96, v96
    v_cvt_pk_bf16_f32 v133, v94, v95
    v_exp_f32 v97, v97
    v_exp_f32 v98, v98
    v_cvt_pk_bf16_f32 v134, v96, v97
    v_exp_f32 v99, v99
    v_exp_f32 v100, v100
    v_cvt_pk_bf16_f32 v135, v98, v99
    v_exp_f32 v101, v101
    v_exp_f32 v102, v102
    v_mfma_f32_32x32x16_bf16 v[156:171], v[44:47], v[132:135], v[156:171]
    v_cvt_pk_bf16_f32 v136, v100, v101
    v_exp_f32 v103, v103
    v_exp_f32 v104, v104
    v_cvt_pk_bf16_f32 v137, v102, v103
    v_exp_f32 v105, v105
    v_exp_f32 v106, v106
    v_exp_f32 v107, v107
    v_cvt_pk_bf16_f32 v138, v104, v105
    v_cvt_pk_bf16_f32 v139, v106, v107
    v_mfma_f32_32x32x16_bf16 v[92:107], v[36:39], v[32:35], 0
    s_waitcnt lgkmcnt(0)
    v_exp_f32 v76, v76
    v_exp_f32 v77, v77
    v_exp_f32 v78, v78
    v_cvt_pk_bf16_f32 v124, v76, v77
    v_exp_f32 v79, v79
    v_mfma_f32_32x32x16_bf16 v[156:171], v[48:51], v[136:139], v[156:171]
    ds_read_b128 v[36:39], v20 offset:6144
    ds_read_b128 v[44:47], v21 offset:12288
    ds_read_b128 v[48:51], v21 offset:12800
    v_exp_f32 v80, v80
    v_cvt_pk_bf16_f32 v125, v78, v79
    v_exp_f32 v81, v81
    v_exp_f32 v82, v82
    v_cvt_pk_bf16_f32 v126, v80, v81
    v_exp_f32 v83, v83
    v_exp_f32 v84, v84
    v_cvt_pk_bf16_f32 v127, v82, v83
    v_exp_f32 v85, v85
    v_exp_f32 v86, v86
    v_mfma_f32_32x32x16_bf16 v[140:155], v[52:55], v[124:127], v[140:155]
    v_cvt_pk_bf16_f32 v128, v84, v85
    v_exp_f32 v87, v87
    v_exp_f32 v88, v88
    v_cvt_pk_bf16_f32 v129, v86, v87
    v_exp_f32 v89, v89
    v_exp_f32 v90, v90
    v_exp_f32 v91, v91
    v_cvt_pk_bf16_f32 v130, v88, v89
    v_cvt_pk_bf16_f32 v131, v90, v91
    v_mfma_f32_32x32x16_bf16 v[76:91], v[40:43], v[28:31], 0
    v_exp_f32 v108, v108
    v_exp_f32 v109, v109
    v_exp_f32 v110, v110
    v_cvt_pk_bf16_f32 v132, v108, v109
    v_exp_f32 v111, v111
    v_mfma_f32_32x32x16_bf16 v[140:155], v[56:59], v[128:131], v[140:155]
    v_exp_f32 v112, v112
    v_cvt_pk_bf16_f32 v133, v110, v111
    v_exp_f32 v113, v113
    v_exp_f32 v114, v114
    v_cvt_pk_bf16_f32 v134, v112, v113
    v_exp_f32 v115, v115
    v_exp_f32 v116, v116
    v_cvt_pk_bf16_f32 v135, v114, v115
    v_exp_f32 v117, v117
    v_exp_f32 v118, v118
    v_mfma_f32_32x32x16_bf16 v[156:171], v[52:55], v[132:135], v[156:171]
    v_cvt_pk_bf16_f32 v136, v116, v117
    v_exp_f32 v119, v119
    v_exp_f32 v120, v120
    v_cvt_pk_bf16_f32 v137, v118, v119
    v_exp_f32 v121, v121
    v_exp_f32 v122, v122
    v_exp_f32 v123, v123
    v_cvt_pk_bf16_f32 v138, v120, v121
    v_cvt_pk_bf16_f32 v139, v122, v123
    v_mfma_f32_32x32x16_bf16 v[108:123], v[40:43], v[32:35], 0
    s_waitcnt lgkmcnt(0)
    v_exp_f32 v60, v60
    v_exp_f32 v61, v61
    v_exp_f32 v62, v62
    v_cvt_pk_bf16_f32 v124, v60, v61
    v_exp_f32 v63, v63
    v_mfma_f32_32x32x16_bf16 v[156:171], v[56:59], v[136:139], v[156:171]
    ds_read_b128 v[40:43], v20 offset:7168
    ds_read_b128 v[52:55], v21 offset:13312
    ds_read_b128 v[56:59], v21 offset:13824
    v_exp_f32 v64, v64
    v_cvt_pk_bf16_f32 v125, v62, v63
    v_exp_f32 v65, v65
    v_exp_f32 v66, v66
    v_cvt_pk_bf16_f32 v126, v64, v65
    v_exp_f32 v67, v67
    v_exp_f32 v68, v68
    v_cvt_pk_bf16_f32 v127, v66, v67
    v_exp_f32 v69, v69
    v_exp_f32 v70, v70
    v_mfma_f32_32x32x16_bf16 v[140:155], v[44:47], v[124:127], v[140:155]
    v_cvt_pk_bf16_f32 v128, v68, v69
    v_exp_f32 v71, v71
    v_exp_f32 v72, v72
    v_cvt_pk_bf16_f32 v129, v70, v71
    v_exp_f32 v73, v73
    v_exp_f32 v74, v74
    v_exp_f32 v75, v75
    v_cvt_pk_bf16_f32 v130, v72, v73
    v_cvt_pk_bf16_f32 v131, v74, v75
    v_mfma_f32_32x32x16_bf16 v[60:75], v[36:39], v[28:31], 0
    v_exp_f32 v92, v92
    v_exp_f32 v93, v93
    v_exp_f32 v94, v94
    v_cvt_pk_bf16_f32 v132, v92, v93
    v_exp_f32 v95, v95
    v_mfma_f32_32x32x16_bf16 v[140:155], v[48:51], v[128:131], v[140:155]
    v_exp_f32 v96, v96
    v_cvt_pk_bf16_f32 v133, v94, v95
    v_exp_f32 v97, v97
    v_exp_f32 v98, v98
    v_cvt_pk_bf16_f32 v134, v96, v97
    v_exp_f32 v99, v99
    v_exp_f32 v100, v100
    v_cvt_pk_bf16_f32 v135, v98, v99
    v_exp_f32 v101, v101
    v_exp_f32 v102, v102
    v_mfma_f32_32x32x16_bf16 v[156:171], v[44:47], v[132:135], v[156:171]
    v_cvt_pk_bf16_f32 v136, v100, v101
    v_exp_f32 v103, v103
    v_exp_f32 v104, v104
    v_cvt_pk_bf16_f32 v137, v102, v103
    v_exp_f32 v105, v105
    v_exp_f32 v106, v106
    v_exp_f32 v107, v107
    v_cvt_pk_bf16_f32 v138, v104, v105
    v_cvt_pk_bf16_f32 v139, v106, v107
    v_mfma_f32_32x32x16_bf16 v[92:107], v[36:39], v[32:35], 0
    s_barrier
    s_waitcnt lgkmcnt(0)
    v_exp_f32 v76, v76
    v_exp_f32 v77, v77
    v_exp_f32 v78, v78
    v_cvt_pk_bf16_f32 v124, v76, v77
    v_exp_f32 v79, v79
    v_mfma_f32_32x32x16_bf16 v[156:171], v[48:51], v[136:139], v[156:171]
    ds_read_b128 v[36:39], v22 offset:0
    ds_read_b128 v[44:47], v21 offset:14336
    ds_read_b128 v[48:51], v21 offset:14848
    v_exp_f32 v80, v80
    v_cvt_pk_bf16_f32 v125, v78, v79
    v_exp_f32 v81, v81
    v_exp_f32 v82, v82
    v_cvt_pk_bf16_f32 v126, v80, v81
    v_exp_f32 v83, v83
    v_exp_f32 v84, v84
    v_cvt_pk_bf16_f32 v127, v82, v83
    v_exp_f32 v85, v85
    v_exp_f32 v86, v86
    v_mfma_f32_32x32x16_bf16 v[140:155], v[52:55], v[124:127], v[140:155]
    v_cvt_pk_bf16_f32 v128, v84, v85
    v_exp_f32 v87, v87
    v_exp_f32 v88, v88
    v_cvt_pk_bf16_f32 v129, v86, v87
    v_exp_f32 v89, v89
    v_exp_f32 v90, v90
    v_exp_f32 v91, v91
    v_cvt_pk_bf16_f32 v130, v88, v89
    v_cvt_pk_bf16_f32 v131, v90, v91
    v_mfma_f32_32x32x16_bf16 v[76:91], v[40:43], v[28:31], 0
    v_exp_f32 v108, v108
    v_exp_f32 v109, v109
    v_exp_f32 v110, v110
    v_cvt_pk_bf16_f32 v132, v108, v109
    v_exp_f32 v111, v111
    v_mfma_f32_32x32x16_bf16 v[140:155], v[56:59], v[128:131], v[140:155]
    v_exp_f32 v112, v112
    v_cvt_pk_bf16_f32 v133, v110, v111
    v_exp_f32 v113, v113
    v_exp_f32 v114, v114
    v_cvt_pk_bf16_f32 v134, v112, v113
    v_exp_f32 v115, v115
    v_exp_f32 v116, v116
    v_cvt_pk_bf16_f32 v135, v114, v115
    v_exp_f32 v117, v117
    v_exp_f32 v118, v118
    v_mfma_f32_32x32x16_bf16 v[156:171], v[52:55], v[132:135], v[156:171]
    v_cvt_pk_bf16_f32 v136, v116, v117
    v_exp_f32 v119, v119
    v_exp_f32 v120, v120
    v_cvt_pk_bf16_f32 v137, v118, v119
    v_exp_f32 v121, v121
    v_exp_f32 v122, v122
    v_exp_f32 v123, v123
    v_cvt_pk_bf16_f32 v138, v120, v121
    v_cvt_pk_bf16_f32 v139, v122, v123
    v_mfma_f32_32x32x16_bf16 v[108:123], v[40:43], v[32:35], 0
    s_waitcnt lgkmcnt(0)
    v_exp_f32 v60, v60
    v_exp_f32 v61, v61
    v_exp_f32 v62, v62
    v_cvt_pk_bf16_f32 v124, v60, v61
    v_exp_f32 v63, v63
    v_mfma_f32_32x32x16_bf16 v[156:171], v[56:59], v[136:139], v[156:171]
    ds_read_b128 v[40:43], v22 offset:1024
    ds_read_b128 v[52:55], v21 offset:15360
    ds_read_b128 v[56:59], v21 offset:15872
    v_exp_f32 v64, v64
    v_cvt_pk_bf16_f32 v125, v62, v63
    v_exp_f32 v65, v65
    v_exp_f32 v66, v66
    v_cvt_pk_bf16_f32 v126, v64, v65
    v_exp_f32 v67, v67
    v_exp_f32 v68, v68
    v_cvt_pk_bf16_f32 v127, v66, v67
    v_exp_f32 v69, v69
    v_exp_f32 v70, v70
    v_mfma_f32_32x32x16_bf16 v[140:155], v[44:47], v[124:127], v[140:155]
    v_cvt_pk_bf16_f32 v128, v68, v69
    v_exp_f32 v71, v71
    v_exp_f32 v72, v72
    v_cvt_pk_bf16_f32 v129, v70, v71
    v_exp_f32 v73, v73
    v_exp_f32 v74, v74
    v_exp_f32 v75, v75
    v_cvt_pk_bf16_f32 v130, v72, v73
    v_cvt_pk_bf16_f32 v131, v74, v75
    v_mfma_f32_32x32x16_bf16 v[60:75], v[36:39], v[28:31], 0
    v_exp_f32 v92, v92
    v_exp_f32 v93, v93
    v_exp_f32 v94, v94
    v_cvt_pk_bf16_f32 v132, v92, v93
    v_exp_f32 v95, v95
    v_mfma_f32_32x32x16_bf16 v[140:155], v[48:51], v[128:131], v[140:155]
    v_exp_f32 v96, v96
    v_cvt_pk_bf16_f32 v133, v94, v95
    v_exp_f32 v97, v97
    v_exp_f32 v98, v98
    v_cvt_pk_bf16_f32 v134, v96, v97
    v_exp_f32 v99, v99
    v_exp_f32 v100, v100
    v_cvt_pk_bf16_f32 v135, v98, v99
    v_exp_f32 v101, v101
    v_exp_f32 v102, v102
    v_mfma_f32_32x32x16_bf16 v[156:171], v[44:47], v[132:135], v[156:171]
    v_cvt_pk_bf16_f32 v136, v100, v101
    v_exp_f32 v103, v103
    v_exp_f32 v104, v104
    v_cvt_pk_bf16_f32 v137, v102, v103
    v_exp_f32 v105, v105
    v_exp_f32 v106, v106
    v_exp_f32 v107, v107
    v_cvt_pk_bf16_f32 v138, v104, v105
    v_cvt_pk_bf16_f32 v139, v106, v107
    v_mfma_f32_32x32x16_bf16 v[92:107], v[36:39], v[32:35], 0
    s_waitcnt lgkmcnt(0)
    v_exp_f32 v76, v76
    v_exp_f32 v77, v77
    v_exp_f32 v78, v78
    v_cvt_pk_bf16_f32 v124, v76, v77
    v_exp_f32 v79, v79
    v_mfma_f32_32x32x16_bf16 v[156:171], v[48:51], v[136:139], v[156:171]
    ds_read_b128 v[36:39], v22 offset:2048
    ds_read_b128 v[44:47], v23 offset:8192
    ds_read_b128 v[48:51], v23 offset:8704
    v_exp_f32 v80, v80
    v_cvt_pk_bf16_f32 v125, v78, v79
    v_exp_f32 v81, v81
    v_exp_f32 v82, v82
    v_cvt_pk_bf16_f32 v126, v80, v81
    v_exp_f32 v83, v83
    v_exp_f32 v84, v84
    v_cvt_pk_bf16_f32 v127, v82, v83
    v_exp_f32 v85, v85
    v_exp_f32 v86, v86
    v_mfma_f32_32x32x16_bf16 v[140:155], v[52:55], v[124:127], v[140:155]
    v_cvt_pk_bf16_f32 v128, v84, v85
    v_exp_f32 v87, v87
    v_exp_f32 v88, v88
    v_cvt_pk_bf16_f32 v129, v86, v87
    v_exp_f32 v89, v89
    v_exp_f32 v90, v90
    v_exp_f32 v91, v91
    v_cvt_pk_bf16_f32 v130, v88, v89
    v_cvt_pk_bf16_f32 v131, v90, v91
    v_mfma_f32_32x32x16_bf16 v[76:91], v[40:43], v[28:31], 0
    v_exp_f32 v108, v108
    v_exp_f32 v109, v109
    v_exp_f32 v110, v110
    v_cvt_pk_bf16_f32 v132, v108, v109
    v_exp_f32 v111, v111
    v_mfma_f32_32x32x16_bf16 v[140:155], v[56:59], v[128:131], v[140:155]
    v_exp_f32 v112, v112
    v_cvt_pk_bf16_f32 v133, v110, v111
    v_exp_f32 v113, v113
    v_exp_f32 v114, v114
    v_cvt_pk_bf16_f32 v134, v112, v113
    v_exp_f32 v115, v115
    v_exp_f32 v116, v116
    v_cvt_pk_bf16_f32 v135, v114, v115
    v_exp_f32 v117, v117
    v_exp_f32 v118, v118
    v_mfma_f32_32x32x16_bf16 v[156:171], v[52:55], v[132:135], v[156:171]
    v_cvt_pk_bf16_f32 v136, v116, v117
    v_exp_f32 v119, v119
    v_exp_f32 v120, v120
    v_cvt_pk_bf16_f32 v137, v118, v119
    v_exp_f32 v121, v121
    v_exp_f32 v122, v122
    v_exp_f32 v123, v123
    v_cvt_pk_bf16_f32 v138, v120, v121
    v_cvt_pk_bf16_f32 v139, v122, v123
    v_mfma_f32_32x32x16_bf16 v[108:123], v[40:43], v[32:35], 0
    v_mov_b32 v20, v22
    v_mov_b32 v172, v21
    v_mov_b32 v21, v23
    v_mov_b32 v23, v26
    v_mov_b32 v26, v172
    s_add_u32 s81, s81, 1
    s_cmp_lt_u32 s81, 8
    s_cbranch_scc1 L_ATT_LOOP
    v_mfma_f32_32x32x16_bf16 v[156:171], v[56:59], v[136:139], v[156:171]
    v_rcp_f32 v172, v148
    s_nop 0
    v_pk_mul_f32 v[174:175], v[140:141], v[172:173] op_sel_hi:[1,0]
    v_pk_mul_f32 v[176:177], v[142:143], v[172:173] op_sel_hi:[1,0]
    v_pk_mul_f32 v[178:179], v[144:145], v[172:173] op_sel_hi:[1,0]
    v_pk_mul_f32 v[180:181], v[146:147], v[172:173] op_sel_hi:[1,0]
    v_cvt_pk_bf16_f32 v124, v174, v175
    v_cvt_pk_bf16_f32 v125, v176, v177
    v_cvt_pk_bf16_f32 v126, v178, v179
    v_cvt_pk_bf16_f32 v127, v180, v181
    s_nop 1
    v_rcp_f32 v172, v164
    s_nop 0
    v_pk_mul_f32 v[174:175], v[156:157], v[172:173] op_sel_hi:[1,0]
    v_pk_mul_f32 v[176:177], v[158:159], v[172:173] op_sel_hi:[1,0]
    v_pk_mul_f32 v[178:179], v[160:161], v[172:173] op_sel_hi:[1,0]
    v_pk_mul_f32 v[180:181], v[162:163], v[172:173] op_sel_hi:[1,0]
    v_cvt_pk_bf16_f32 v132, v174, v175
    v_cvt_pk_bf16_f32 v133, v176, v177
    v_cvt_pk_bf16_f32 v134, v178, v179
    v_cvt_pk_bf16_f32 v135, v180, v181
    s_lshl_b32 s56, s44, 3
    s_lshl_b32 s57, s48, 1
    s_add_u32 s56, s56, s57
    s_lshl_b32 s56, s56, 5
    s_add_u32 s56, s56, s45
    s_lshl_b32 s56, s56, 10
    s_add_u32 s56, s56, s50
    s_add_u32 s56, s56, 6291456
    s_add_u32 s57, s56, 32768
    s_cmp_eq_u32 s52, 0
    s_cbranch_scc1 Lst_safe_9
    buffer_store_dwordx4 v[124:127], v24, s[4:7], s56 offen
    buffer_store_dwordx4 v[132:135], v24, s[4:7], s57 offen
    s_branch Lst_done_10
Lst_safe_9:
    buffer_store_dwordx4 v[124:127], v24, s[4:7], s56 offen sc1
    buffer_store_dwordx4 v[132:135], v24, s[4:7], s57 offen sc1
Lst_done_10:
    s_mov_b32 s58, 0x21800000
    s_mov_b32 s59, 0x71800000
    s_mov_b64 s[64:65], -1
    v_mul_f32 v184, 0, v140
    v_fma_f32 v184, v141, 0, v184
    v_fma_f32 v184, v142, 0, v184
    v_fma_f32 v184, v143, 0, v184
    v_fma_f32 v184, v144, 0, v184
    v_fma_f32 v184, v145, 0, v184
    v_fma_f32 v184, v146, 0, v184
    v_fma_f32 v184, v147, 0, v184
    v_cmp_eq_f32 vcc, 0, v184
    s_nop 0
    s_and_b64 s[64:65], s[64:65], vcc
    v_cmp_le_f32 vcc, s58, v148
    s_nop 0
    s_and_b64 s[64:65], s[64:65], vcc
    v_cmp_ge_f32 vcc, s59, v148
    s_nop 0
    s_and_b64 s[64:65], s[64:65], vcc
    v_mul_f32 v184, 0, v156
    v_fma_f32 v184, v157, 0, v184
    v_fma_f32 v184, v158, 0, v184
    v_fma_f32 v184, v159, 0, v184
    v_fma_f32 v184, v160, 0, v184
    v_fma_f32 v184, v161, 0, v184
    v_fma_f32 v184, v162, 0, v184
    v_fma_f32 v184, v163, 0, v184
    v_cmp_eq_f32 vcc, 0, v184
    s_nop 0
    s_and_b64 s[64:65], s[64:65], vcc
    v_cmp_le_f32 vcc, s58, v164
    s_nop 0
    s_and_b64 s[64:65], s[64:65], vcc
    v_cmp_ge_f32 vcc, s59, v164
    s_nop 0
    s_and_b64 s[64:65], s[64:65], vcc
    s_cmp_eq_u64 s[64:65], -1
    s_cbranch_scc1 Latt_ok_11
    v_mov_b32 v172, 159360
    v_mov_b32 v173, 1
    ds_write_b32 v172, v173
Latt_ok_11:
    s_waitcnt vmcnt(0) lgkmcnt(0)
    s_barrier
    v_mov_b32 v172, 159360
    ds_read_b32 v173, v172
    s_waitcnt lgkmcnt(0)
    v_readfirstlane_b32 s56, v173
    s_nop 0
    s_cmp_eq_u32 s56, 0
    s_cbranch_scc1 L_ATT_DONE
    v_and_b32 v186, 27, v1
    v_cmp_eq_u32 vcc, 16, v186
    v_mov_b32 v184, 0x3f803f80
    s_nop 0
    v_cndmask_b32 v186, 0, v184, vcc
    v_mov_b32 v44, v186
    v_mov_b32 v45, v186
    v_mov_b32 v46, v186
    v_mov_b32 v47, v186
    v_mov_b32 v48, v186
    v_mov_b32 v49, v186
    v_mov_b32 v50, v186
    v_mov_b32 v51, v186
    v_mov_b32 v140, 0
    v_mov_b32 v141, 0
    v_mov_b32 v142, 0
    v_mov_b32 v143, 0
    v_mov_b32 v144, 0
    v_mov_b32 v145, 0
    v_mov_b32 v146, 0
    v_mov_b32 v147, 0
    v_mov_b32 v148, 0
    v_mov_b32 v149, 0
    v_mov_b32 v150, 0
    v_mov_b32 v151, 0
    v_mov_b32 v152, 0
    v_mov_b32 v153, 0
    v_mov_b32 v154, 0
    v_mov_b32 v155, 0
    v_mov_b32 v182, 0xff800000
    v_mov_b32 v156, 0
    v_mov_b32 v157, 0
    v_mov_b32 v158, 0
    v_mov_b32 v159, 0
    v_mov_b32 v160, 0
    v_mov_b32 v161, 0
    v_mov_b32 v162, 0
    v_mov_b32 v163, 0
    v_mov_b32 v164, 0
    v_mov_b32 v165, 0
    v_mov_b32 v166, 0
    v_mov_b32 v167, 0
    v_mov_b32 v168, 0
    v_mov_b32 v169, 0
    v_mov_b32 v170, 0
    v_mov_b32 v171, 0
    v_mov_b32 v183, 0xff800000
    s_lshl_b32 s80, s45, 16
    s_add_u32 s80, s80, s50
    s_add_u32 s80, s80, 2097152
    s_mul_i32 s56, s49, 24117248
    s_add_u32 s80, s80, s56
    s_mov_b32 s81, 0
L_SLOW_LOOP:
    s_lshl_b32 s56, s81, 10
    s_add_u32 s56, s56, s80
    buffer_load_dwordx4 v[36:39], v24, s[4:7], s56 offen sc1
    s_add_u32 s56, s56, 2097152
    s_mov_b64 exec, s[66:67]
    buffer_load_dwordx4 v[44:47], v25, s[4:7], s56 offen sc1
    buffer_load_dwordx4 v[48:51], v25, s[4:7], s56 offen offset:512 sc1
    s_mov_b64 exec, -1
    s_waitcnt vmcnt(0)
    v_mfma_f32_32x32x16_bf16 v[60:75], v[36:39], v[28:31], 0
    s_nop 11
    v_max3_f32 v184, v60, v61, v62
    v_max3_f32 v184, v184, v63, v64
    v_max3_f32 v184, v184, v65, v66
    v_max3_f32 v184, v184, v67, v68
    v_max3_f32 v184, v184, v69, v70
    v_max3_f32 v184, v184, v71, v72
    v_max3_f32 v184, v184, v73, v74
    v_max_f32 v184, v184, v75
    v_mov_b32 v186, v184
    s_nop 1
    v_permlane32_swap_b32 v184, v186
    v_max3_f32 v184, v184, v186, v182
    v_sub_f32 v185, v182, v184
    v_exp_f32 v185, v185
    v_mov_b32 v182, v184
    v_sub_f32 v60, v60, v184
    v_exp_f32 v60, v60
    v_sub_f32 v61, v61, v184
    v_exp_f32 v61, v61
    v_sub_f32 v62, v62, v184
    v_exp_f32 v62, v62
    v_sub_f32 v63, v63, v184
    v_exp_f32 v63, v63
    v_sub_f32 v64, v64, v184
    v_exp_f32 v64, v64
    v_sub_f32 v65, v65, v184
    v_exp_f32 v65, v65
    v_sub_f32 v66, v66, v184
    v_exp_f32 v66, v66
    v_sub_f32 v67, v67, v184
    v_exp_f32 v67, v67
    v_sub_f32 v68, v68, v184
    v_exp_f32 v68, v68
    v_sub_f32 v69, v69, v184
    v_exp_f32 v69, v69
    v_sub_f32 v70, v70, v184
    v_exp_f32 v70, v70
    v_sub_f32 v71, v71, v184
    v_exp_f32 v71, v71
    v_sub_f32 v72, v72, v184
    v_exp_f32 v72, v72
    v_sub_f32 v73, v73, v184
    v_exp_f32 v73, v73
    v_sub_f32 v74, v74, v184
    v_exp_f32 v74, v74
    v_sub_f32 v75, v75, v184
    v_exp_f32 v75, v75
    v_cvt_pk_bf16_f32 v124, v60, v61
    v_cvt_pk_bf16_f32 v125, v62, v63
    v_cvt_pk_bf16_f32 v126, v64, v65
    v_cvt_pk_bf16_f32 v127, v66, v67
    v_cvt_pk_bf16_f32 v128, v68, v69
    v_cvt_pk_bf16_f32 v129, v70, v71
    v_cvt_pk_bf16_f32 v130, v72, v73
    v_cvt_pk_bf16_f32 v131, v74, v75
    v_mul_f32 v140, v140, v185
    v_mul_f32 v141, v141, v185
    v_mul_f32 v142, v142, v185
    v_mul_f32 v143, v143, v185
    v_mul_f32 v144, v144, v185
    v_mul_f32 v145, v145, v185
    v_mul_f32 v146, v146, v185
    v_mul_f32 v147, v147, v185
    v_mul_f32 v148, v148, v185
    v_mul_f32 v149, v149, v185
    v_mul_f32 v150, v150, v185
    v_mul_f32 v151, v151, v185
    v_mul_f32 v152, v152, v185
    v_mul_f32 v153, v153, v185
    v_mul_f32 v154, v154, v185
    v_mul_f32 v155, v155, v185
    s_nop 1
    v_mfma_f32_32x32x16_bf16 v[140:155], v[44:47], v[124:127], v[140:155]
    v_mfma_f32_32x32x16_bf16 v[140:155], v[48:51], v[128:131], v[140:155]
    v_mfma_f32_32x32x16_bf16 v[92:107], v[36:39], v[32:35], 0
    s_nop 11
    v_max3_f32 v184, v92, v93, v94
    v_max3_f32 v184, v184, v95, v96
    v_max3_f32 v184, v184, v97, v98
    v_max3_f32 v184, v184, v99, v100
    v_max3_f32 v184, v184, v101, v102
    v_max3_f32 v184, v184, v103, v104
    v_max3_f32 v184, v184, v105, v106
    v_max_f32 v184, v184, v107
    v_mov_b32 v186, v184
    s_nop 1
    v_permlane32_swap_b32 v184, v186
    v_max3_f32 v184, v184, v186, v183
    v_sub_f32 v185, v183, v184
    v_exp_f32 v185, v185
    v_mov_b32 v183, v184
    v_sub_f32 v92, v92, v184
    v_exp_f32 v92, v92
    v_sub_f32 v93, v93, v184
    v_exp_f32 v93, v93
    v_sub_f32 v94, v94, v184
    v_exp_f32 v94, v94
    v_sub_f32 v95, v95, v184
    v_exp_f32 v95, v95
    v_sub_f32 v96, v96, v184
    v_exp_f32 v96, v96
    v_sub_f32 v97, v97, v184
    v_exp_f32 v97, v97
    v_sub_f32 v98, v98, v184
    v_exp_f32 v98, v98
    v_sub_f32 v99, v99, v184
    v_exp_f32 v99, v99
    v_sub_f32 v100, v100, v184
    v_exp_f32 v100, v100
    v_sub_f32 v101, v101, v184
    v_exp_f32 v101, v101
    v_sub_f32 v102, v102, v184
    v_exp_f32 v102, v102
    v_sub_f32 v103, v103, v184
    v_exp_f32 v103, v103
    v_sub_f32 v104, v104, v184
    v_exp_f32 v104, v104
    v_sub_f32 v105, v105, v184
    v_exp_f32 v105, v105
    v_sub_f32 v106, v106, v184
    v_exp_f32 v106, v106
    v_sub_f32 v107, v107, v184
    v_exp_f32 v107, v107
    v_cvt_pk_bf16_f32 v132, v92, v93
    v_cvt_pk_bf16_f32 v133, v94, v95
    v_cvt_pk_bf16_f32 v134, v96, v97
    v_cvt_pk_bf16_f32 v135, v98, v99
    v_cvt_pk_bf16_f32 v136, v100, v101
    v_cvt_pk_bf16_f32 v137, v102, v103
    v_cvt_pk_bf16_f32 v138, v104, v105
    v_cvt_pk_bf16_f32 v139, v106, v107
    v_mul_f32 v156, v156, v185
    v_mul_f32 v157, v157, v185
    v_mul_f32 v158, v158, v185
    v_mul_f32 v159, v159, v185
    v_mul_f32 v160, v160, v185
    v_mul_f32 v161, v161, v185
    v_mul_f32 v162, v162, v185
    v_mul_f32 v163, v163, v185
    v_mul_f32 v164, v164, v185
    v_mul_f32 v165, v165, v185
    v_mul_f32 v166, v166, v185
    v_mul_f32 v167, v167, v185
    v_mul_f32 v168, v168, v185
    v_mul_f32 v169, v169, v185
    v_mul_f32 v170, v170, v185
    v_mul_f32 v171, v171, v185
    s_nop 1
    v_mfma_f32_32x32x16_bf16 v[156:171], v[44:47], v[132:135], v[156:171]
    v_mfma_f32_32x32x16_bf16 v[156:171], v[48:51], v[136:139], v[156:171]
    s_nop 7
    s_nop 7
    s_add_u32 s81, s81, 1
    s_cmp_lt_u32 s81, 64
    s_cbranch_scc1 L_SLOW_LOOP
    v_rcp_f32 v172, v148
    s_nop 0
    v_pk_mul_f32 v[174:175], v[140:141], v[172:173] op_sel_hi:[1,0]
    v_pk_mul_f32 v[176:177], v[142:143], v[172:173] op_sel_hi:[1,0]
    v_pk_mul_f32 v[178:179], v[144:145], v[172:173] op_sel_hi:[1,0]
    v_pk_mul_f32 v[180:181], v[146:147], v[172:173] op_sel_hi:[1,0]
    v_cvt_pk_bf16_f32 v124, v174, v175
    v_cvt_pk_bf16_f32 v125, v176, v177
    v_cvt_pk_bf16_f32 v126, v178, v179
    v_cvt_pk_bf16_f32 v127, v180, v181
    v_rcp_f32 v172, v164
    s_nop 0
    v_pk_mul_f32 v[174:175], v[156:157], v[172:173] op_sel_hi:[1,0]
    v_pk_mul_f32 v[176:177], v[158:159], v[172:173] op_sel_hi:[1,0]
    v_pk_mul_f32 v[178:179], v[160:161], v[172:173] op_sel_hi:[1,0]
    v_pk_mul_f32 v[180:181], v[162:163], v[172:173] op_sel_hi:[1,0]
    v_cvt_pk_bf16_f32 v132, v174, v175
    v_cvt_pk_bf16_f32 v133, v176, v177
    v_cvt_pk_bf16_f32 v134, v178, v179
    v_cvt_pk_bf16_f32 v135, v180, v181
    s_lshl_b32 s56, s44, 3
    s_lshl_b32 s57, s48, 1
    s_add_u32 s56, s56, s57
    s_lshl_b32 s56, s56, 5
    s_add_u32 s56, s56, s45
    s_lshl_b32 s56, s56, 10
    s_add_u32 s56, s56, s50
    s_add_u32 s56, s56, 6291456
    s_add_u32 s57, s56, 32768
    s_cmp_eq_u32 s52, 0
    s_cbranch_scc1 Lst_safe_12
    buffer_store_dwordx4 v[124:127], v24, s[4:7], s56 offen
    buffer_store_dwordx4 v[132:135], v24, s[4:7], s57 offen
    s_branch Lst_done_13
Lst_safe_12:
    buffer_store_dwordx4 v[124:127], v24, s[4:7], s56 offen sc1
    buffer_store_dwordx4 v[132:135], v24, s[4:7], s57 offen sc1
Lst_done_13:
    s_waitcnt vmcnt(0)
    s_barrier
L_ATT_DONE:
    s_cmp_lg_u32 s49, 0
    s_cbranch_scc1 LS3_af_14
    s_lshl_b32 s56, s51, 15
    s_add_u32 s56, s56, s54
    buffer_load_dwordx2 v[80:81], v8, s[8:11], s56 offen offset:0
    buffer_load_dwordx2 v[82:83], v8, s[8:11], s56 offen offset:16
    buffer_load_dwordx2 v[84:85], v8, s[8:11], s56 offen offset:32
    buffer_load_dwordx2 v[86:87], v8, s[8:11], s56 offen offset:48
    s_branch LS3_j_15
LS3_af_14:
    s_add_u32 s56, s51, s74
    s_mul_i32 s56, s56, 32
    s_lshl_b32 s63, s47, 2
    s_add_u32 s56, s56, s63
    s_lshl_b32 s63, s75, 1
    s_add_u32 s56, s56, s63
    s_lshl_b32 s56, s56, 10
    s_add_u32 s56, s56, s50
    s_add_u32 s56, s56, 14680064
    buffer_load_dwordx4 v[80:83], v7, s[4:7], s56 offen sc1
    buffer_load_dwordx4 v[84:87], v7, s[4:7], s56 offen offset:1024 sc1
LS3_j_15:
    s_add_u32 s98, s51, s74
    s_mul_i32 s98, s98, 32
    s_lshl_b32 s63, s47, 2
    s_add_u32 s98, s98, s63
    s_lshl_b32 s63, s75, 1
    s_add_u32 s98, s98, s63
    s_lshl_b32 s98, s98, 10
    s_add_u32 s98, s98, s50
    s_add_u32 s98, s98, 8388608
    s_add_u32 s99, s51, s74
    s_lshl_b32 s99, s99, 4
    s_lshl_b32 s57, s47, 1
    s_add_u32 s99, s99, s57
    s_add_u32 s99, s99, s75
    s_lshl_b32 s99, s99, 8
    s_add_u32 s99, s99, s50
    s_add_u32 s99, s99, 25165824
    ds_read_b128 v[128:131], v5 offset:0
    ds_read_b128 v[132:135], v5 offset:1024
    ds_read_b128 v[136:139], v5 offset:2048
    ds_read_b128 v[140:143], v5 offset:3072
    ds_read_b128 v[144:147], v5 offset:8192
    ds_read_b128 v[148:151], v5 offset:9216
    ds_read_b128 v[152:155], v5 offset:10240
    ds_read_b128 v[156:159], v5 offset:11264
    s_waitcnt lgkmcnt(4)
    ds_read_b128 v[160:163], v5 offset:16384
    ds_read_b128 v[164:167], v5 offset:17408
    ds_read_b128 v[168:171], v5 offset:18432
    ds_read_b128 v[172:175], v5 offset:19456
    ds_read_b128 v[176:179], v5 offset:24576
    ds_read_b128 v[180:183], v5 offset:25600
    ds_read_b128 v[184:187], v5 offset:26624
    ds_read_b128 v[188:191], v5 offset:27648
    s_waitcnt lgkmcnt(4)
    ds_read_b128 v[192:195], v5 offset:32768
    ds_read_b128 v[196:199], v5 offset:33792
    ds_read_b128 v[200:203], v5 offset:34816
    ds_read_b128 v[204:207], v5 offset:35840
    ds_read_b128 v[208:211], v5 offset:40960
    ds_read_b128 v[212:215], v5 offset:41984
    ds_read_b128 v[216:219], v5 offset:43008
    ds_read_b128 v[220:223], v5 offset:44032
    s_waitcnt lgkmcnt(4)
    ds_read_b128 v[224:227], v5 offset:49152
    ds_read_b128 v[228:231], v5 offset:50176
    ds_read_b128 v[232:235], v5 offset:51200
    ds_read_b128 v[236:239], v5 offset:52224
    ds_read_b128 v[240:243], v5 offset:57344
    ds_read_b128 v[244:247], v5 offset:58368
    ds_read_b128 v[248:251], v5 offset:59392
    ds_read_b128 v[252:255], v5 offset:60416
    s_waitcnt lgkmcnt(4)
    s_waitcnt vmcnt(0)
    v_lshlrev_b32 v16, 16, v80
    v_and_b32 v17, 0xffff0000, v80
    v_lshlrev_b32 v18, 16, v81
    v_and_b32 v19, 0xffff0000, v81
    v_lshlrev_b32 v20, 16, v82
    v_and_b32 v21, 0xffff0000, v82
    v_lshlrev_b32 v22, 16, v83
    v_and_b32 v23, 0xffff0000, v83
    v_lshlrev_b32 v24, 16, v84
    v_and_b32 v25, 0xffff0000, v84
    v_lshlrev_b32 v26, 16, v85
    v_and_b32 v27, 0xffff0000, v85
    v_lshlrev_b32 v28, 16, v86
    v_and_b32 v29, 0xffff0000, v86
    v_lshlrev_b32 v30, 16, v87
    v_and_b32 v31, 0xffff0000, v87
    s_waitcnt lgkmcnt(0)
    s_barrier
    ds_read_b128 v[48:51], v2 offset:0
    ds_read_b128 v[52:55], v2 offset:1040
    ds_read_b128 v[56:59], v2 offset:2080
    ds_read_b128 v[60:63], v2 offset:3120
    s_barrier
    s_waitcnt lgkmcnt(1)
    v_mfma_f32_32x32x16_bf16 v[16:31], v[128:131], v[48:51], v[16:31]
    ds_read_b128 v[64:67], v2 offset:4160
    v_mfma_f32_32x32x16_bf16 v[16:31], v[132:135], v[52:55], v[16:31]
    ds_read_b128 v[68:71], v2 offset:5200
    v_mfma_f32_32x32x16_bf16 v[16:31], v[136:139], v[56:59], v[16:31]
    ds_read_b128 v[72:75], v2 offset:6240
    s_waitcnt lgkmcnt(3)
    v_mfma_f32_32x32x16_bf16 v[16:31], v[140:143], v[60:63], v[16:31]
    ds_read_b128 v[76:79], v2 offset:7280
    s_barrier
    s_waitcnt lgkmcnt(1)
    v_mfma_f32_32x32x16_bf16 v[16:31], v[144:147], v[64:67], v[16:31]
    ds_read_b128 v[48:51], v2 offset:8320
    v_mfma_f32_32x32x16_bf16 v[16:31], v[148:151], v[68:71], v[16:31]
    ds_read_b128 v[52:55], v2 offset:9360
    v_mfma_f32_32x32x16_bf16 v[16:31], v[152:155], v[72:75], v[16:31]
    ds_read_b128 v[56:59], v2 offset:10400
    s_waitcnt lgkmcnt(3)
    v_mfma_f32_32x32x16_bf16 v[16:31], v[156:159], v[76:79], v[16:31]
    ds_read_b128 v[60:63], v2 offset:11440
    s_barrier
    s_waitcnt lgkmcnt(1)
    v_mfma_f32_32x32x16_bf16 v[16:31], v[160:163], v[48:51], v[16:31]
    ds_read_b128 v[64:67], v2 offset:12480
    v_mfma_f32_32x32x16_bf16 v[16:31], v[164:167], v[52:55], v[16:31]
    ds_read_b128 v[68:71], v2 offset:13520
    v_mfma_f32_32x32x16_bf16 v[16:31], v[168:171], v[56:59], v[16:31]
    ds_read_b128 v[72:75], v2 offset:14560
    s_waitcnt lgkmcnt(3)
    v_mfma_f32_32x32x16_bf16 v[16:31], v[172:175], v[60:63], v[16:31]
    ds_read_b128 v[76:79], v2 offset:15600
    s_barrier
    s_waitcnt lgkmcnt(1)
    v_mfma_f32_32x32x16_bf16 v[16:31], v[176:179], v[64:67], v[16:31]
    ds_read_b128 v[48:51], v2 offset:16640
    v_mfma_f32_32x32x16_bf16 v[16:31], v[180:183], v[68:71], v[16:31]
    ds_read_b128 v[52:55], v2 offset:17680
    v_mfma_f32_32x32x16_bf16 v[16:31], v[184:187], v[72:75], v[16:31]
    ds_read_b128 v[56:59], v2 offset:18720
    s_waitcnt lgkmcnt(3)
    v_mfma_f32_32x32x16_bf16 v[16:31], v[188:191], v[76:79], v[16:31]
    ds_read_b128 v[60:63], v2 offset:19760
    s_barrier
    s_waitcnt lgkmcnt(1)
    v_mfma_f32_32x32x16_bf16 v[16:31], v[192:195], v[48:51], v[16:31]
    ds_read_b128 v[64:67], v2 offset:20800
    v_mfma_f32_32x32x16_bf16 v[16:31], v[196:199], v[52:55], v[16:31]
    ds_read_b128 v[68:71], v2 offset:21840
    v_mfma_f32_32x32x16_bf16 v[16:31], v[200:203], v[56:59], v[16:31]
    ds_read_b128 v[72:75], v2 offset:22880
    s_waitcnt lgkmcnt(3)
    v_mfma_f32_32x32x16_bf16 v[16:31], v[204:207], v[60:63], v[16:31]
    ds_read_b128 v[76:79], v2 offset:23920
    s_barrier
    s_waitcnt lgkmcnt(1)
    v_mfma_f32_32x32x16_bf16 v[16:31], v[208:211], v[64:67], v[16:31]
    ds_read_b128 v[48:51], v2 offset:24960
    v_mfma_f32_32x32x16_bf16 v[16:31], v[212:215], v[68:71], v[16:31]
    ds_read_b128 v[52:55], v2 offset:26000
    v_mfma_f32_32x32x16_bf16 v[16:31], v[216:219], v[72:75], v[16:31]
    ds_read_b128 v[56:59], v2 offset:27040
    s_waitcnt lgkmcnt(3)
    v_mfma_f32_32x32x16_bf16 v[16:31], v[220:223], v[76:79], v[16:31]
    ds_read_b128 v[60:63], v2 offset:28080
    s_barrier
    s_waitcnt lgkmcnt(1)
    v_mfma_f32_32x32x16_bf16 v[16:31], v[224:227], v[48:51], v[16:31]
    ds_read_b128 v[64:67], v2 offset:29120
    v_mfma_f32_32x32x16_bf16 v[16:31], v[228:231], v[52:55], v[16:31]
    ds_read_b128 v[68:71], v2 offset:30160
    v_mfma_f32_32x32x16_bf16 v[16:31], v[232:235], v[56:59], v[16:31]
    ds_read_b128 v[72:75], v2 offset:31200
    s_waitcnt lgkmcnt(3)
    v_mfma_f32_32x32x16_bf16 v[16:31], v[236:239], v[60:63], v[16:31]
    ds_read_b128 v[76:79], v2 offset:32240
    s_waitcnt lgkmcnt(1)
    v_mfma_f32_32x32x16_bf16 v[16:31], v[240:243], v[64:67], v[16:31]
    v_mfma_f32_32x32x16_bf16 v[16:31], v[244:247], v[68:71], v[16:31]
    v_mfma_f32_32x32x16_bf16 v[16:31], v[248:251], v[72:75], v[16:31]
    s_waitcnt lgkmcnt(0)
    v_mfma_f32_32x32x16_bf16 v[16:31], v[252:255], v[76:79], v[16:31]
    s_nop 11
    v_cvt_pk_bf16_f32 v116, v16, v17
    v_cvt_pk_bf16_f32 v117, v18, v19
    v_cvt_pk_bf16_f32 v118, v20, v21
    v_cvt_pk_bf16_f32 v119, v22, v23
    v_cvt_pk_bf16_f32 v120, v24, v25
    v_cvt_pk_bf16_f32 v121, v26, v27
    v_cvt_pk_bf16_f32 v122, v28, v29
    v_cvt_pk_bf16_f32 v123, v30, v31
    s_cmp_eq_u32 s52, 0
    s_cbranch_scc1 Lst_safe_16
    buffer_store_dwordx4 v[116:119], v7, s[4:7], s98 offen
    buffer_store_dwordx4 v[120:123], v7, s[4:7], s98 offen offset:1024
    s_branch Lst_done_17
Lst_safe_16:
    buffer_store_dwordx4 v[116:119], v7, s[4:7], s98 offen sc1
    buffer_store_dwordx4 v[120:123], v7, s[4:7], s98 offen offset:1024 sc1
Lst_done_17:
    v_pk_add_f32 v[112:113], v[16:17], v[18:19]
    v_pk_mul_f32 v[114:115], v[16:17], v[16:17]
    v_pk_fma_f32 v[114:115], v[18:19], v[18:19], v[114:115]
    v_pk_add_f32 v[112:113], v[112:113], v[20:21]
    v_pk_fma_f32 v[114:115], v[20:21], v[20:21], v[114:115]
    v_pk_add_f32 v[112:113], v[112:113], v[22:23]
    v_pk_fma_f32 v[114:115], v[22:23], v[22:23], v[114:115]
    v_pk_add_f32 v[112:113], v[112:113], v[24:25]
    v_pk_fma_f32 v[114:115], v[24:25], v[24:25], v[114:115]
    v_pk_add_f32 v[112:113], v[112:113], v[26:27]
    v_pk_fma_f32 v[114:115], v[26:27], v[26:27], v[114:115]
    v_pk_add_f32 v[112:113], v[112:113], v[28:29]
    v_pk_fma_f32 v[114:115], v[28:29], v[28:29], v[114:115]
    v_pk_add_f32 v[112:113], v[112:113], v[30:31]
    v_pk_fma_f32 v[114:115], v[30:31], v[30:31], v[114:115]
    v_add_f32 v112, v112, v113
    v_add_f32 v113, v114, v115
    v_mov_b32 v114, v112
    v_mov_b32 v115, v113
    s_nop 0
    v_permlane32_swap_b32 v112, v114
    v_permlane32_swap_b32 v113, v115
    v_add_f32 v112, v112, v114
    v_add_f32 v113, v113, v115
    s_cmp_eq_u32 s52, 0
    s_cbranch_scc1 Lst_safe_18
    buffer_store_dwordx2 v[112:113], v9, s[4:7], s99 offen
    s_branch Lst_done_19
Lst_safe_18:
    buffer_store_dwordx2 v[112:113], v9, s[4:7], s99 offen sc1
Lst_done_19:
    s_waitcnt vmcnt(0)
    s_barrier
    s_mul_i32 s100, s47, 64
    s_mul_i32 s63, s75, 32
    s_add_u32 s100, s100, s63
    s_lshl_b32 s62, s100, 2
    s_add_u32 s62, s62, 71680
    buffer_load_dwordx4 v[80:83], v10, s[4:7], s62 offen offset:0 sc1
    buffer_load_dwordx4 v[84:87], v10, s[4:7], s62 offen offset:32 sc1
    buffer_load_dwordx4 v[88:91], v10, s[4:7], s62 offen offset:64 sc1
    buffer_load_dwordx4 v[92:95], v10, s[4:7], s62 offen offset:96 sc1
    s_add_u32 s98, s51, s74
    s_mul_i32 s98, s98, 32
    s_lshl_b32 s63, s47, 2
    s_add_u32 s98, s98, s63
    s_lshl_b32 s63, s75, 1
    s_add_u32 s98, s98, s63
    s_lshl_b32 s98, s98, 10
    s_add_u32 s98, s98, s50
    s_add_u32 s98, s98, 10485760
    s_mul_i32 s56, s49, 24117248
    s_add_u32 s98, s98, s56
    s_lshl_b32 s56, s46, 1
    s_add_u32 s56, s56, s74
    s_mov_b32 s99, s52
    s_cmp_eq_u32 s56, 0
    s_cselect_b32 s99, 0, s99
    s_cmp_eq_u32 s56, 7
    s_cselect_b32 s99, 0, s99
    ds_read_b128 v[128:131], v6 offset:0
    ds_read_b128 v[132:135], v6 offset:1024
    ds_read_b128 v[136:139], v6 offset:2048
    ds_read_b128 v[140:143], v6 offset:3072
    ds_read_b128 v[144:147], v6 offset:8192
    ds_read_b128 v[148:151], v6 offset:9216
    ds_read_b128 v[152:155], v6 offset:10240
    ds_read_b128 v[156:159], v6 offset:11264
    s_waitcnt lgkmcnt(4)
    ds_read_b128 v[160:163], v6 offset:16384
    ds_read_b128 v[164:167], v6 offset:17408
    ds_read_b128 v[168:171], v6 offset:18432
    ds_read_b128 v[172:175], v6 offset:19456
    ds_read_b128 v[176:179], v5 offset:0
    ds_read_b128 v[180:183], v5 offset:1024
    ds_read_b128 v[184:187], v5 offset:2048
    ds_read_b128 v[188:191], v5 offset:3072
    s_waitcnt lgkmcnt(4)
    ds_read_b128 v[192:195], v5 offset:8192
    ds_read_b128 v[196:199], v5 offset:9216
    ds_read_b128 v[200:203], v5 offset:10240
    ds_read_b128 v[204:207], v5 offset:11264
    ds_read_b128 v[208:211], v5 offset:16384
    ds_read_b128 v[212:215], v5 offset:17408
    ds_read_b128 v[216:219], v5 offset:18432
    ds_read_b128 v[220:223], v5 offset:19456
    s_waitcnt lgkmcnt(4)
    ds_read_b128 v[224:227], v5 offset:24576
    ds_read_b128 v[228:231], v5 offset:25600
    ds_read_b128 v[232:235], v5 offset:26624
    ds_read_b128 v[236:239], v5 offset:27648
    ds_read_b128 v[240:243], v5 offset:32768
    ds_read_b128 v[244:247], v5 offset:33792
    ds_read_b128 v[248:251], v5 offset:34816
    ds_read_b128 v[252:255], v5 offset:35840
    s_waitcnt lgkmcnt(4)
    s_waitcnt lgkmcnt(0)
    s_barrier
    ds_read_b128 v[48:51], v2 offset:0
    ds_read_b128 v[52:55], v2 offset:1040
    ds_read_b128 v[56:59], v2 offset:2080
    ds_read_b128 v[60:63], v2 offset:3120
    s_barrier
    s_waitcnt lgkmcnt(1)
    v_mfma_f32_32x32x16_bf16 v[16:31], v[128:131], v[48:51], 0
    ds_read_b128 v[64:67], v2 offset:4160
    v_mfma_f32_32x32x16_bf16 v[16:31], v[132:135], v[52:55], v[16:31]
    ds_read_b128 v[68:71], v2 offset:5200
    v_mfma_f32_32x32x16_bf16 v[16:31], v[136:139], v[56:59], v[16:31]
    ds_read_b128 v[72:75], v2 offset:6240
    s_waitcnt lgkmcnt(3)
    v_mfma_f32_32x32x16_bf16 v[16:31], v[140:143], v[60:63], v[16:31]
    ds_read_b128 v[76:79], v2 offset:7280
    s_barrier
    s_waitcnt lgkmcnt(1)
    v_mfma_f32_32x32x16_bf16 v[16:31], v[144:147], v[64:67], v[16:31]
    ds_read_b128 v[48:51], v2 offset:8320
    v_mfma_f32_32x32x16_bf16 v[16:31], v[148:151], v[68:71], v[16:31]
    ds_read_b128 v[52:55], v2 offset:9360
    v_mfma_f32_32x32x16_bf16 v[16:31], v[152:155], v[72:75], v[16:31]
    ds_read_b128 v[56:59], v2 offset:10400
    s_waitcnt lgkmcnt(3)
    v_mfma_f32_32x32x16_bf16 v[16:31], v[156:159], v[76:79], v[16:31]
    ds_read_b128 v[60:63], v2 offset:11440
    s_barrier
    s_waitcnt lgkmcnt(1)
    v_mfma_f32_32x32x16_bf16 v[16:31], v[160:163], v[48:51], v[16:31]
    ds_read_b128 v[64:67], v2 offset:12480
    v_mfma_f32_32x32x16_bf16 v[16:31], v[164:167], v[52:55], v[16:31]
    ds_read_b128 v[68:71], v2 offset:13520
    v_mfma_f32_32x32x16_bf16 v[16:31], v[168:171], v[56:59], v[16:31]
    ds_read_b128 v[72:75], v2 offset:14560
    s_waitcnt lgkmcnt(3)
    v_mfma_f32_32x32x16_bf16 v[16:31], v[172:175], v[60:63], v[16:31]
    ds_read_b128 v[76:79], v2 offset:15600
    s_barrier
    s_waitcnt lgkmcnt(1)
    v_mfma_f32_32x32x16_bf16 v[16:31], v[176:179], v[64:67], v[16:31]
    ds_read_b128 v[48:51], v2 offset:16640
    v_mfma_f32_32x32x16_bf16 v[16:31], v[180:183], v[68:71], v[16:31]
    ds_read_b128 v[52:55], v2 offset:17680
    v_mfma_f32_32x32x16_bf16 v[16:31], v[184:187], v[72:75], v[16:31]
    ds_read_b128 v[56:59], v2 offset:18720
    s_waitcnt lgkmcnt(3)
    v_mfma_f32_32x32x16_bf16 v[16:31], v[188:191], v[76:79], v[16:31]
    ds_read_b128 v[60:63], v2 offset:19760
    s_barrier
    s_waitcnt lgkmcnt(1)
    v_mfma_f32_32x32x16_bf16 v[16:31], v[192:195], v[48:51], v[16:31]
    ds_read_b128 v[64:67], v2 offset:20800
    v_mfma_f32_32x32x16_bf16 v[16:31], v[196:199], v[52:55], v[16:31]
    ds_read_b128 v[68:71], v2 offset:21840
    v_mfma_f32_32x32x16_bf16 v[16:31], v[200:203], v[56:59], v[16:31]
    ds_read_b128 v[72:75], v2 offset:22880
    s_waitcnt lgkmcnt(3)
    v_mfma_f32_32x32x16_bf16 v[16:31], v[204:207], v[60:63], v[16:31]
    ds_read_b128 v[76:79], v2 offset:23920
    s_barrier
    s_waitcnt lgkmcnt(1)
    v_mfma_f32_32x32x16_bf16 v[16:31], v[208:211], v[64:67], v[16:31]
    ds_read_b128 v[48:51], v2 offset:24960
    v_mfma_f32_32x32x16_bf16 v[16:31], v[212:215], v[68:71], v[16:31]
    ds_read_b128 v[52:55], v2 offset:26000
    v_mfma_f32_32x32x16_bf16 v[16:31], v[216:219], v[72:75], v[16:31]
    ds_read_b128 v[56:59], v2 offset:27040
    s_waitcnt lgkmcnt(3)
    v_mfma_f32_32x32x16_bf16 v[16:31], v[220:223], v[76:79], v[16:31]
    ds_read_b128 v[60:63], v2 offset:28080
    s_barrier
    ds_read_b32 v126, v12 offset:0
    ds_read_b32 v127, v12 offset:512
    s_waitcnt lgkmcnt(3)
    v_mfma_f32_32x32x16_bf16 v[16:31], v[224:227], v[48:51], v[16:31]
    ds_read_b128 v[64:67], v2 offset:29120
    v_mfma_f32_32x32x16_bf16 v[16:31], v[228:231], v[52:55], v[16:31]
    ds_read_b128 v[68:71], v2 offset:30160
    v_mfma_f32_32x32x16_bf16 v[16:31], v[232:235], v[56:59], v[16:31]
    ds_read_b128 v[72:75], v2 offset:31200
    s_waitcnt lgkmcnt(5)
    v_mfma_f32_32x32x16_bf16 v[16:31], v[236:239], v[60:63], v[16:31]
    ds_read_b128 v[76:79], v2 offset:32240
    s_waitcnt lgkmcnt(1)
    v_mfma_f32_32x32x16_bf16 v[16:31], v[240:243], v[64:67], v[16:31]
    v_mfma_f32_32x32x16_bf16 v[16:31], v[244:247], v[68:71], v[16:31]
    v_mfma_f32_32x32x16_bf16 v[16:31], v[248:251], v[72:75], v[16:31]
    s_waitcnt lgkmcnt(0)
    v_mfma_f32_32x32x16_bf16 v[16:31], v[252:255], v[76:79], v[16:31]
    v_mul_f32 v124, 0x40135761, v127
    v_mul_f32 v125, v127, v127
    v_rcp_f32 v122, v127
    v_mul_f32 v125, v125, v127
    v_mul_f32 v125, 0x3dd2d3e8, v125
    s_waitcnt vmcnt(0)
    s_nop 5
    v_pk_fma_f32 v[96:97], v[80:81], v[126:127], v[16:17] op_sel_hi:[1,0,1]
    v_pk_fma_f32 v[98:99], v[82:83], v[126:127], v[18:19] op_sel_hi:[1,0,1]
    v_pk_fma_f32 v[100:101], v[84:85], v[126:127], v[20:21] op_sel_hi:[1,0,1]
    v_pk_fma_f32 v[102:103], v[86:87], v[126:127], v[22:23] op_sel_hi:[1,0,1]
    v_pk_fma_f32 v[104:105], v[88:89], v[126:127], v[24:25] op_sel_hi:[1,0,1]
    v_pk_fma_f32 v[106:107], v[90:91], v[126:127], v[26:27] op_sel_hi:[1,0,1]
    v_pk_fma_f32 v[108:109], v[92:93], v[126:127], v[28:29] op_sel_hi:[1,0,1]
    v_pk_fma_f32 v[110:111], v[94:95], v[126:127], v[30:31] op_sel_hi:[1,0,1]
    v_pk_mul_f32 v[112:113], v[96:97], v[96:97]
    v_pk_mul_f32 v[116:117], v[98:99], v[98:99]
    v_pk_fma_f32 v[112:113], v[112:113], v[124:125], v[124:125] op_sel:[0,1,0] op_sel_hi:[1,1,0]
    v_pk_fma_f32 v[116:117], v[116:117], v[124:125], v[124:125] op_sel:[0,1,0] op_sel_hi:[1,1,0]
    v_pk_mul_f32 v[112:113], v[112:113], v[96:97]
    v_pk_mul_f32 v[116:117], v[116:117], v[98:99]
    v_exp_f32 v114, -v112
    v_exp_f32 v118, -v116
    v_exp_f32 v115, -v113
    v_exp_f32 v119, -v117
    v_pk_fma_f32 v[114:115], v[114:115], v[122:123], v[122:123] op_sel_hi:[1,0,0]
    v_pk_fma_f32 v[118:119], v[118:119], v[122:123], v[122:123] op_sel_hi:[1,0,0]
    v_rcp_f32 v114, v114
    v_rcp_f32 v118, v118
    v_rcp_f32 v115, v115
    v_rcp_f32 v119, v119
    v_pk_mul_f32 v[96:97], v[96:97], v[114:115]
    v_pk_mul_f32 v[98:99], v[98:99], v[118:119]
    v_cvt_pk_bf16_f32 v96, v96, v97
    v_cvt_pk_bf16_f32 v97, v98, v99
    v_pk_mul_f32 v[112:113], v[100:101], v[100:101]
    v_pk_mul_f32 v[116:117], v[102:103], v[102:103]
    v_pk_fma_f32 v[112:113], v[112:113], v[124:125], v[124:125] op_sel:[0,1,0] op_sel_hi:[1,1,0]
    v_pk_fma_f32 v[116:117], v[116:117], v[124:125], v[124:125] op_sel:[0,1,0] op_sel_hi:[1,1,0]
    v_pk_mul_f32 v[112:113], v[112:113], v[100:101]
    v_pk_mul_f32 v[116:117], v[116:117], v[102:103]
    v_exp_f32 v114, -v112
    v_exp_f32 v118, -v116
    v_exp_f32 v115, -v113
    v_exp_f32 v119, -v117
    v_pk_fma_f32 v[114:115], v[114:115], v[122:123], v[122:123] op_sel_hi:[1,0,0]
    v_pk_fma_f32 v[118:119], v[118:119], v[122:123], v[122:123] op_sel_hi:[1,0,0]
    v_rcp_f32 v114, v114
    v_rcp_f32 v118, v118
    v_rcp_f32 v115, v115
    v_rcp_f32 v119, v119
    v_pk_mul_f32 v[100:101], v[100:101], v[114:115]
    v_pk_mul_f32 v[102:103], v[102:103], v[118:119]
    v_cvt_pk_bf16_f32 v98, v100, v101
    v_cvt_pk_bf16_f32 v99, v102, v103
    v_pk_mul_f32 v[112:113], v[104:105], v[104:105]
    v_pk_mul_f32 v[116:117], v[106:107], v[106:107]
    v_pk_fma_f32 v[112:113], v[112:113], v[124:125], v[124:125] op_sel:[0,1,0] op_sel_hi:[1,1,0]
    v_pk_fma_f32 v[116:117], v[116:117], v[124:125], v[124:125] op_sel:[0,1,0] op_sel_hi:[1,1,0]
    v_pk_mul_f32 v[112:113], v[112:113], v[104:105]
    v_pk_mul_f32 v[116:117], v[116:117], v[106:107]
    v_exp_f32 v114, -v112
    v_exp_f32 v118, -v116
    v_exp_f32 v115, -v113
    v_exp_f32 v119, -v117
    v_pk_fma_f32 v[114:115], v[114:115], v[122:123], v[122:123] op_sel_hi:[1,0,0]
    v_pk_fma_f32 v[118:119], v[118:119], v[122:123], v[122:123] op_sel_hi:[1,0,0]
    v_rcp_f32 v114, v114
    v_rcp_f32 v118, v118
    v_rcp_f32 v115, v115
    v_rcp_f32 v119, v119
    v_pk_mul_f32 v[104:105], v[104:105], v[114:115]
    v_pk_mul_f32 v[106:107], v[106:107], v[118:119]
    v_cvt_pk_bf16_f32 v100, v104, v105
    v_cvt_pk_bf16_f32 v101, v106, v107
    v_pk_mul_f32 v[112:113], v[108:109], v[108:109]
    v_pk_mul_f32 v[116:117], v[110:111], v[110:111]
    v_pk_fma_f32 v[112:113], v[112:113], v[124:125], v[124:125] op_sel:[0,1,0] op_sel_hi:[1,1,0]
    v_pk_fma_f32 v[116:117], v[116:117], v[124:125], v[124:125] op_sel:[0,1,0] op_sel_hi:[1,1,0]
    v_pk_mul_f32 v[112:113], v[112:113], v[108:109]
    v_pk_mul_f32 v[116:117], v[116:117], v[110:111]
    v_exp_f32 v114, -v112
    v_exp_f32 v118, -v116
    v_exp_f32 v115, -v113
    v_exp_f32 v119, -v117
    v_pk_fma_f32 v[114:115], v[114:115], v[122:123], v[122:123] op_sel_hi:[1,0,0]
    v_pk_fma_f32 v[118:119], v[118:119], v[122:123], v[122:123] op_sel_hi:[1,0,0]
    v_rcp_f32 v114, v114
    v_rcp_f32 v118, v118
    v_rcp_f32 v115, v115
    v_rcp_f32 v119, v119
    v_pk_mul_f32 v[108:109], v[108:109], v[114:115]
    v_pk_mul_f32 v[110:111], v[110:111], v[118:119]
    v_cvt_pk_bf16_f32 v102, v108, v109
    v_cvt_pk_bf16_f32 v103, v110, v111
    s_cmp_eq_u32 s99, 0
    s_cbranch_scc1 Lst_safe_20
    buffer_store_dwordx4 v[96:99], v7, s[4:7], s98 offen
    buffer_store_dwordx4 v[100:103], v7, s[4:7], s98 offen offset:1024
    s_branch Lst_done_21
Lst_safe_20:
    buffer_store_dwordx4 v[96:99], v7, s[4:7], s98 offen sc1
    buffer_store_dwordx4 v[100:103], v7, s[4:7], s98 offen offset:1024 sc1
Lst_done_21:
    s_waitcnt vmcnt(0)
    s_barrier
    s_add_u32 s56, s51, s74
    s_mul_i32 s56, s56, 32
    s_lshl_b32 s63, s47, 2
    s_add_u32 s56, s56, s63
    s_lshl_b32 s63, s75, 1
    s_add_u32 s56, s56, s63
    s_lshl_b32 s56, s56, 10
    s_add_u32 s56, s56, s50
    s_add_u32 s56, s56, 8388608
    buffer_load_dwordx4 v[80:83], v7, s[4:7], s56 offen sc1
    buffer_load_dwordx4 v[84:87], v7, s[4:7], s56 offen offset:1024 sc1
    ds_read_b32 v126, v12 offset:0
    ds_read_b32 v127, v12 offset:256
    s_add_u32 s98, s51, s74
    s_mul_i32 s98, s98, 32
    s_lshl_b32 s63, s47, 2
    s_add_u32 s98, s98, s63
    s_lshl_b32 s63, s75, 1
    s_add_u32 s98, s98, s63
    s_lshl_b32 s98, s98, 10
    s_add_u32 s98, s98, s50
    s_add_u32 s98, s98, 12582912
    s_add_u32 s99, s51, s74
    s_lshl_b32 s99, s99, 4
    s_lshl_b32 s57, s47, 1
    s_add_u32 s99, s99, s57
    s_add_u32 s99, s99, s75
    s_lshl_b32 s99, s99, 8
    s_add_u32 s99, s99, s50
    s_add_u32 s99, s99, 25427968
    ds_read_b128 v[128:131], v5 offset:40960
    ds_read_b128 v[132:135], v5 offset:41984
    ds_read_b128 v[136:139], v5 offset:43008
    ds_read_b128 v[140:143], v5 offset:44032
    ds_read_b128 v[144:147], v5 offset:49152
    ds_read_b128 v[148:151], v5 offset:50176
    ds_read_b128 v[152:155], v5 offset:51200
    ds_read_b128 v[156:159], v5 offset:52224
    s_waitcnt lgkmcnt(4)
    ds_read_b128 v[160:163], v5 offset:57344
    ds_read_b128 v[164:167], v5 offset:58368
    ds_read_b128 v[168:171], v5 offset:59392
    ds_read_b128 v[172:175], v5 offset:60416
    ds_read_b128 v[176:179], v6 offset:0
    ds_read_b128 v[180:183], v6 offset:1024
    ds_read_b128 v[184:187], v6 offset:2048
    ds_read_b128 v[188:191], v6 offset:3072
    s_waitcnt lgkmcnt(4)
    ds_read_b128 v[192:195], v6 offset:8192
    ds_read_b128 v[196:199], v6 offset:9216
    ds_read_b128 v[200:203], v6 offset:10240
    ds_read_b128 v[204:207], v6 offset:11264
    ds_read_b128 v[208:211], v6 offset:16384
    ds_read_b128 v[212:215], v6 offset:17408
    ds_read_b128 v[216:219], v6 offset:18432
    ds_read_b128 v[220:223], v6 offset:19456
    s_waitcnt lgkmcnt(4)
    ds_read_b128 v[224:227], v5 offset:0
    ds_read_b128 v[228:231], v5 offset:1024
    ds_read_b128 v[232:235], v5 offset:2048
    ds_read_b128 v[236:239], v5 offset:3072
    ds_read_b128 v[240:243], v5 offset:8192
    ds_read_b128 v[244:247], v5 offset:9216
    ds_read_b128 v[248:251], v5 offset:10240
    ds_read_b128 v[252:255], v5 offset:11264
    s_waitcnt lgkmcnt(4)
    s_waitcnt vmcnt(0) lgkmcnt(0)
    v_lshlrev_b32 v16, 16, v80
    v_and_b32 v17, 0xffff0000, v80
    v_lshlrev_b32 v18, 16, v81
    v_and_b32 v19, 0xffff0000, v81
    v_lshlrev_b32 v20, 16, v82
    v_and_b32 v21, 0xffff0000, v82
    v_lshlrev_b32 v22, 16, v83
    v_and_b32 v23, 0xffff0000, v83
    v_lshlrev_b32 v24, 16, v84
    v_and_b32 v25, 0xffff0000, v84
    v_lshlrev_b32 v26, 16, v85
    v_and_b32 v27, 0xffff0000, v85
    v_lshlrev_b32 v28, 16, v86
    v_and_b32 v29, 0xffff0000, v86
    v_lshlrev_b32 v30, 16, v87
    v_and_b32 v31, 0xffff0000, v87
    v_pk_add_f32 v[16:17], v[16:17], v[126:127] op_sel_hi:[1,0]
    v_pk_add_f32 v[18:19], v[18:19], v[126:127] op_sel_hi:[1,0]
    v_pk_add_f32 v[20:21], v[20:21], v[126:127] op_sel_hi:[1,0]
    v_pk_add_f32 v[22:23], v[22:23], v[126:127] op_sel_hi:[1,0]
    v_pk_add_f32 v[24:25], v[24:25], v[126:127] op_sel_hi:[1,0]
    v_pk_add_f32 v[26:27], v[26:27], v[126:127] op_sel_hi:[1,0]
    v_pk_add_f32 v[28:29], v[28:29], v[126:127] op_sel_hi:[1,0]
    v_pk_add_f32 v[30:31], v[30:31], v[126:127] op_sel_hi:[1,0]
    v_pk_mul_f32 v[16:17], v[16:17], v[126:127] op_sel:[0,1] op_sel_hi:[1,1]
    v_pk_mul_f32 v[18:19], v[18:19], v[126:127] op_sel:[0,1] op_sel_hi:[1,1]
    v_pk_mul_f32 v[20:21], v[20:21], v[126:127] op_sel:[0,1] op_sel_hi:[1,1]
    v_pk_mul_f32 v[22:23], v[22:23], v[126:127] op_sel:[0,1] op_sel_hi:[1,1]
    v_pk_mul_f32 v[24:25], v[24:25], v[126:127] op_sel:[0,1] op_sel_hi:[1,1]
    v_pk_mul_f32 v[26:27], v[26:27], v[126:127] op_sel:[0,1] op_sel_hi:[1,1]
    v_pk_mul_f32 v[28:29], v[28:29], v[126:127] op_sel:[0,1] op_sel_hi:[1,1]
    v_pk_mul_f32 v[30:31], v[30:31], v[126:127] op_sel:[0,1] op_sel_hi:[1,1]
    s_waitcnt lgkmcnt(0)
    s_barrier
    ds_read_b128 v[48:51], v2 offset:0
    ds_read_b128 v[52:55], v2 offset:1040
    ds_read_b128 v[56:59], v2 offset:2080
    ds_read_b128 v[60:63], v2 offset:3120
    s_barrier
    s_waitcnt lgkmcnt(1)
    v_mfma_f32_32x32x16_bf16 v[16:31], v[128:131], v[48:51], v[16:31]
    ds_read_b128 v[64:67], v2 offset:4160
    v_mfma_f32_32x32x16_bf16 v[16:31], v[132:135], v[52:55], v[16:31]
    ds_read_b128 v[68:71], v2 offset:5200
    v_mfma_f32_32x32x16_bf16 v[16:31], v[136:139], v[56:59], v[16:31]
    ds_read_b128 v[72:75], v2 offset:6240
    s_waitcnt lgkmcnt(3)
    v_mfma_f32_32x32x16_bf16 v[16:31], v[140:143], v[60:63], v[16:31]
    ds_read_b128 v[76:79], v2 offset:7280
    s_barrier
    s_waitcnt lgkmcnt(1)
    v_mfma_f32_32x32x16_bf16 v[16:31], v[144:147], v[64:67], v[16:31]
    ds_read_b128 v[48:51], v2 offset:8320
    v_mfma_f32_32x32x16_bf16 v[16:31], v[148:151], v[68:71], v[16:31]
    ds_read_b128 v[52:55], v2 offset:9360
    v_mfma_f32_32x32x16_bf16 v[16:31], v[152:155], v[72:75], v[16:31]
    ds_read_b128 v[56:59], v2 offset:10400
    s_waitcnt lgkmcnt(3)
    v_mfma_f32_32x32x16_bf16 v[16:31], v[156:159], v[76:79], v[16:31]
    ds_read_b128 v[60:63], v2 offset:11440
    s_barrier
    s_waitcnt lgkmcnt(1)
    v_mfma_f32_32x32x16_bf16 v[16:31], v[160:163], v[48:51], v[16:31]
    ds_read_b128 v[64:67], v2 offset:12480
    v_mfma_f32_32x32x16_bf16 v[16:31], v[164:167], v[52:55], v[16:31]
    ds_read_b128 v[68:71], v2 offset:13520
    v_mfma_f32_32x32x16_bf16 v[16:31], v[168:171], v[56:59], v[16:31]
    ds_read_b128 v[72:75], v2 offset:14560
    s_waitcnt lgkmcnt(3)
    v_mfma_f32_32x32x16_bf16 v[16:31], v[172:175], v[60:63], v[16:31]
    ds_read_b128 v[76:79], v2 offset:15600
    s_barrier
    s_waitcnt lgkmcnt(1)
    v_mfma_f32_32x32x16_bf16 v[16:31], v[176:179], v[64:67], v[16:31]
    ds_read_b128 v[48:51], v2 offset:16640
    v_mfma_f32_32x32x16_bf16 v[16:31], v[180:183], v[68:71], v[16:31]
    ds_read_b128 v[52:55], v2 offset:17680
    v_mfma_f32_32x32x16_bf16 v[16:31], v[184:187], v[72:75], v[16:31]
    ds_read_b128 v[56:59], v2 offset:18720
    s_waitcnt lgkmcnt(3)
    v_mfma_f32_32x32x16_bf16 v[16:31], v[188:191], v[76:79], v[16:31]
    ds_read_b128 v[60:63], v2 offset:19760
    s_barrier
    s_waitcnt lgkmcnt(1)
    v_mfma_f32_32x32x16_bf16 v[16:31], v[192:195], v[48:51], v[16:31]
    ds_read_b128 v[64:67], v2 offset:20800
    v_mfma_f32_32x32x16_bf16 v[16:31], v[196:199], v[52:55], v[16:31]
    ds_read_b128 v[68:71], v2 offset:21840
    v_mfma_f32_32x32x16_bf16 v[16:31], v[200:203], v[56:59], v[16:31]
    ds_read_b128 v[72:75], v2 offset:22880
    s_waitcnt lgkmcnt(3)
    v_mfma_f32_32x32x16_bf16 v[16:31], v[204:207], v[60:63], v[16:31]
    ds_read_b128 v[76:79], v2 offset:23920
    s_barrier
    s_waitcnt lgkmcnt(1)
    v_mfma_f32_32x32x16_bf16 v[16:31], v[208:211], v[64:67], v[16:31]
    ds_read_b128 v[48:51], v2 offset:24960
    v_mfma_f32_32x32x16_bf16 v[16:31], v[212:215], v[68:71], v[16:31]
    ds_read_b128 v[52:55], v2 offset:26000
    v_mfma_f32_32x32x16_bf16 v[16:31], v[216:219], v[72:75], v[16:31]
    ds_read_b128 v[56:59], v2 offset:27040
    s_waitcnt lgkmcnt(3)
    v_mfma_f32_32x32x16_bf16 v[16:31], v[220:223], v[76:79], v[16:31]
    ds_read_b128 v[60:63], v2 offset:28080
    s_barrier
    s_waitcnt lgkmcnt(1)
    v_mfma_f32_32x32x16_bf16 v[16:31], v[224:227], v[48:51], v[16:31]
    ds_read_b128 v[64:67], v2 offset:29120
    v_mfma_f32_32x32x16_bf16 v[16:31], v[228:231], v[52:55], v[16:31]
    ds_read_b128 v[68:71], v2 offset:30160
    v_mfma_f32_32x32x16_bf16 v[16:31], v[232:235], v[56:59], v[16:31]
    ds_read_b128 v[72:75], v2 offset:31200
    s_waitcnt lgkmcnt(3)
    v_mfma_f32_32x32x16_bf16 v[16:31], v[236:239], v[60:63], v[16:31]
    ds_read_b128 v[76:79], v2 offset:32240
    s_waitcnt lgkmcnt(1)
    v_mfma_f32_32x32x16_bf16 v[16:31], v[240:243], v[64:67], v[16:31]
    v_mfma_f32_32x32x16_bf16 v[16:31], v[244:247], v[68:71], v[16:31]
    v_mfma_f32_32x32x16_bf16 v[16:31], v[248:251], v[72:75], v[16:31]
    s_waitcnt lgkmcnt(0)
    v_mfma_f32_32x32x16_bf16 v[16:31], v[252:255], v[76:79], v[16:31]
    s_nop 11
    v_cvt_pk_bf16_f32 v116, v16, v17
    v_cvt_pk_bf16_f32 v117, v18, v19
    v_cvt_pk_bf16_f32 v118, v20, v21
    v_cvt_pk_bf16_f32 v119, v22, v23
    v_cvt_pk_bf16_f32 v120, v24, v25
    v_cvt_pk_bf16_f32 v121, v26, v27
    v_cvt_pk_bf16_f32 v122, v28, v29
    v_cvt_pk_bf16_f32 v123, v30, v31
    s_cmp_eq_u32 s52, 0
    s_cbranch_scc1 Lst_safe_22
    buffer_store_dwordx4 v[116:119], v7, s[4:7], s98 offen
    buffer_store_dwordx4 v[120:123], v7, s[4:7], s98 offen offset:1024
    s_branch Lst_done_23
Lst_safe_22:
    buffer_store_dwordx4 v[116:119], v7, s[4:7], s98 offen sc1
    buffer_store_dwordx4 v[120:123], v7, s[4:7], s98 offen offset:1024 sc1
Lst_done_23:
    v_pk_add_f32 v[112:113], v[16:17], v[18:19]
    v_pk_mul_f32 v[114:115], v[16:17], v[16:17]
    v_pk_fma_f32 v[114:115], v[18:19], v[18:19], v[114:115]
    v_pk_add_f32 v[112:113], v[112:113], v[20:21]
    v_pk_fma_f32 v[114:115], v[20:21], v[20:21], v[114:115]
    v_pk_add_f32 v[112:113], v[112:113], v[22:23]
    v_pk_fma_f32 v[114:115], v[22:23], v[22:23], v[114:115]
    v_pk_add_f32 v[112:113], v[112:113], v[24:25]
    v_pk_fma_f32 v[114:115], v[24:25], v[24:25], v[114:115]
    v_pk_add_f32 v[112:113], v[112:113], v[26:27]
    v_pk_fma_f32 v[114:115], v[26:27], v[26:27], v[114:115]
    v_pk_add_f32 v[112:113], v[112:113], v[28:29]
    v_pk_fma_f32 v[114:115], v[28:29], v[28:29], v[114:115]
    v_pk_add_f32 v[112:113], v[112:113], v[30:31]
    v_pk_fma_f32 v[114:115], v[30:31], v[30:31], v[114:115]
    v_add_f32 v112, v112, v113
    v_add_f32 v113, v114, v115
    v_mov_b32 v114, v112
    v_mov_b32 v115, v113
    s_nop 0
    v_permlane32_swap_b32 v112, v114
    v_permlane32_swap_b32 v113, v115
    v_add_f32 v112, v112, v114
    v_add_f32 v113, v113, v115
    s_cmp_eq_u32 s52, 0
    s_cbranch_scc1 Lst_safe_24
    buffer_store_dwordx2 v[112:113], v9, s[4:7], s99 offen
    s_branch Lst_done_25
Lst_safe_24:
    buffer_store_dwordx2 v[112:113], v9, s[4:7], s99 offen sc1
Lst_done_25:
    s_waitcnt vmcnt(0)
    s_barrier
    s_mul_i32 s100, s47, 224
    s_mul_i32 s63, s75, 32
    s_add_u32 s100, s100, s63
    s_mul_i32 s79, s47, 224
    s_lshl_b32 s62, s100, 2
    s_add_u32 s62, s62, 73728
    buffer_load_dwordx4 v[80:83], v10, s[4:7], s62 offen offset:0 sc1
    buffer_load_dwordx4 v[84:87], v10, s[4:7], s62 offen offset:32 sc1
    buffer_load_dwordx4 v[88:91], v10, s[4:7], s62 offen offset:64 sc1
    buffer_load_dwordx4 v[92:95], v10, s[4:7], s62 offen offset:96 sc1
    s_add_u32 s98, s51, s74
    s_mul_i32 s98, s98, 112
    s_mul_i32 s56, s47, 14
    s_add_u32 s98, s98, s56
    s_lshl_b32 s56, s75, 1
    s_add_u32 s98, s98, s56
    s_lshl_b32 s98, s98, 10
    s_add_u32 s98, s98, s50
    s_add_u32 s98, s98, 16777216
    s_barrier
    ds_read_b128 v[48:51], v5 offset:16384
    ds_read_b128 v[128:131], v2 offset:0
    ds_read_b128 v[52:55], v5 offset:17408
    ds_read_b128 v[132:135], v2 offset:1040
    ds_read_b128 v[56:59], v5 offset:18432
    ds_read_b128 v[136:139], v2 offset:2080
    ds_read_b128 v[60:63], v5 offset:19456
    ds_read_b128 v[140:143], v2 offset:3120
    s_barrier
    s_waitcnt lgkmcnt(2)
    v_mfma_f32_32x32x16_bf16 v[16:31], v[48:51], v[128:131], 0
    ds_read_b128 v[64:67], v5 offset:24576
    ds_read_b128 v[144:147], v2 offset:4160
    v_mfma_f32_32x32x16_bf16 v[16:31], v[52:55], v[132:135], v[16:31]
    ds_read_b128 v[68:71], v5 offset:25600
    ds_read_b128 v[148:151], v2 offset:5200
    v_mfma_f32_32x32x16_bf16 v[16:31], v[56:59], v[136:139], v[16:31]
    ds_read_b128 v[72:75], v5 offset:26624
    ds_read_b128 v[152:155], v2 offset:6240
    s_waitcnt lgkmcnt(6)
    v_mfma_f32_32x32x16_bf16 v[16:31], v[60:63], v[140:143], v[16:31]
    ds_read_b128 v[76:79], v5 offset:27648
    ds_read_b128 v[156:159], v2 offset:7280
    s_barrier
    s_waitcnt lgkmcnt(2)
    v_mfma_f32_32x32x16_bf16 v[16:31], v[64:67], v[144:147], v[16:31]
    ds_read_b128 v[48:51], v5 offset:32768
    ds_read_b128 v[160:163], v2 offset:8320
    v_mfma_f32_32x32x16_bf16 v[16:31], v[68:71], v[148:151], v[16:31]
    ds_read_b128 v[52:55], v5 offset:33792
    ds_read_b128 v[164:167], v2 offset:9360
    v_mfma_f32_32x32x16_bf16 v[16:31], v[72:75], v[152:155], v[16:31]
    ds_read_b128 v[56:59], v5 offset:34816
    ds_read_b128 v[168:171], v2 offset:10400
    s_waitcnt lgkmcnt(6)
    v_mfma_f32_32x32x16_bf16 v[16:31], v[76:79], v[156:159], v[16:31]
    ds_read_b128 v[60:63], v5 offset:35840
    ds_read_b128 v[172:175], v2 offset:11440
    s_barrier
    s_waitcnt lgkmcnt(2)
    v_mfma_f32_32x32x16_bf16 v[16:31], v[48:51], v[160:163], v[16:31]
    ds_read_b128 v[64:67], v5 offset:40960
    ds_read_b128 v[176:179], v2 offset:12480
    v_mfma_f32_32x32x16_bf16 v[16:31], v[52:55], v[164:167], v[16:31]
    ds_read_b128 v[68:71], v5 offset:41984
    ds_read_b128 v[180:183], v2 offset:13520
    v_mfma_f32_32x32x16_bf16 v[16:31], v[56:59], v[168:171], v[16:31]
    ds_read_b128 v[72:75], v5 offset:43008
    ds_read_b128 v[184:187], v2 offset:14560
    s_waitcnt lgkmcnt(6)
    v_mfma_f32_32x32x16_bf16 v[16:31], v[60:63], v[172:175], v[16:31]
    ds_read_b128 v[76:79], v5 offset:44032
    ds_read_b128 v[188:191], v2 offset:15600
    s_barrier
    s_waitcnt lgkmcnt(2)
    v_mfma_f32_32x32x16_bf16 v[16:31], v[64:67], v[176:179], v[16:31]
    ds_read_b128 v[48:51], v5 offset:49152
    ds_read_b128 v[192:195], v2 offset:16640
    v_mfma_f32_32x32x16_bf16 v[16:31], v[68:71], v[180:183], v[16:31]
    ds_read_b128 v[52:55], v5 offset:50176
    ds_read_b128 v[196:199], v2 offset:17680
    v_mfma_f32_32x32x16_bf16 v[16:31], v[72:75], v[184:187], v[16:31]
    ds_read_b128 v[56:59], v5 offset:51200
    ds_read_b128 v[200:203], v2 offset:18720
    s_waitcnt lgkmcnt(6)
    v_mfma_f32_32x32x16_bf16 v[16:31], v[76:79], v[188:191], v[16:31]
    ds_read_b128 v[60:63], v5 offset:52224
    ds_read_b128 v[204:207], v2 offset:19760
    s_barrier
    s_waitcnt lgkmcnt(2)
    v_mfma_f32_32x32x16_bf16 v[16:31], v[48:51], v[192:195], v[16:31]
    ds_read_b128 v[64:67], v5 offset:57344
    ds_read_b128 v[208:211], v2 offset:20800
    v_mfma_f32_32x32x16_bf16 v[16:31], v[52:55], v[196:199], v[16:31]
    ds_read_b128 v[68:71], v5 offset:58368
    ds_read_b128 v[212:215], v2 offset:21840
    v_mfma_f32_32x32x16_bf16 v[16:31], v[56:59], v[200:203], v[16:31]
    ds_read_b128 v[72:75], v5 offset:59392
    ds_read_b128 v[216:219], v2 offset:22880
    s_waitcnt lgkmcnt(6)
    v_mfma_f32_32x32x16_bf16 v[16:31], v[60:63], v[204:207], v[16:31]
    ds_read_b128 v[76:79], v5 offset:60416
    ds_read_b128 v[220:223], v2 offset:23920
    s_barrier
    s_waitcnt lgkmcnt(2)
    v_mfma_f32_32x32x16_bf16 v[16:31], v[64:67], v[208:211], v[16:31]
    ds_read_b128 v[48:51], v6 offset:0
    ds_read_b128 v[224:227], v2 offset:24960
    v_mfma_f32_32x32x16_bf16 v[16:31], v[68:71], v[212:215], v[16:31]
    ds_read_b128 v[52:55], v6 offset:1024
    ds_read_b128 v[228:231], v2 offset:26000
    v_mfma_f32_32x32x16_bf16 v[16:31], v[72:75], v[216:219], v[16:31]
    ds_read_b128 v[56:59], v6 offset:2048
    ds_read_b128 v[232:235], v2 offset:27040
    s_waitcnt lgkmcnt(6)
    v_mfma_f32_32x32x16_bf16 v[16:31], v[76:79], v[220:223], v[16:31]
    ds_read_b128 v[60:63], v6 offset:3072
    ds_read_b128 v[236:239], v2 offset:28080
    s_barrier
    ds_read_b32 v126, v12 offset:768
    ds_read_b32 v127, v12 offset:1024
    s_waitcnt lgkmcnt(4)
    v_mfma_f32_32x32x16_bf16 v[16:31], v[48:51], v[224:227], v[16:31]
    ds_read_b128 v[64:67], v6 offset:8192
    ds_read_b128 v[240:243], v2 offset:29120
    v_mfma_f32_32x32x16_bf16 v[16:31], v[52:55], v[228:231], v[16:31]
    ds_read_b128 v[68:71], v6 offset:9216
    ds_read_b128 v[244:247], v2 offset:30160
    v_mfma_f32_32x32x16_bf16 v[16:31], v[56:59], v[232:235], v[16:31]
    ds_read_b128 v[72:75], v6 offset:10240
    ds_read_b128 v[248:251], v2 offset:31200
    s_waitcnt lgkmcnt(8)
    v_mfma_f32_32x32x16_bf16 v[16:31], v[60:63], v[236:239], v[16:31]
    ds_read_b128 v[76:79], v6 offset:11264
    ds_read_b128 v[252:255], v2 offset:32240
    s_barrier
    s_waitcnt lgkmcnt(2)
    v_mfma_f32_32x32x16_bf16 v[16:31], v[64:67], v[240:243], v[16:31]
    ds_read_b128 v[48:51], v6 offset:16384
    v_mfma_f32_32x32x16_bf16 v[16:31], v[68:71], v[244:247], v[16:31]
    ds_read_b128 v[52:55], v6 offset:17408
    v_mfma_f32_32x32x16_bf16 v[16:31], v[72:75], v[248:251], v[16:31]
    ds_read_b128 v[56:59], v6 offset:18432
    s_waitcnt lgkmcnt(3)
    v_mfma_f32_32x32x16_bf16 v[16:31], v[76:79], v[252:255], v[16:31]
    ds_read_b128 v[60:63], v6 offset:19456
    s_barrier
    s_waitcnt lgkmcnt(1)
    v_mfma_f32_32x32x16_bf16 v[32:47], v[48:51], v[128:131], 0
    ds_read_b128 v[64:67], v5 offset:0
    v_mul_f32 v124, 0x40135761, v127
    v_mul_f32 v125, v127, v127
    v_rcp_f32 v122, v127
    v_mul_f32 v125, v125, v127
    v_mul_f32 v125, 0x3dd2d3e8, v125
    s_waitcnt vmcnt(0)
    v_mfma_f32_32x32x16_bf16 v[32:47], v[52:55], v[132:135], v[32:47]
    ds_read_b128 v[68:71], v5 offset:1024
    v_fma_f32 v96, v80, v126, v16
    v_fma_f32 v97, v81, v126, v17
    v_fma_f32 v98, v82, v126, v18
    v_fma_f32 v99, v83, v126, v19
    v_fma_f32 v100, v84, v126, v20
    v_fma_f32 v101, v85, v126, v21
    v_mfma_f32_32x32x16_bf16 v[32:47], v[56:59], v[136:139], v[32:47]
    ds_read_b128 v[72:75], v5 offset:2048
    v_fma_f32 v102, v86, v126, v22
    v_fma_f32 v103, v87, v126, v23
    v_fma_f32 v104, v88, v126, v24
    v_fma_f32 v105, v89, v126, v25
    v_fma_f32 v106, v90, v126, v26
    v_fma_f32 v107, v91, v126, v27
    s_waitcnt lgkmcnt(3)
    v_mfma_f32_32x32x16_bf16 v[32:47], v[60:63], v[140:143], v[32:47]
    ds_read_b128 v[76:79], v5 offset:3072
    v_fma_f32 v108, v92, v126, v28
    v_fma_f32 v109, v93, v126, v29
    v_fma_f32 v110, v94, v126, v30
    v_fma_f32 v111, v95, v126, v31
    s_lshl_b32 s62, s100, 2
    s_add_u32 s62, s62, 73984
    s_barrier
    s_waitcnt lgkmcnt(1)
    v_mfma_f32_32x32x16_bf16 v[32:47], v[64:67], v[144:147], v[32:47]
    ds_read_b128 v[48:51], v5 offset:8192
    buffer_load_dwordx4 v[80:83], v10, s[4:7], s62 offen offset:0 sc1
    buffer_load_dwordx4 v[84:87], v10, s[4:7], s62 offen offset:32 sc1
    buffer_load_dwordx4 v[88:91], v10, s[4:7], s62 offen offset:64 sc1
    buffer_load_dwordx4 v[92:95], v10, s[4:7], s62 offen offset:96 sc1
    v_mul_f32 v112, v96, v96
    v_mul_f32 v116, v98, v98
    v_mfma_f32_32x32x16_bf16 v[32:47], v[68:71], v[148:151], v[32:47]
    ds_read_b128 v[52:55], v5 offset:9216
    v_mul_f32 v113, v97, v97
    v_mul_f32 v117, v99, v99
    v_fma_f32 v112, v112, v125, v124
    v_fma_f32 v116, v116, v125, v124
    v_fma_f32 v113, v113, v125, v124
    v_fma_f32 v117, v117, v125, v124
    v_mfma_f32_32x32x16_bf16 v[32:47], v[72:75], v[152:155], v[32:47]
    ds_read_b128 v[56:59], v5 offset:10240
    v_mul_f32 v112, v112, v96
    v_mul_f32 v116, v116, v98
    v_mul_f32 v113, v113, v97
    v_mul_f32 v117, v117, v99
    v_exp_f32 v114, -v112
    v_exp_f32 v118, -v116
    s_waitcnt lgkmcnt(3)
    v_mfma_f32_32x32x16_bf16 v[32:47], v[76:79], v[156:159], v[32:47]
    ds_read_b128 v[60:63], v5 offset:11264
    v_exp_f32 v115, -v113
    v_exp_f32 v119, -v117
    v_fma_f32 v114, v114, v122, v122
    v_fma_f32 v118, v118, v122, v122
    v_fma_f32 v115, v115, v122, v122
    v_fma_f32 v119, v119, v122, v122
    s_barrier
    s_waitcnt lgkmcnt(1)
    v_mfma_f32_32x32x16_bf16 v[32:47], v[48:51], v[160:163], v[32:47]
    ds_read_b128 v[64:67], v5 offset:16384
    v_rcp_f32 v114, v114
    v_rcp_f32 v118, v118
    v_rcp_f32 v115, v115
    v_rcp_f32 v119, v119
    v_mul_f32 v96, v96, v114
    v_mul_f32 v98, v98, v118
    v_mfma_f32_32x32x16_bf16 v[32:47], v[52:55], v[164:167], v[32:47]
    ds_read_b128 v[68:71], v5 offset:17408
    v_mul_f32 v97, v97, v115
    v_mul_f32 v99, v99, v119
    v_cvt_pk_bf16_f32 v96, v96, v97
    v_cvt_pk_bf16_f32 v97, v98, v99
    v_mul_f32 v112, v100, v100
    v_mul_f32 v116, v102, v102
    v_mfma_f32_32x32x16_bf16 v[32:47], v[56:59], v[168:171], v[32:47]
    ds_read_b128 v[72:75], v5 offset:18432
    v_mul_f32 v113, v101, v101
    v_mul_f32 v117, v103, v103
    v_fma_f32 v112, v112, v125, v124
    v_fma_f32 v116, v116, v125, v124
    v_fma_f32 v113, v113, v125, v124
    v_fma_f32 v117, v117, v125, v124
    s_waitcnt lgkmcnt(3)
    v_mfma_f32_32x32x16_bf16 v[32:47], v[60:63], v[172:175], v[32:47]
    ds_read_b128 v[76:79], v5 offset:19456
    v_mul_f32 v112, v112, v100
    v_mul_f32 v116, v116, v102
    v_mul_f32 v113, v113, v101
    v_mul_f32 v117, v117, v103
    v_exp_f32 v114, -v112
    v_exp_f32 v118, -v116
    s_barrier
    s_waitcnt lgkmcnt(1)
    v_mfma_f32_32x32x16_bf16 v[32:47], v[64:67], v[176:179], v[32:47]
    ds_read_b128 v[48:51], v5 offset:24576
    v_exp_f32 v115, -v113
    v_exp_f32 v119, -v117
    v_fma_f32 v114, v114, v122, v122
    v_fma_f32 v118, v118, v122, v122
    v_fma_f32 v115, v115, v122, v122
    v_fma_f32 v119, v119, v122, v122
    v_mfma_f32_32x32x16_bf16 v[32:47], v[68:71], v[180:183], v[32:47]
    ds_read_b128 v[52:55], v5 offset:25600
    v_rcp_f32 v114, v114
    v_rcp_f32 v118, v118
    v_rcp_f32 v115, v115
    v_rcp_f32 v119, v119
    v_mul_f32 v100, v100, v114
    v_mul_f32 v102, v102, v118
    v_mfma_f32_32x32x16_bf16 v[32:47], v[72:75], v[184:187], v[32:47]
    ds_read_b128 v[56:59], v5 offset:26624
    v_mul_f32 v101, v101, v115
    v_mul_f32 v103, v103, v119
    v_cvt_pk_bf16_f32 v98, v100, v101
    v_cvt_pk_bf16_f32 v99, v102, v103
    v_mul_f32 v112, v104, v104
    v_mul_f32 v116, v106, v106
    s_waitcnt lgkmcnt(3)
    v_mfma_f32_32x32x16_bf16 v[32:47], v[76:79], v[188:191], v[32:47]
    ds_read_b128 v[60:63], v5 offset:27648
    v_mul_f32 v113, v105, v105
    v_mul_f32 v117, v107, v107
    v_fma_f32 v112, v112, v125, v124
    v_fma_f32 v116, v116, v125, v124
    v_fma_f32 v113, v113, v125, v124
    v_fma_f32 v117, v117, v125, v124
    s_barrier
    s_waitcnt lgkmcnt(1)
    v_mfma_f32_32x32x16_bf16 v[32:47], v[48:51], v[192:195], v[32:47]
    ds_read_b128 v[64:67], v5 offset:32768
    v_mul_f32 v112, v112, v104
    v_mul_f32 v116, v116, v106
    v_mul_f32 v113, v113, v105
    v_mul_f32 v117, v117, v107
    v_exp_f32 v114, -v112
    v_exp_f32 v118, -v116
    v_mfma_f32_32x32x16_bf16 v[32:47], v[52:55], v[196:199], v[32:47]
    ds_read_b128 v[68:71], v5 offset:33792
    v_exp_f32 v115, -v113
    v_exp_f32 v119, -v117
    v_fma_f32 v114, v114, v122, v122
    v_fma_f32 v118, v118, v122, v122
    v_fma_f32 v115, v115, v122, v122
    v_fma_f32 v119, v119, v122, v122
    v_mfma_f32_32x32x16_bf16 v[32:47], v[56:59], v[200:203], v[32:47]
    ds_read_b128 v[72:75], v5 offset:34816
    v_rcp_f32 v114, v114
    v_rcp_f32 v118, v118
    v_rcp_f32 v115, v115
    v_rcp_f32 v119, v119
    v_mul_f32 v104, v104, v114
    v_mul_f32 v106, v106, v118
    s_waitcnt lgkmcnt(3)
    v_mfma_f32_32x32x16_bf16 v[32:47], v[60:63], v[204:207], v[32:47]
    ds_read_b128 v[76:79], v5 offset:35840
    v_mul_f32 v105, v105, v115
    v_mul_f32 v107, v107, v119
    v_cvt_pk_bf16_f32 v100, v104, v105
    v_cvt_pk_bf16_f32 v101, v106, v107
    v_mul_f32 v112, v108, v108
    v_mul_f32 v116, v110, v110
    s_barrier
    s_waitcnt lgkmcnt(1)
    v_mfma_f32_32x32x16_bf16 v[32:47], v[64:67], v[208:211], v[32:47]
    ds_read_b128 v[48:51], v5 offset:40960
    v_mul_f32 v113, v109, v109
    v_mul_f32 v117, v111, v111
    v_fma_f32 v112, v112, v125, v124
    v_fma_f32 v116, v116, v125, v124
    v_fma_f32 v113, v113, v125, v124
    v_fma_f32 v117, v117, v125, v124
    v_mfma_f32_32x32x16_bf16 v[32:47], v[68:71], v[212:215], v[32:47]
    ds_read_b128 v[52:55], v5 offset:41984
    v_mul_f32 v112, v112, v108
    v_mul_f32 v116, v116, v110
    v_mul_f32 v113, v113, v109
    v_mul_f32 v117, v117, v111
    v_exp_f32 v114, -v112
    v_exp_f32 v118, -v116
    v_mfma_f32_32x32x16_bf16 v[32:47], v[72:75], v[216:219], v[32:47]
    ds_read_b128 v[56:59], v5 offset:43008
    v_exp_f32 v115, -v113
    v_exp_f32 v119, -v117
    v_fma_f32 v114, v114, v122, v122
    v_fma_f32 v118, v118, v122, v122
    v_fma_f32 v115, v115, v122, v122
    v_fma_f32 v119, v119, v122, v122
    s_waitcnt lgkmcnt(3)
    v_mfma_f32_32x32x16_bf16 v[32:47], v[76:79], v[220:223], v[32:47]
    ds_read_b128 v[60:63], v5 offset:44032
    v_rcp_f32 v114, v114
    v_rcp_f32 v118, v118
    v_rcp_f32 v115, v115
    v_rcp_f32 v119, v119
    v_mul_f32 v108, v108, v114
    v_mul_f32 v110, v110, v118
    s_barrier
    s_waitcnt lgkmcnt(1)
    v_mfma_f32_32x32x16_bf16 v[32:47], v[48:51], v[224:227], v[32:47]
    ds_read_b128 v[64:67], v5 offset:49152
    v_mul_f32 v109, v109, v115
    v_mul_f32 v111, v111, v119
    v_cvt_pk_bf16_f32 v102, v108, v109
    v_cvt_pk_bf16_f32 v103, v110, v111
    s_add_u32 s99, s98, 0
    s_cmp_eq_u32 s52, 0
    s_cbranch_scc1 Lst_safe_26
    buffer_store_dwordx4 v[96:99], v7, s[4:7], s99 offen
    buffer_store_dwordx4 v[100:103], v7, s[4:7], s99 offen offset:1024
    s_branch Lst_done_27
Lst_safe_26:
    buffer_store_dwordx4 v[96:99], v7, s[4:7], s99 offen sc1
    buffer_store_dwordx4 v[100:103], v7, s[4:7], s99 offen offset:1024 sc1
Lst_done_27:
    v_mfma_f32_32x32x16_bf16 v[32:47], v[52:55], v[228:231], v[32:47]
    ds_read_b128 v[68:71], v5 offset:50176
    v_mfma_f32_32x32x16_bf16 v[32:47], v[56:59], v[232:235], v[32:47]
    ds_read_b128 v[72:75], v5 offset:51200
    s_waitcnt lgkmcnt(3)
    v_mfma_f32_32x32x16_bf16 v[32:47], v[60:63], v[236:239], v[32:47]
    ds_read_b128 v[76:79], v5 offset:52224
    s_barrier
    s_waitcnt lgkmcnt(1)
    v_mfma_f32_32x32x16_bf16 v[32:47], v[64:67], v[240:243], v[32:47]
    ds_read_b128 v[48:51], v5 offset:57344
    v_mfma_f32_32x32x16_bf16 v[32:47], v[68:71], v[244:247], v[32:47]
    ds_read_b128 v[52:55], v5 offset:58368
    v_mfma_f32_32x32x16_bf16 v[32:47], v[72:75], v[248:251], v[32:47]
    ds_read_b128 v[56:59], v5 offset:59392
    s_waitcnt lgkmcnt(3)
    v_mfma_f32_32x32x16_bf16 v[32:47], v[76:79], v[252:255], v[32:47]
    ds_read_b128 v[60:63], v5 offset:60416
    s_barrier
    s_waitcnt lgkmcnt(1)
    v_mfma_f32_32x32x16_bf16 v[16:31], v[48:51], v[128:131], 0
    ds_read_b128 v[64:67], v6 offset:0
    s_waitcnt vmcnt(2)
    s_nop 5
    v_fma_f32 v96, v80, v126, v32
    v_fma_f32 v97, v81, v126, v33
    v_fma_f32 v98, v82, v126, v34
    v_fma_f32 v99, v83, v126, v35
    v_fma_f32 v100, v84, v126, v36
    v_mfma_f32_32x32x16_bf16 v[16:31], v[52:55], v[132:135], v[16:31]
    ds_read_b128 v[68:71], v6 offset:1024
    v_fma_f32 v101, v85, v126, v37
    v_fma_f32 v102, v86, v126, v38
    v_fma_f32 v103, v87, v126, v39
    v_fma_f32 v104, v88, v126, v40
    v_fma_f32 v105, v89, v126, v41
    v_fma_f32 v106, v90, v126, v42
    v_mfma_f32_32x32x16_bf16 v[16:31], v[56:59], v[136:139], v[16:31]
    ds_read_b128 v[72:75], v6 offset:2048
    v_fma_f32 v107, v91, v126, v43
    v_fma_f32 v108, v92, v126, v44
    v_fma_f32 v109, v93, v126, v45
    v_fma_f32 v110, v94, v126, v46
    v_fma_f32 v111, v95, v126, v47
    s_lshl_b32 s62, s100, 2
    s_waitcnt lgkmcnt(3)
    v_mfma_f32_32x32x16_bf16 v[16:31], v[60:63], v[140:143], v[16:31]
    ds_read_b128 v[76:79], v6 offset:3072
    s_add_u32 s62, s62, 74240
    buffer_load_dwordx4 v[80:83], v10, s[4:7], s62 offen offset:0 sc1
    buffer_load_dwordx4 v[84:87], v10, s[4:7], s62 offen offset:32 sc1
    buffer_load_dwordx4 v[88:91], v10, s[4:7], s62 offen offset:64 sc1
    buffer_load_dwordx4 v[92:95], v10, s[4:7], s62 offen offset:96 sc1
    v_mul_f32 v112, v96, v96
    s_barrier
    s_waitcnt lgkmcnt(1)
    v_mfma_f32_32x32x16_bf16 v[16:31], v[64:67], v[144:147], v[16:31]
    ds_read_b128 v[48:51], v6 offset:8192
    v_mul_f32 v116, v98, v98
    v_mul_f32 v113, v97, v97
    v_mul_f32 v117, v99, v99
    v_fma_f32 v112, v112, v125, v124
    v_fma_f32 v116, v116, v125, v124
    v_fma_f32 v113, v113, v125, v124
    v_mfma_f32_32x32x16_bf16 v[16:31], v[68:71], v[148:151], v[16:31]
    ds_read_b128 v[52:55], v6 offset:9216
    v_fma_f32 v117, v117, v125, v124
    v_mul_f32 v112, v112, v96
    v_mul_f32 v116, v116, v98
    v_mul_f32 v113, v113, v97
    v_mul_f32 v117, v117, v99
    v_exp_f32 v114, -v112
    v_mfma_f32_32x32x16_bf16 v[16:31], v[72:75], v[152:155], v[16:31]
    ds_read_b128 v[56:59], v6 offset:10240
    v_exp_f32 v118, -v116
    v_exp_f32 v115, -v113
    v_exp_f32 v119, -v117
    v_fma_f32 v114, v114, v122, v122
    v_fma_f32 v118, v118, v122, v122
    v_fma_f32 v115, v115, v122, v122
    s_waitcnt lgkmcnt(3)
    v_mfma_f32_32x32x16_bf16 v[16:31], v[76:79], v[156:159], v[16:31]
    ds_read_b128 v[60:63], v6 offset:11264
    v_fma_f32 v119, v119, v122, v122
    v_rcp_f32 v114, v114
    v_rcp_f32 v118, v118
    v_rcp_f32 v115, v115
    v_rcp_f32 v119, v119
    v_mul_f32 v96, v96, v114
    s_barrier
    s_waitcnt lgkmcnt(1)
    v_mfma_f32_32x32x16_bf16 v[16:31], v[48:51], v[160:163], v[16:31]
    ds_read_b128 v[64:67], v6 offset:16384
    v_mul_f32 v98, v98, v118
    v_mul_f32 v97, v97, v115
    v_mul_f32 v99, v99, v119
    v_cvt_pk_bf16_f32 v96, v96, v97
    v_cvt_pk_bf16_f32 v97, v98, v99
    v_mul_f32 v112, v100, v100
    v_mfma_f32_32x32x16_bf16 v[16:31], v[52:55], v[164:167], v[16:31]
    ds_read_b128 v[68:71], v6 offset:17408
    v_mul_f32 v116, v102, v102
    v_mul_f32 v113, v101, v101
    v_mul_f32 v117, v103, v103
    v_fma_f32 v112, v112, v125, v124
    v_fma_f32 v116, v116, v125, v124
    v_fma_f32 v113, v113, v125, v124
    v_mfma_f32_32x32x16_bf16 v[16:31], v[56:59], v[168:171], v[16:31]
    ds_read_b128 v[72:75], v6 offset:18432
    v_fma_f32 v117, v117, v125, v124
    v_mul_f32 v112, v112, v100
    v_mul_f32 v116, v116, v102
    v_mul_f32 v113, v113, v101
    v_mul_f32 v117, v117, v103
    v_exp_f32 v114, -v112
    s_waitcnt lgkmcnt(3)
    v_mfma_f32_32x32x16_bf16 v[16:31], v[60:63], v[172:175], v[16:31]
    ds_read_b128 v[76:79], v6 offset:19456
    v_exp_f32 v118, -v116
    v_exp_f32 v115, -v113
    v_exp_f32 v119, -v117
    v_fma_f32 v114, v114, v122, v122
    v_fma_f32 v118, v118, v122, v122
    v_fma_f32 v115, v115, v122, v122
    s_barrier
    s_waitcnt lgkmcnt(1)
    v_mfma_f32_32x32x16_bf16 v[16:31], v[64:67], v[176:179], v[16:31]
    ds_read_b128 v[48:51], v5 offset:0
    v_fma_f32 v119, v119, v122, v122
    v_rcp_f32 v114, v114
    v_rcp_f32 v118, v118
    v_rcp_f32 v115, v115
    v_rcp_f32 v119, v119
    v_mul_f32 v100, v100, v114
    v_mfma_f32_32x32x16_bf16 v[16:31], v[68:71], v[180:183], v[16:31]
    ds_read_b128 v[52:55], v5 offset:1024
    v_mul_f32 v102, v102, v118
    v_mul_f32 v101, v101, v115
    v_mul_f32 v103, v103, v119
    v_cvt_pk_bf16_f32 v98, v100, v101
    v_cvt_pk_bf16_f32 v99, v102, v103
    v_mul_f32 v112, v104, v104
    v_mfma_f32_32x32x16_bf16 v[16:31], v[72:75], v[184:187], v[16:31]
    ds_read_b128 v[56:59], v5 offset:2048
    v_mul_f32 v116, v106, v106
    v_mul_f32 v113, v105, v105
    v_mul_f32 v117, v107, v107
    v_fma_f32 v112, v112, v125, v124
    v_fma_f32 v116, v116, v125, v124
    v_fma_f32 v113, v113, v125, v124
    s_waitcnt lgkmcnt(3)
    v_mfma_f32_32x32x16_bf16 v[16:31], v[76:79], v[188:191], v[16:31]
    ds_read_b128 v[60:63], v5 offset:3072
    v_fma_f32 v117, v117, v125, v124
    v_mul_f32 v112, v112, v104
    v_mul_f32 v116, v116, v106
    v_mul_f32 v113, v113, v105
    v_mul_f32 v117, v117, v107
    v_exp_f32 v114, -v112
    s_barrier
    s_waitcnt lgkmcnt(1)
    v_mfma_f32_32x32x16_bf16 v[16:31], v[48:51], v[192:195], v[16:31]
    ds_read_b128 v[64:67], v5 offset:8192
    v_exp_f32 v118, -v116
    v_exp_f32 v115, -v113
    v_exp_f32 v119, -v117
    v_fma_f32 v114, v114, v122, v122
    v_fma_f32 v118, v118, v122, v122
    v_fma_f32 v115, v115, v122, v122
    v_mfma_f32_32x32x16_bf16 v[16:31], v[52:55], v[196:199], v[16:31]
    ds_read_b128 v[68:71], v5 offset:9216
    v_fma_f32 v119, v119, v122, v122
    v_rcp_f32 v114, v114
    v_rcp_f32 v118, v118
    v_rcp_f32 v115, v115
    v_rcp_f32 v119, v119
    v_mul_f32 v104, v104, v114
    v_mfma_f32_32x32x16_bf16 v[16:31], v[56:59], v[200:203], v[16:31]
    ds_read_b128 v[72:75], v5 offset:10240
    v_mul_f32 v106, v106, v118
    v_mul_f32 v105, v105, v115
    v_mul_f32 v107, v107, v119
    v_cvt_pk_bf16_f32 v100, v104, v105
    v_cvt_pk_bf16_f32 v101, v106, v107
    v_mul_f32 v112, v108, v108
    s_waitcnt lgkmcnt(3)
    v_mfma_f32_32x32x16_bf16 v[16:31], v[60:63], v[204:207], v[16:31]
    ds_read_b128 v[76:79], v5 offset:11264
    v_mul_f32 v116, v110, v110
    v_mul_f32 v113, v109, v109
    v_mul_f32 v117, v111, v111
    v_fma_f32 v112, v112, v125, v124
    v_fma_f32 v116, v116, v125, v124
    v_fma_f32 v113, v113, v125, v124
    s_barrier
    s_waitcnt lgkmcnt(1)
    v_mfma_f32_32x32x16_bf16 v[16:31], v[64:67], v[208:211], v[16:31]
    ds_read_b128 v[48:51], v5 offset:16384
    v_fma_f32 v117, v117, v125, v124
    v_mul_f32 v112, v112, v108
    v_mul_f32 v116, v116, v110
    v_mul_f32 v113, v113, v109
    v_mul_f32 v117, v117, v111
    v_exp_f32 v114, -v112
    v_mfma_f32_32x32x16_bf16 v[16:31], v[68:71], v[212:215], v[16:31]
    ds_read_b128 v[52:55], v5 offset:17408
    v_exp_f32 v118, -v116
    v_exp_f32 v115, -v113
    v_exp_f32 v119, -v117
    v_fma_f32 v114, v114, v122, v122
    v_fma_f32 v118, v118, v122, v122
    v_fma_f32 v115, v115, v122, v122
    v_mfma_f32_32x32x16_bf16 v[16:31], v[72:75], v[216:219], v[16:31]
    ds_read_b128 v[56:59], v5 offset:18432
    v_fma_f32 v119, v119, v122, v122
    v_rcp_f32 v114, v114
    v_rcp_f32 v118, v118
    v_rcp_f32 v115, v115
    v_rcp_f32 v119, v119
    v_mul_f32 v108, v108, v114
    s_waitcnt lgkmcnt(3)
    v_mfma_f32_32x32x16_bf16 v[16:31], v[76:79], v[220:223], v[16:31]
    ds_read_b128 v[60:63], v5 offset:19456
    v_mul_f32 v110, v110, v118
    v_mul_f32 v109, v109, v115
    v_mul_f32 v111, v111, v119
    v_cvt_pk_bf16_f32 v102, v108, v109
    v_cvt_pk_bf16_f32 v103, v110, v111
    s_add_u32 s99, s98, 4096
    s_barrier
    s_waitcnt lgkmcnt(1)
    v_mfma_f32_32x32x16_bf16 v[16:31], v[48:51], v[224:227], v[16:31]
    ds_read_b128 v[64:67], v5 offset:24576
    s_cmp_eq_u32 s52, 0
    s_cbranch_scc1 Lst_safe_28
    buffer_store_dwordx4 v[96:99], v7, s[4:7], s99 offen
    buffer_store_dwordx4 v[100:103], v7, s[4:7], s99 offen offset:1024
    s_branch Lst_done_29
Lst_safe_28:
    buffer_store_dwordx4 v[96:99], v7, s[4:7], s99 offen sc1
    buffer_store_dwordx4 v[100:103], v7, s[4:7], s99 offen offset:1024 sc1
Lst_done_29:
    v_mfma_f32_32x32x16_bf16 v[16:31], v[52:55], v[228:231], v[16:31]
    ds_read_b128 v[68:71], v5 offset:25600
    v_mfma_f32_32x32x16_bf16 v[16:31], v[56:59], v[232:235], v[16:31]
    ds_read_b128 v[72:75], v5 offset:26624
    s_waitcnt lgkmcnt(3)
    v_mfma_f32_32x32x16_bf16 v[16:31], v[60:63], v[236:239], v[16:31]
    ds_read_b128 v[76:79], v5 offset:27648
    s_barrier
    s_waitcnt lgkmcnt(1)
    v_mfma_f32_32x32x16_bf16 v[16:31], v[64:67], v[240:243], v[16:31]
    ds_read_b128 v[48:51], v5 offset:32768
    v_mfma_f32_32x32x16_bf16 v[16:31], v[68:71], v[244:247], v[16:31]
    ds_read_b128 v[52:55], v5 offset:33792
    v_mfma_f32_32x32x16_bf16 v[16:31], v[72:75], v[248:251], v[16:31]
    ds_read_b128 v[56:59], v5 offset:34816
    s_waitcnt lgkmcnt(3)
    v_mfma_f32_32x32x16_bf16 v[16:31], v[76:79], v[252:255], v[16:31]
    ds_read_b128 v[60:63], v5 offset:35840
    s_barrier
    s_cmp_eq_u32 s75, 1
    s_cbranch_scc1 Lks1_32
    s_waitcnt lgkmcnt(1)
    v_mfma_f32_32x32x16_bf16 v[32:47], v[48:51], v[128:131], 0
    ds_read_b128 v[64:67], v5 offset:40960
    s_waitcnt vmcnt(2)
    s_nop 3
    v_fma_f32 v96, v80, v126, v16
    v_fma_f32 v97, v81, v126, v17
    v_fma_f32 v98, v82, v126, v18
    v_fma_f32 v99, v83, v126, v19
    v_fma_f32 v100, v84, v126, v20
    v_fma_f32 v101, v85, v126, v21
    v_fma_f32 v102, v86, v126, v22
    v_mfma_f32_32x32x16_bf16 v[32:47], v[52:55], v[132:135], v[32:47]
    ds_read_b128 v[68:71], v5 offset:41984
    v_fma_f32 v103, v87, v126, v23
    v_fma_f32 v104, v88, v126, v24
    v_fma_f32 v105, v89, v126, v25
    v_fma_f32 v106, v90, v126, v26
    v_fma_f32 v107, v91, v126, v27
    v_fma_f32 v108, v92, v126, v28
    v_fma_f32 v109, v93, v126, v29
    v_fma_f32 v110, v94, v126, v30
    v_mfma_f32_32x32x16_bf16 v[32:47], v[56:59], v[136:139], v[32:47]
    ds_read_b128 v[72:75], v5 offset:43008
    v_fma_f32 v111, v95, v126, v31
    s_lshl_b32 s62, s79, 2
    s_add_u32 s62, s62, 74496
    buffer_load_dwordx4 v[80:83], v10, s[4:7], s62 offen offset:0 sc1
    buffer_load_dwordx4 v[84:87], v10, s[4:7], s62 offen offset:32 sc1
    buffer_load_dwordx4 v[88:91], v10, s[4:7], s62 offen offset:64 sc1
    buffer_load_dwordx4 v[92:95], v10, s[4:7], s62 offen offset:96 sc1
    v_mul_f32 v112, v96, v96
    s_waitcnt lgkmcnt(3)
    v_mfma_f32_32x32x16_bf16 v[32:47], v[60:63], v[140:143], v[32:47]
    ds_read_b128 v[76:79], v5 offset:44032
    v_mul_f32 v116, v98, v98
    v_mul_f32 v113, v97, v97
    v_mul_f32 v117, v99, v99
    v_fma_f32 v112, v112, v125, v124
    v_fma_f32 v116, v116, v125, v124
    v_fma_f32 v113, v113, v125, v124
    v_fma_f32 v117, v117, v125, v124
    v_mul_f32 v112, v112, v96
    s_branch Lksj_33
Lks1_32:
    s_waitcnt lgkmcnt(1)
    v_mfma_f32_32x32x16_bf16 v[32:47], v[48:51], v[192:195], 0
    ds_read_b128 v[64:67], v5 offset:40960
    s_waitcnt vmcnt(2)
    s_nop 3
    v_fma_f32 v96, v80, v126, v16
    v_fma_f32 v97, v81, v126, v17
    v_fma_f32 v98, v82, v126, v18
    v_fma_f32 v99, v83, v126, v19
    v_fma_f32 v100, v84, v126, v20
    v_fma_f32 v101, v85, v126, v21
    v_fma_f32 v102, v86, v126, v22
    v_mfma_f32_32x32x16_bf16 v[32:47], v[52:55], v[196:199], v[32:47]
    ds_read_b128 v[68:71], v5 offset:41984
    v_fma_f32 v103, v87, v126, v23
    v_fma_f32 v104, v88, v126, v24
    v_fma_f32 v105, v89, v126, v25
    v_fma_f32 v106, v90, v126, v26
    v_fma_f32 v107, v91, v126, v27
    v_fma_f32 v108, v92, v126, v28
    v_fma_f32 v109, v93, v126, v29
    v_fma_f32 v110, v94, v126, v30
    v_mfma_f32_32x32x16_bf16 v[32:47], v[56:59], v[200:203], v[32:47]
    ds_read_b128 v[72:75], v5 offset:43008
    v_fma_f32 v111, v95, v126, v31
    s_lshl_b32 s62, s79, 2
    s_add_u32 s62, s62, 74496
    buffer_load_dwordx4 v[80:83], v10, s[4:7], s62 offen offset:0 sc1
    buffer_load_dwordx4 v[84:87], v10, s[4:7], s62 offen offset:32 sc1
    buffer_load_dwordx4 v[88:91], v10, s[4:7], s62 offen offset:64 sc1
    buffer_load_dwordx4 v[92:95], v10, s[4:7], s62 offen offset:96 sc1
    v_mul_f32 v112, v96, v96
    s_waitcnt lgkmcnt(3)
    v_mfma_f32_32x32x16_bf16 v[32:47], v[60:63], v[204:207], v[32:47]
    ds_read_b128 v[76:79], v5 offset:44032
    v_mul_f32 v116, v98, v98
    v_mul_f32 v113, v97, v97
    v_mul_f32 v117, v99, v99
    v_fma_f32 v112, v112, v125, v124
    v_fma_f32 v116, v116, v125, v124
    v_fma_f32 v113, v113, v125, v124
    v_fma_f32 v117, v117, v125, v124
    v_mul_f32 v112, v112, v96
Lksj_33:
    s_barrier
    s_cmp_eq_u32 s75, 1
    s_cbranch_scc1 Lks1_36
    s_waitcnt lgkmcnt(1)
    v_mfma_f32_32x32x16_bf16 v[32:47], v[64:67], v[144:147], v[32:47]
    ds_read_b128 v[48:51], v5 offset:49152
    v_mul_f32 v116, v116, v98
    v_mul_f32 v113, v113, v97
    v_mul_f32 v117, v117, v99
    v_exp_f32 v114, -v112
    v_exp_f32 v118, -v116
    v_exp_f32 v115, -v113
    v_exp_f32 v119, -v117
    v_fma_f32 v114, v114, v122, v122
    v_mfma_f32_32x32x16_bf16 v[32:47], v[68:71], v[148:151], v[32:47]
    ds_read_b128 v[52:55], v5 offset:50176
    v_fma_f32 v118, v118, v122, v122
    v_fma_f32 v115, v115, v122, v122
    v_fma_f32 v119, v119, v122, v122
    v_rcp_f32 v114, v114
    v_rcp_f32 v118, v118
    v_rcp_f32 v115, v115
    v_rcp_f32 v119, v119
    v_mul_f32 v96, v96, v114
    v_mfma_f32_32x32x16_bf16 v[32:47], v[72:75], v[152:155], v[32:47]
    ds_read_b128 v[56:59], v5 offset:51200
    v_mul_f32 v98, v98, v118
    v_mul_f32 v97, v97, v115
    v_mul_f32 v99, v99, v119
    v_cvt_pk_bf16_f32 v96, v96, v97
    v_cvt_pk_bf16_f32 v97, v98, v99
    v_mul_f32 v112, v100, v100
    v_mul_f32 v116, v102, v102
    v_mul_f32 v113, v101, v101
    s_waitcnt lgkmcnt(3)
    v_mfma_f32_32x32x16_bf16 v[32:47], v[76:79], v[156:159], v[32:47]
    ds_read_b128 v[60:63], v5 offset:52224
    v_mul_f32 v117, v103, v103
    v_fma_f32 v112, v112, v125, v124
    v_fma_f32 v116, v116, v125, v124
    v_fma_f32 v113, v113, v125, v124
    v_fma_f32 v117, v117, v125, v124
    v_mul_f32 v112, v112, v100
    v_mul_f32 v116, v116, v102
    v_mul_f32 v113, v113, v101
    s_branch Lksj_37
Lks1_36:
    s_waitcnt lgkmcnt(1)
    v_mfma_f32_32x32x16_bf16 v[32:47], v[64:67], v[208:211], v[32:47]
    ds_read_b128 v[48:51], v5 offset:49152
    v_mul_f32 v116, v116, v98
    v_mul_f32 v113, v113, v97
    v_mul_f32 v117, v117, v99
    v_exp_f32 v114, -v112
    v_exp_f32 v118, -v116
    v_exp_f32 v115, -v113
    v_exp_f32 v119, -v117
    v_fma_f32 v114, v114, v122, v122
    v_mfma_f32_32x32x16_bf16 v[32:47], v[68:71], v[212:215], v[32:47]
    ds_read_b128 v[52:55], v5 offset:50176
    v_fma_f32 v118, v118, v122, v122
    v_fma_f32 v115, v115, v122, v122
    v_fma_f32 v119, v119, v122, v122
    v_rcp_f32 v114, v114
    v_rcp_f32 v118, v118
    v_rcp_f32 v115, v115
    v_rcp_f32 v119, v119
    v_mul_f32 v96, v96, v114
    v_mfma_f32_32x32x16_bf16 v[32:47], v[72:75], v[216:219], v[32:47]
    ds_read_b128 v[56:59], v5 offset:51200
    v_mul_f32 v98, v98, v118
    v_mul_f32 v97, v97, v115
    v_mul_f32 v99, v99, v119
    v_cvt_pk_bf16_f32 v96, v96, v97
    v_cvt_pk_bf16_f32 v97, v98, v99
    v_mul_f32 v112, v100, v100
    v_mul_f32 v116, v102, v102
    v_mul_f32 v113, v101, v101
    s_waitcnt lgkmcnt(3)
    v_mfma_f32_32x32x16_bf16 v[32:47], v[76:79], v[220:223], v[32:47]
    ds_read_b128 v[60:63], v5 offset:52224
    v_mul_f32 v117, v103, v103
    v_fma_f32 v112, v112, v125, v124
    v_fma_f32 v116, v116, v125, v124
    v_fma_f32 v113, v113, v125, v124
    v_fma_f32 v117, v117, v125, v124
    v_mul_f32 v112, v112, v100
    v_mul_f32 v116, v116, v102
    v_mul_f32 v113, v113, v101
Lksj_37:
    s_barrier
    s_cmp_eq_u32 s75, 1
    s_cbranch_scc1 Lks1_40
    s_waitcnt lgkmcnt(1)
    v_mfma_f32_32x32x16_bf16 v[32:47], v[48:51], v[160:163], v[32:47]
    ds_read_b128 v[64:67], v5 offset:57344
    v_mul_f32 v117, v117, v103
    v_exp_f32 v114, -v112
    v_exp_f32 v118, -v116
    v_exp_f32 v115, -v113
    v_exp_f32 v119, -v117
    v_fma_f32 v114, v114, v122, v122
    v_fma_f32 v118, v118, v122, v122
    v_fma_f32 v115, v115, v122, v122
    v_mfma_f32_32x32x16_bf16 v[32:47], v[52:55], v[164:167], v[32:47]
    ds_read_b128 v[68:71], v5 offset:58368
    v_fma_f32 v119, v119, v122, v122
    v_rcp_f32 v114, v114
    v_rcp_f32 v118, v118
    v_rcp_f32 v115, v115
    v_rcp_f32 v119, v119
    v_mul_f32 v100, v100, v114
    v_mul_f32 v102, v102, v118
    v_mul_f32 v101, v101, v115
    v_mfma_f32_32x32x16_bf16 v[32:47], v[56:59], v[168:171], v[32:47]
    ds_read_b128 v[72:75], v5 offset:59392
    v_mul_f32 v103, v103, v119
    v_cvt_pk_bf16_f32 v98, v100, v101
    v_cvt_pk_bf16_f32 v99, v102, v103
    v_mul_f32 v112, v104, v104
    v_mul_f32 v116, v106, v106
    v_mul_f32 v113, v105, v105
    v_mul_f32 v117, v107, v107
    v_fma_f32 v112, v112, v125, v124
    s_waitcnt lgkmcnt(3)
    v_mfma_f32_32x32x16_bf16 v[32:47], v[60:63], v[172:175], v[32:47]
    ds_read_b128 v[76:79], v5 offset:60416
    v_fma_f32 v116, v116, v125, v124
    v_fma_f32 v113, v113, v125, v124
    v_fma_f32 v117, v117, v125, v124
    v_mul_f32 v112, v112, v104
    v_mul_f32 v116, v116, v106
    v_mul_f32 v113, v113, v105
    v_mul_f32 v117, v117, v107
    v_exp_f32 v114, -v112
    s_branch Lksj_41
Lks1_40:
    s_waitcnt lgkmcnt(1)
    v_mfma_f32_32x32x16_bf16 v[32:47], v[48:51], v[224:227], v[32:47]
    ds_read_b128 v[64:67], v5 offset:57344
    v_mul_f32 v117, v117, v103
    v_exp_f32 v114, -v112
    v_exp_f32 v118, -v116
    v_exp_f32 v115, -v113
    v_exp_f32 v119, -v117
    v_fma_f32 v114, v114, v122, v122
    v_fma_f32 v118, v118, v122, v122
    v_fma_f32 v115, v115, v122, v122
    v_mfma_f32_32x32x16_bf16 v[32:47], v[52:55], v[228:231], v[32:47]
    ds_read_b128 v[68:71], v5 offset:58368
    v_fma_f32 v119, v119, v122, v122
    v_rcp_f32 v114, v114
    v_rcp_f32 v118, v118
    v_rcp_f32 v115, v115
    v_rcp_f32 v119, v119
    v_mul_f32 v100, v100, v114
    v_mul_f32 v102, v102, v118
    v_mul_f32 v101, v101, v115
    v_mfma_f32_32x32x16_bf16 v[32:47], v[56:59], v[232:235], v[32:47]
    ds_read_b128 v[72:75], v5 offset:59392
    v_mul_f32 v103, v103, v119
    v_cvt_pk_bf16_f32 v98, v100, v101
    v_cvt_pk_bf16_f32 v99, v102, v103
    v_mul_f32 v112, v104, v104
    v_mul_f32 v116, v106, v106
    v_mul_f32 v113, v105, v105
    v_mul_f32 v117, v107, v107
    v_fma_f32 v112, v112, v125, v124
    s_waitcnt lgkmcnt(3)
    v_mfma_f32_32x32x16_bf16 v[32:47], v[60:63], v[236:239], v[32:47]
    ds_read_b128 v[76:79], v5 offset:60416
    v_fma_f32 v116, v116, v125, v124
    v_fma_f32 v113, v113, v125, v124
    v_fma_f32 v117, v117, v125, v124
    v_mul_f32 v112, v112, v104
    v_mul_f32 v116, v116, v106
    v_mul_f32 v113, v113, v105
    v_mul_f32 v117, v117, v107
    v_exp_f32 v114, -v112
Lksj_41:
    s_lshl_b32 s56, s48, 11
    s_add_u32 s57, s56, 57344
    v_add_u32 v120, s57, v7
    s_xor_b32 s56, s56, 4096
    s_add_u32 s57, s56, 57344
    v_add_u32 v121, s57, v7
    s_cmp_eq_u32 s75, 1
    s_cbranch_scc1 Lks1_44
    s_waitcnt lgkmcnt(1)
    v_mfma_f32_32x32x16_bf16 v[32:47], v[64:67], v[176:179], v[32:47]
    v_mfma_f32_32x32x16_bf16 v[32:47], v[68:71], v[180:183], v[32:47]
    v_mfma_f32_32x32x16_bf16 v[32:47], v[72:75], v[184:187], v[32:47]
    s_waitcnt lgkmcnt(0)
    v_mfma_f32_32x32x16_bf16 v[32:47], v[76:79], v[188:191], v[32:47]
    v_exp_f32 v118, -v116
    v_exp_f32 v115, -v113
    v_exp_f32 v119, -v117
    v_fma_f32 v114, v114, v122, v122
    v_fma_f32 v118, v118, v122, v122
    v_fma_f32 v115, v115, v122, v122
    v_fma_f32 v119, v119, v122, v122
    v_rcp_f32 v114, v114
    v_rcp_f32 v118, v118
    v_rcp_f32 v115, v115
    v_rcp_f32 v119, v119
    v_mul_f32 v104, v104, v114
    v_mul_f32 v106, v106, v118
    v_mul_f32 v105, v105, v115
    v_mul_f32 v107, v107, v119
    v_cvt_pk_bf16_f32 v100, v104, v105
    v_cvt_pk_bf16_f32 v101, v106, v107
    v_mul_f32 v112, v108, v108
    v_mul_f32 v116, v110, v110
    v_mul_f32 v113, v109, v109
    v_mul_f32 v117, v111, v111
    v_fma_f32 v112, v112, v125, v124
    v_fma_f32 v116, v116, v125, v124
    v_fma_f32 v113, v113, v125, v124
    v_fma_f32 v117, v117, v125, v124
    v_mul_f32 v112, v112, v108
    v_mul_f32 v116, v116, v110
    v_mul_f32 v113, v113, v109
    v_mul_f32 v117, v117, v111
    v_exp_f32 v114, -v112
    v_exp_f32 v118, -v116
    v_exp_f32 v115, -v113
    v_exp_f32 v119, -v117
    v_fma_f32 v114, v114, v122, v122
    v_fma_f32 v118, v118, v122, v122
    v_fma_f32 v115, v115, v122, v122
    v_fma_f32 v119, v119, v122, v122
    v_rcp_f32 v114, v114
    v_rcp_f32 v118, v118
    v_rcp_f32 v115, v115
    v_rcp_f32 v119, v119
    v_mul_f32 v108, v108, v114
    v_mul_f32 v110, v110, v118
    v_mul_f32 v109, v109, v115
    v_mul_f32 v111, v111, v119
    v_cvt_pk_bf16_f32 v102, v108, v109
    v_cvt_pk_bf16_f32 v103, v110, v111
    s_add_u32 s99, s98, 8192
    s_cmp_eq_u32 s52, 0
    s_cbranch_scc1 Lst_safe_30
    buffer_store_dwordx4 v[96:99], v7, s[4:7], s99 offen
    buffer_store_dwordx4 v[100:103], v7, s[4:7], s99 offen offset:1024
    s_branch Lst_done_31
Lst_safe_30:
    buffer_store_dwordx4 v[96:99], v7, s[4:7], s99 offen sc1
    buffer_store_dwordx4 v[100:103], v7, s[4:7], s99 offen offset:1024 sc1
Lst_done_31:
    ds_write_b128 v120, v[40:43] offset:0
    ds_write_b128 v120, v[44:47] offset:1024
    s_waitcnt lgkmcnt(0)
    s_branch Lksj_45
Lks1_44:
    s_waitcnt lgkmcnt(1)
    v_mfma_f32_32x32x16_bf16 v[32:47], v[64:67], v[240:243], v[32:47]
    v_mfma_f32_32x32x16_bf16 v[32:47], v[68:71], v[244:247], v[32:47]
    v_mfma_f32_32x32x16_bf16 v[32:47], v[72:75], v[248:251], v[32:47]
    s_waitcnt lgkmcnt(0)
    v_mfma_f32_32x32x16_bf16 v[32:47], v[76:79], v[252:255], v[32:47]
    v_exp_f32 v118, -v116
    v_exp_f32 v115, -v113
    v_exp_f32 v119, -v117
    v_fma_f32 v114, v114, v122, v122
    v_fma_f32 v118, v118, v122, v122
    v_fma_f32 v115, v115, v122, v122
    v_fma_f32 v119, v119, v122, v122
    v_rcp_f32 v114, v114
    v_rcp_f32 v118, v118
    v_rcp_f32 v115, v115
    v_rcp_f32 v119, v119
    v_mul_f32 v104, v104, v114
    v_mul_f32 v106, v106, v118
    v_mul_f32 v105, v105, v115
    v_mul_f32 v107, v107, v119
    v_cvt_pk_bf16_f32 v100, v104, v105
    v_cvt_pk_bf16_f32 v101, v106, v107
    v_mul_f32 v112, v108, v108
    v_mul_f32 v116, v110, v110
    v_mul_f32 v113, v109, v109
    v_mul_f32 v117, v111, v111
    v_fma_f32 v112, v112, v125, v124
    v_fma_f32 v116, v116, v125, v124
    v_fma_f32 v113, v113, v125, v124
    v_fma_f32 v117, v117, v125, v124
    v_mul_f32 v112, v112, v108
    v_mul_f32 v116, v116, v110
    v_mul_f32 v113, v113, v109
    v_mul_f32 v117, v117, v111
    v_exp_f32 v114, -v112
    v_exp_f32 v118, -v116
    v_exp_f32 v115, -v113
    v_exp_f32 v119, -v117
    v_fma_f32 v114, v114, v122, v122
    v_fma_f32 v118, v118, v122, v122
    v_fma_f32 v115, v115, v122, v122
    v_fma_f32 v119, v119, v122, v122
    v_rcp_f32 v114, v114
    v_rcp_f32 v118, v118
    v_rcp_f32 v115, v115
    v_rcp_f32 v119, v119
    v_mul_f32 v108, v108, v114
    v_mul_f32 v110, v110, v118
    v_mul_f32 v109, v109, v115
    v_mul_f32 v111, v111, v119
    v_cvt_pk_bf16_f32 v102, v108, v109
    v_cvt_pk_bf16_f32 v103, v110, v111
    s_add_u32 s99, s98, 8192
    s_cmp_eq_u32 s52, 0
    s_cbranch_scc1 Lst_safec_47
    buffer_store_dwordx4 v[96:99], v7, s[4:7], s99 offen
    buffer_store_dwordx4 v[100:103], v7, s[4:7], s99 offen offset:1024
    s_branch Lst_donec_46
Lst_safec_47:
    buffer_store_dwordx4 v[96:99], v7, s[4:7], s99 offen sc1
    buffer_store_dwordx4 v[100:103], v7, s[4:7], s99 offen offset:1024 sc1
Lst_donec_46:
    ds_write_b128 v120, v[32:35] offset:0
    ds_write_b128 v120, v[36:39] offset:1024
    s_waitcnt lgkmcnt(0)
    v_mov_b32 v32, v40
    v_mov_b32 v33, v41
    v_mov_b32 v34, v42
    v_mov_b32 v35, v43
    v_mov_b32 v36, v44
    v_mov_b32 v37, v45
    v_mov_b32 v38, v46
    v_mov_b32 v39, v47
    s_waitcnt vmcnt(2)
    v_mov_b32 v80, v88
    v_mov_b32 v81, v89
    v_mov_b32 v82, v90
    v_mov_b32 v83, v91
    v_mov_b32 v84, v92
    v_mov_b32 v85, v93
    v_mov_b32 v86, v94
    v_mov_b32 v87, v95
Lksj_45:
    s_barrier
    ds_read_b128 v[104:107], v121 offset:0
    ds_read_b128 v[108:111], v121 offset:1024
    s_waitcnt lgkmcnt(0)
    v_pk_add_f32 v[32:33], v[32:33], v[104:105]
    v_pk_add_f32 v[34:35], v[34:35], v[106:107]
    v_pk_add_f32 v[36:37], v[36:37], v[108:109]
    v_pk_add_f32 v[38:39], v[38:39], v[110:111]
    s_waitcnt vmcnt(2)
    v_pk_fma_f32 v[96:97], v[80:81], v[126:127], v[32:33] op_sel_hi:[1,0,1]
    v_pk_fma_f32 v[98:99], v[82:83], v[126:127], v[34:35] op_sel_hi:[1,0,1]
    v_pk_fma_f32 v[100:101], v[84:85], v[126:127], v[36:37] op_sel_hi:[1,0,1]
    v_pk_fma_f32 v[102:103], v[86:87], v[126:127], v[38:39] op_sel_hi:[1,0,1]
    v_pk_mul_f32 v[112:113], v[96:97], v[96:97]
    v_pk_mul_f32 v[116:117], v[98:99], v[98:99]
    v_pk_fma_f32 v[112:113], v[112:113], v[124:125], v[124:125] op_sel:[0,1,0] op_sel_hi:[1,1,0]
    v_pk_fma_f32 v[116:117], v[116:117], v[124:125], v[124:125] op_sel:[0,1,0] op_sel_hi:[1,1,0]
    v_pk_mul_f32 v[112:113], v[112:113], v[96:97]
    v_pk_mul_f32 v[116:117], v[116:117], v[98:99]
    v_exp_f32 v114, -v112
    v_exp_f32 v118, -v116
    v_exp_f32 v115, -v113
    v_exp_f32 v119, -v117
    v_pk_fma_f32 v[114:115], v[114:115], v[122:123], v[122:123] op_sel_hi:[1,0,0]
    v_pk_fma_f32 v[118:119], v[118:119], v[122:123], v[122:123] op_sel_hi:[1,0,0]
    v_rcp_f32 v114, v114
    v_rcp_f32 v118, v118
    v_rcp_f32 v115, v115
    v_rcp_f32 v119, v119
    v_pk_mul_f32 v[96:97], v[96:97], v[114:115]
    v_pk_mul_f32 v[98:99], v[98:99], v[118:119]
    v_cvt_pk_bf16_f32 v96, v96, v97
    v_cvt_pk_bf16_f32 v97, v98, v99
    v_pk_mul_f32 v[112:113], v[100:101], v[100:101]
    v_pk_mul_f32 v[116:117], v[102:103], v[102:103]
    v_pk_fma_f32 v[112:113], v[112:113], v[124:125], v[124:125] op_sel:[0,1,0] op_sel_hi:[1,1,0]
    v_pk_fma_f32 v[116:117], v[116:117], v[124:125], v[124:125] op_sel:[0,1,0] op_sel_hi:[1,1,0]
    v_pk_mul_f32 v[112:113], v[112:113], v[100:101]
    v_pk_mul_f32 v[116:117], v[116:117], v[102:103]
    v_exp_f32 v114, -v112
    v_exp_f32 v118, -v116
    v_exp_f32 v115, -v113
    v_exp_f32 v119, -v117
    v_pk_fma_f32 v[114:115], v[114:115], v[122:123], v[122:123] op_sel_hi:[1,0,0]
    v_pk_fma_f32 v[118:119], v[118:119], v[122:123], v[122:123] op_sel_hi:[1,0,0]
    v_rcp_f32 v114, v114
    v_rcp_f32 v118, v118
    v_rcp_f32 v115, v115
    v_rcp_f32 v119, v119
    v_pk_mul_f32 v[100:101], v[100:101], v[114:115]
    v_pk_mul_f32 v[102:103], v[102:103], v[118:119]
    v_cvt_pk_bf16_f32 v98, v100, v101
    v_cvt_pk_bf16_f32 v99, v102, v103
    s_lshl_b32 s56, s75, 10
    s_sub_u32 s99, s98, s56
    s_add_u32 s99, s99, 12288
    s_cmp_eq_u32 s52, 0
    s_cbranch_scc1 Lst_safe_48
    buffer_store_dwordx4 v[96:99], v7, s[4:7], s99 offen
    s_branch Lst_done_49
Lst_safe_48:
    buffer_store_dwordx4 v[96:99], v7, s[4:7], s99 offen sc1
Lst_done_49:
    s_waitcnt vmcnt(0)
    s_barrier
    s_add_u32 s56, s51, s74
    s_mul_i32 s56, s56, 32
    s_lshl_b32 s63, s47, 2
    s_add_u32 s56, s56, s63
    s_lshl_b32 s63, s75, 1
    s_add_u32 s56, s56, s63
    s_lshl_b32 s56, s56, 10
    s_add_u32 s56, s56, s50
    s_add_u32 s56, s56, 8388608
    buffer_load_dwordx4 v[80:83], v7, s[4:7], s56 offen sc1
    buffer_load_dwordx4 v[84:87], v7, s[4:7], s56 offen offset:1024 sc1
    s_add_u32 s56, s51, s74
    s_mul_i32 s56, s56, 32
    s_lshl_b32 s63, s47, 2
    s_add_u32 s56, s56, s63
    s_lshl_b32 s63, s75, 1
    s_add_u32 s56, s56, s63
    s_lshl_b32 s56, s56, 10
    s_add_u32 s56, s56, s50
    s_add_u32 s56, s56, 12582912
    buffer_load_dwordx4 v[88:91], v7, s[4:7], s56 offen sc1
    buffer_load_dwordx4 v[92:95], v7, s[4:7], s56 offen offset:1024 sc1
    s_add_u32 s98, s51, s74
    s_mul_i32 s98, s98, 32
    s_lshl_b32 s63, s47, 2
    s_add_u32 s98, s98, s63
    s_lshl_b32 s63, s75, 1
    s_add_u32 s98, s98, s63
    s_lshl_b32 s98, s98, 10
    s_add_u32 s98, s98, s50
    s_add_u32 s98, s98, 14680064
    s_add_u32 s99, s51, s74
    s_lshl_b32 s99, s99, 4
    s_lshl_b32 s57, s47, 1
    s_add_u32 s99, s99, s57
    s_add_u32 s99, s99, s75
    s_lshl_b32 s99, s99, 8
    s_add_u32 s99, s99, s50
    s_add_u32 s99, s99, 25690112
    s_lshl_b32 s56, s75, 12
    v_add_u32 v15, s56, v7
    ds_read_b128 v[160:163], v15 offset:0
    ds_read_b128 v[164:167], v15 offset:1024
    ds_read_b128 v[168:171], v15 offset:2048
    ds_read_b128 v[172:175], v15 offset:3072
    ds_read_b128 v[176:179], v15 offset:8192
    ds_read_b128 v[180:183], v15 offset:9216
    ds_read_b128 v[184:187], v15 offset:10240
    ds_read_b128 v[188:191], v15 offset:11264
    s_waitcnt lgkmcnt(4)
    ds_read_b128 v[192:195], v15 offset:16384
    ds_read_b128 v[196:199], v15 offset:17408
    ds_read_b128 v[200:203], v15 offset:18432
    ds_read_b128 v[204:207], v15 offset:19456
    ds_read_b128 v[208:211], v15 offset:24576
    ds_read_b128 v[212:215], v15 offset:25600
    ds_read_b128 v[216:219], v15 offset:26624
    ds_read_b128 v[220:223], v15 offset:27648
    s_waitcnt lgkmcnt(4)
    ds_read_b128 v[224:227], v15 offset:32768
    ds_read_b128 v[228:231], v15 offset:33792
    ds_read_b128 v[232:235], v15 offset:34816
    ds_read_b128 v[236:239], v15 offset:35840
    ds_read_b128 v[240:243], v15 offset:40960
    ds_read_b128 v[244:247], v15 offset:41984
    ds_read_b128 v[248:251], v15 offset:43008
    ds_read_b128 v[252:255], v15 offset:44032
    s_waitcnt lgkmcnt(4)
    ds_read_b128 v[32:35], v15 offset:49152
    ds_read_b128 v[36:39], v15 offset:50176
    ds_read_b128 v[40:43], v15 offset:51200
    ds_read_b128 v[44:47], v15 offset:52224
    s_waitcnt vmcnt(0)
    v_lshlrev_b32 v16, 16, v80
    v_and_b32 v17, 0xffff0000, v80
    v_lshlrev_b32 v18, 16, v81
    v_and_b32 v19, 0xffff0000, v81
    v_lshlrev_b32 v20, 16, v82
    v_and_b32 v21, 0xffff0000, v82
    v_lshlrev_b32 v22, 16, v83
    v_and_b32 v23, 0xffff0000, v83
    v_lshlrev_b32 v24, 16, v84
    v_and_b32 v25, 0xffff0000, v84
    v_lshlrev_b32 v26, 16, v85
    v_and_b32 v27, 0xffff0000, v85
    v_lshlrev_b32 v28, 16, v86
    v_and_b32 v29, 0xffff0000, v86
    v_lshlrev_b32 v30, 16, v87
    v_and_b32 v31, 0xffff0000, v87
    v_lshlrev_b32 v96, 16, v88
    v_and_b32 v97, 0xffff0000, v88
    v_lshlrev_b32 v98, 16, v89
    v_and_b32 v99, 0xffff0000, v89
    v_lshlrev_b32 v100, 16, v90
    v_and_b32 v101, 0xffff0000, v90
    v_lshlrev_b32 v102, 16, v91
    v_and_b32 v103, 0xffff0000, v91
    v_lshlrev_b32 v104, 16, v92
    v_and_b32 v105, 0xffff0000, v92
    v_lshlrev_b32 v106, 16, v93
    v_and_b32 v107, 0xffff0000, v93
    v_lshlrev_b32 v108, 16, v94
    v_and_b32 v109, 0xffff0000, v94
    v_lshlrev_b32 v110, 16, v95
    v_and_b32 v111, 0xffff0000, v95
    v_pk_add_f32 v[16:17], v[16:17], v[96:97]
    v_pk_add_f32 v[18:19], v[18:19], v[98:99]
    v_pk_add_f32 v[20:21], v[20:21], v[100:101]
    v_pk_add_f32 v[22:23], v[22:23], v[102:103]
    v_pk_add_f32 v[24:25], v[24:25], v[104:105]
    v_pk_add_f32 v[26:27], v[26:27], v[106:107]
    v_pk_add_f32 v[28:29], v[28:29], v[108:109]
    v_pk_add_f32 v[30:31], v[30:31], v[110:111]
    s_waitcnt lgkmcnt(0)
    s_barrier
    s_barrier
    ds_read_b128 v[48:51], v6 offset:0
    ds_read_b128 v[128:131], v2 offset:0
    ds_read_b128 v[52:55], v6 offset:1024
    ds_read_b128 v[132:135], v2 offset:1040
    ds_read_b128 v[56:59], v6 offset:2048
    ds_read_b128 v[136:139], v2 offset:2080
    ds_read_b128 v[60:63], v6 offset:3072
    ds_read_b128 v[140:143], v2 offset:3120
    s_barrier
    s_waitcnt lgkmcnt(2)
    v_mfma_f32_32x32x16_bf16 v[16:31], v[48:51], v[128:131], v[16:31]
    ds_read_b128 v[64:67], v6 offset:8192
    ds_read_b128 v[144:147], v2 offset:4160
    v_mfma_f32_32x32x16_bf16 v[16:31], v[52:55], v[132:135], v[16:31]
    ds_read_b128 v[68:71], v6 offset:9216
    ds_read_b128 v[148:151], v2 offset:5200
    v_mfma_f32_32x32x16_bf16 v[16:31], v[56:59], v[136:139], v[16:31]
    ds_read_b128 v[72:75], v6 offset:10240
    ds_read_b128 v[152:155], v2 offset:6240
    s_waitcnt lgkmcnt(6)
    v_mfma_f32_32x32x16_bf16 v[16:31], v[60:63], v[140:143], v[16:31]
    ds_read_b128 v[76:79], v6 offset:11264
    ds_read_b128 v[156:159], v2 offset:7280
    s_barrier
    s_waitcnt lgkmcnt(2)
    v_mfma_f32_32x32x16_bf16 v[16:31], v[64:67], v[144:147], v[16:31]
    ds_read_b128 v[48:51], v6 offset:16384
    ds_read_b128 v[128:131], v2 offset:8320
    v_mfma_f32_32x32x16_bf16 v[16:31], v[68:71], v[148:151], v[16:31]
    ds_read_b128 v[52:55], v6 offset:17408
    ds_read_b128 v[132:135], v2 offset:9360
    v_mfma_f32_32x32x16_bf16 v[16:31], v[72:75], v[152:155], v[16:31]
    ds_read_b128 v[56:59], v6 offset:18432
    ds_read_b128 v[136:139], v2 offset:10400
    s_waitcnt lgkmcnt(6)
    v_mfma_f32_32x32x16_bf16 v[16:31], v[76:79], v[156:159], v[16:31]
    ds_read_b128 v[60:63], v6 offset:19456
    ds_read_b128 v[140:143], v2 offset:11440
    s_barrier
    s_waitcnt lgkmcnt(2)
    v_mfma_f32_32x32x16_bf16 v[16:31], v[48:51], v[128:131], v[16:31]
    ds_read_b128 v[64:67], v5 offset:0
    ds_read_b128 v[144:147], v2 offset:12480
    v_mfma_f32_32x32x16_bf16 v[16:31], v[52:55], v[132:135], v[16:31]
    ds_read_b128 v[68:71], v5 offset:1024
    ds_read_b128 v[148:151], v2 offset:13520
    v_mfma_f32_32x32x16_bf16 v[16:31], v[56:59], v[136:139], v[16:31]
    ds_read_b128 v[72:75], v5 offset:2048
    ds_read_b128 v[152:155], v2 offset:14560
    s_waitcnt lgkmcnt(6)
    v_mfma_f32_32x32x16_bf16 v[16:31], v[60:63], v[140:143], v[16:31]
    ds_read_b128 v[76:79], v5 offset:3072
    ds_read_b128 v[156:159], v2 offset:15600
    s_barrier
    s_waitcnt lgkmcnt(2)
    v_mfma_f32_32x32x16_bf16 v[16:31], v[64:67], v[144:147], v[16:31]
    ds_read_b128 v[48:51], v5 offset:8192
    ds_read_b128 v[128:131], v2 offset:16640
    v_mfma_f32_32x32x16_bf16 v[16:31], v[68:71], v[148:151], v[16:31]
    ds_read_b128 v[52:55], v5 offset:9216
    ds_read_b128 v[132:135], v2 offset:17680
    v_mfma_f32_32x32x16_bf16 v[16:31], v[72:75], v[152:155], v[16:31]
    ds_read_b128 v[56:59], v5 offset:10240
    ds_read_b128 v[136:139], v2 offset:18720
    s_waitcnt lgkmcnt(6)
    v_mfma_f32_32x32x16_bf16 v[16:31], v[76:79], v[156:159], v[16:31]
    ds_read_b128 v[60:63], v5 offset:11264
    ds_read_b128 v[140:143], v2 offset:19760
    s_barrier
    s_waitcnt lgkmcnt(2)
    v_mfma_f32_32x32x16_bf16 v[16:31], v[48:51], v[128:131], v[16:31]
    ds_read_b128 v[64:67], v5 offset:16384
    ds_read_b128 v[144:147], v2 offset:20800
    v_mfma_f32_32x32x16_bf16 v[16:31], v[52:55], v[132:135], v[16:31]
    ds_read_b128 v[68:71], v5 offset:17408
    ds_read_b128 v[148:151], v2 offset:21840
    v_mfma_f32_32x32x16_bf16 v[16:31], v[56:59], v[136:139], v[16:31]
    ds_read_b128 v[72:75], v5 offset:18432
    ds_read_b128 v[152:155], v2 offset:22880
    s_waitcnt lgkmcnt(6)
    v_mfma_f32_32x32x16_bf16 v[16:31], v[60:63], v[140:143], v[16:31]
    ds_read_b128 v[76:79], v5 offset:19456
    ds_read_b128 v[156:159], v2 offset:23920
    s_barrier
    s_waitcnt lgkmcnt(2)
    v_mfma_f32_32x32x16_bf16 v[16:31], v[64:67], v[144:147], v[16:31]
    ds_read_b128 v[48:51], v5 offset:24576
    ds_read_b128 v[128:131], v2 offset:24960
    v_mfma_f32_32x32x16_bf16 v[16:31], v[68:71], v[148:151], v[16:31]
    ds_read_b128 v[52:55], v5 offset:25600
    ds_read_b128 v[132:135], v2 offset:26000
    v_mfma_f32_32x32x16_bf16 v[16:31], v[72:75], v[152:155], v[16:31]
    ds_read_b128 v[56:59], v5 offset:26624
    ds_read_b128 v[136:139], v2 offset:27040
    s_waitcnt lgkmcnt(6)
    v_mfma_f32_32x32x16_bf16 v[16:31], v[76:79], v[156:159], v[16:31]
    ds_read_b128 v[60:63], v5 offset:27648
    ds_read_b128 v[140:143], v2 offset:28080
    s_barrier
    s_waitcnt lgkmcnt(2)
    v_mfma_f32_32x32x16_bf16 v[16:31], v[48:51], v[128:131], v[16:31]
    ds_read_b128 v[64:67], v5 offset:32768
    ds_read_b128 v[144:147], v2 offset:29120
    v_mfma_f32_32x32x16_bf16 v[16:31], v[52:55], v[132:135], v[16:31]
    ds_read_b128 v[68:71], v5 offset:33792
    ds_read_b128 v[148:151], v2 offset:30160
    v_mfma_f32_32x32x16_bf16 v[16:31], v[56:59], v[136:139], v[16:31]
    ds_read_b128 v[72:75], v5 offset:34816
    ds_read_b128 v[152:155], v2 offset:31200
    s_waitcnt lgkmcnt(6)
    v_mfma_f32_32x32x16_bf16 v[16:31], v[60:63], v[140:143], v[16:31]
    ds_read_b128 v[76:79], v5 offset:35840
    ds_read_b128 v[156:159], v2 offset:32240
    s_barrier
    s_waitcnt lgkmcnt(2)
    v_mfma_f32_32x32x16_bf16 v[16:31], v[64:67], v[144:147], v[16:31]
    ds_read_b128 v[48:51], v5 offset:40960
    ds_read_b128 v[128:131], v2 offset:0
    v_mfma_f32_32x32x16_bf16 v[16:31], v[68:71], v[148:151], v[16:31]
    ds_read_b128 v[52:55], v5 offset:41984
    ds_read_b128 v[132:135], v2 offset:1040
    v_mfma_f32_32x32x16_bf16 v[16:31], v[72:75], v[152:155], v[16:31]
    ds_read_b128 v[56:59], v5 offset:43008
    ds_read_b128 v[136:139], v2 offset:2080
    s_waitcnt lgkmcnt(6)
    v_mfma_f32_32x32x16_bf16 v[16:31], v[76:79], v[156:159], v[16:31]
    ds_read_b128 v[60:63], v5 offset:44032
    ds_read_b128 v[140:143], v2 offset:3120
    s_barrier
    s_waitcnt lgkmcnt(2)
    v_mfma_f32_32x32x16_bf16 v[16:31], v[48:51], v[128:131], v[16:31]
    ds_read_b128 v[64:67], v5 offset:49152
    ds_read_b128 v[144:147], v2 offset:4160
    v_mfma_f32_32x32x16_bf16 v[16:31], v[52:55], v[132:135], v[16:31]
    ds_read_b128 v[68:71], v5 offset:50176
    ds_read_b128 v[148:151], v2 offset:5200
    v_mfma_f32_32x32x16_bf16 v[16:31], v[56:59], v[136:139], v[16:31]
    ds_read_b128 v[72:75], v5 offset:51200
    ds_read_b128 v[152:155], v2 offset:6240
    s_waitcnt lgkmcnt(6)
    v_mfma_f32_32x32x16_bf16 v[16:31], v[60:63], v[140:143], v[16:31]
    ds_read_b128 v[76:79], v5 offset:52224
    ds_read_b128 v[156:159], v2 offset:7280
    s_barrier
    s_waitcnt lgkmcnt(2)
    v_mfma_f32_32x32x16_bf16 v[16:31], v[64:67], v[144:147], v[16:31]
    ds_read_b128 v[48:51], v5 offset:57344
    ds_read_b128 v[128:131], v2 offset:8320
    v_mfma_f32_32x32x16_bf16 v[16:31], v[68:71], v[148:151], v[16:31]
    ds_read_b128 v[52:55], v5 offset:58368
    ds_read_b128 v[132:135], v2 offset:9360
    v_mfma_f32_32x32x16_bf16 v[16:31], v[72:75], v[152:155], v[16:31]
    ds_read_b128 v[56:59], v5 offset:59392
    ds_read_b128 v[136:139], v2 offset:10400
    s_waitcnt lgkmcnt(6)
    v_mfma_f32_32x32x16_bf16 v[16:31], v[76:79], v[156:159], v[16:31]
    ds_read_b128 v[60:63], v5 offset:60416
    ds_read_b128 v[140:143], v2 offset:11440
    s_barrier
    s_waitcnt lgkmcnt(2)
    v_mfma_f32_32x32x16_bf16 v[16:31], v[48:51], v[128:131], v[16:31]
    ds_read_b128 v[144:147], v2 offset:12480
    v_mfma_f32_32x32x16_bf16 v[16:31], v[52:55], v[132:135], v[16:31]
    ds_read_b128 v[148:151], v2 offset:13520
    v_mfma_f32_32x32x16_bf16 v[16:31], v[56:59], v[136:139], v[16:31]
    ds_read_b128 v[152:155], v2 offset:14560
    s_waitcnt lgkmcnt(3)
    v_mfma_f32_32x32x16_bf16 v[16:31], v[60:63], v[140:143], v[16:31]
    ds_read_b128 v[156:159], v2 offset:15600
    s_barrier
    s_waitcnt lgkmcnt(1)
    v_mfma_f32_32x32x16_bf16 v[16:31], v[160:163], v[144:147], v[16:31]
    ds_read_b128 v[128:131], v2 offset:16640
    v_mfma_f32_32x32x16_bf16 v[16:31], v[164:167], v[148:151], v[16:31]
    ds_read_b128 v[132:135], v2 offset:17680
    v_mfma_f32_32x32x16_bf16 v[16:31], v[168:171], v[152:155], v[16:31]
    ds_read_b128 v[136:139], v2 offset:18720
    s_waitcnt lgkmcnt(3)
    v_mfma_f32_32x32x16_bf16 v[16:31], v[172:175], v[156:159], v[16:31]
    ds_read_b128 v[140:143], v2 offset:19760
    s_barrier
    s_waitcnt lgkmcnt(1)
    v_mfma_f32_32x32x16_bf16 v[16:31], v[176:179], v[128:131], v[16:31]
    ds_read_b128 v[144:147], v2 offset:20800
    v_mfma_f32_32x32x16_bf16 v[16:31], v[180:183], v[132:135], v[16:31]
    ds_read_b128 v[148:151], v2 offset:21840
    v_mfma_f32_32x32x16_bf16 v[16:31], v[184:187], v[136:139], v[16:31]
    ds_read_b128 v[152:155], v2 offset:22880
    s_waitcnt lgkmcnt(3)
    v_mfma_f32_32x32x16_bf16 v[16:31], v[188:191], v[140:143], v[16:31]
    ds_read_b128 v[156:159], v2 offset:23920
    s_barrier
    s_waitcnt lgkmcnt(1)
    v_mfma_f32_32x32x16_bf16 v[16:31], v[192:195], v[144:147], v[16:31]
    ds_read_b128 v[128:131], v2 offset:24960
    v_mfma_f32_32x32x16_bf16 v[16:31], v[196:199], v[148:151], v[16:31]
    ds_read_b128 v[132:135], v2 offset:26000
    v_mfma_f32_32x32x16_bf16 v[16:31], v[200:203], v[152:155], v[16:31]
    ds_read_b128 v[136:139], v2 offset:27040
    s_waitcnt lgkmcnt(3)
    v_mfma_f32_32x32x16_bf16 v[16:31], v[204:207], v[156:159], v[16:31]
    ds_read_b128 v[140:143], v2 offset:28080
    s_barrier
    s_waitcnt lgkmcnt(1)
    v_mfma_f32_32x32x16_bf16 v[16:31], v[208:211], v[128:131], v[16:31]
    ds_read_b128 v[144:147], v2 offset:29120
    v_mfma_f32_32x32x16_bf16 v[16:31], v[212:215], v[132:135], v[16:31]
    ds_read_b128 v[148:151], v2 offset:30160
    v_mfma_f32_32x32x16_bf16 v[16:31], v[216:219], v[136:139], v[16:31]
    ds_read_b128 v[152:155], v2 offset:31200
    s_waitcnt lgkmcnt(3)
    v_mfma_f32_32x32x16_bf16 v[16:31], v[220:223], v[140:143], v[16:31]
    ds_read_b128 v[156:159], v2 offset:32240
    s_barrier
    s_waitcnt lgkmcnt(1)
    v_mfma_f32_32x32x16_bf16 v[16:31], v[224:227], v[144:147], v[16:31]
    ds_read_b128 v[128:131], v2 offset:0
    v_mfma_f32_32x32x16_bf16 v[16:31], v[228:231], v[148:151], v[16:31]
    ds_read_b128 v[132:135], v2 offset:1040
    v_mfma_f32_32x32x16_bf16 v[16:31], v[232:235], v[152:155], v[16:31]
    ds_read_b128 v[136:139], v2 offset:2080
    s_waitcnt lgkmcnt(3)
    v_mfma_f32_32x32x16_bf16 v[16:31], v[236:239], v[156:159], v[16:31]
    ds_read_b128 v[140:143], v2 offset:3120
    s_barrier
    s_waitcnt lgkmcnt(1)
    v_mfma_f32_32x32x16_bf16 v[16:31], v[240:243], v[128:131], v[16:31]
    ds_read_b128 v[144:147], v2 offset:4160
    v_mfma_f32_32x32x16_bf16 v[16:31], v[244:247], v[132:135], v[16:31]
    ds_read_b128 v[148:151], v2 offset:5200
    v_mfma_f32_32x32x16_bf16 v[16:31], v[248:251], v[136:139], v[16:31]
    ds_read_b128 v[152:155], v2 offset:6240
    s_waitcnt lgkmcnt(3)
    v_mfma_f32_32x32x16_bf16 v[16:31], v[252:255], v[140:143], v[16:31]
    ds_read_b128 v[156:159], v2 offset:7280
    s_barrier
    s_waitcnt lgkmcnt(1)
    v_mfma_f32_32x32x16_bf16 v[16:31], v[32:35], v[144:147], v[16:31]
    ds_read_b128 v[48:51], v6 offset:0
    ds_read_b128 v[128:131], v2 offset:8320
    v_mfma_f32_32x32x16_bf16 v[16:31], v[36:39], v[148:151], v[16:31]
    ds_read_b128 v[52:55], v6 offset:1024
    ds_read_b128 v[132:135], v2 offset:9360
    v_mfma_f32_32x32x16_bf16 v[16:31], v[40:43], v[152:155], v[16:31]
    ds_read_b128 v[56:59], v6 offset:2048
    ds_read_b128 v[136:139], v2 offset:10400
    s_waitcnt lgkmcnt(6)
    v_mfma_f32_32x32x16_bf16 v[16:31], v[44:47], v[156:159], v[16:31]
    ds_read_b128 v[60:63], v6 offset:3072
    ds_read_b128 v[140:143], v2 offset:11440
    s_barrier
    s_waitcnt lgkmcnt(2)
    v_mfma_f32_32x32x16_bf16 v[16:31], v[48:51], v[128:131], v[16:31]
    ds_read_b128 v[64:67], v6 offset:8192
    ds_read_b128 v[144:147], v2 offset:12480
    v_mfma_f32_32x32x16_bf16 v[16:31], v[52:55], v[132:135], v[16:31]
    ds_read_b128 v[68:71], v6 offset:9216
    ds_read_b128 v[148:151], v2 offset:13520
    v_mfma_f32_32x32x16_bf16 v[16:31], v[56:59], v[136:139], v[16:31]
    ds_read_b128 v[72:75], v6 offset:10240
    ds_read_b128 v[152:155], v2 offset:14560
    s_waitcnt lgkmcnt(6)
    v_mfma_f32_32x32x16_bf16 v[16:31], v[60:63], v[140:143], v[16:31]
    ds_read_b128 v[76:79], v6 offset:11264
    ds_read_b128 v[156:159], v2 offset:15600
    s_barrier
    s_waitcnt lgkmcnt(2)
    v_mfma_f32_32x32x16_bf16 v[16:31], v[64:67], v[144:147], v[16:31]
    ds_read_b128 v[48:51], v6 offset:16384
    ds_read_b128 v[128:131], v2 offset:16640
    v_mfma_f32_32x32x16_bf16 v[16:31], v[68:71], v[148:151], v[16:31]
    ds_read_b128 v[52:55], v6 offset:17408
    ds_read_b128 v[132:135], v2 offset:17680
    v_mfma_f32_32x32x16_bf16 v[16:31], v[72:75], v[152:155], v[16:31]
    ds_read_b128 v[56:59], v6 offset:18432
    ds_read_b128 v[136:139], v2 offset:18720
    s_waitcnt lgkmcnt(6)
    v_mfma_f32_32x32x16_bf16 v[16:31], v[76:79], v[156:159], v[16:31]
    ds_read_b128 v[60:63], v6 offset:19456
    ds_read_b128 v[140:143], v2 offset:19760
    s_barrier
    s_waitcnt lgkmcnt(2)
    v_mfma_f32_32x32x16_bf16 v[16:31], v[48:51], v[128:131], v[16:31]
    ds_read_b128 v[64:67], v5 offset:0
    ds_read_b128 v[144:147], v2 offset:20800
    v_mfma_f32_32x32x16_bf16 v[16:31], v[52:55], v[132:135], v[16:31]
    ds_read_b128 v[68:71], v5 offset:1024
    ds_read_b128 v[148:151], v2 offset:21840
    v_mfma_f32_32x32x16_bf16 v[16:31], v[56:59], v[136:139], v[16:31]
    ds_read_b128 v[72:75], v5 offset:2048
    ds_read_b128 v[152:155], v2 offset:22880
    s_waitcnt lgkmcnt(6)
    v_mfma_f32_32x32x16_bf16 v[16:31], v[60:63], v[140:143], v[16:31]
    ds_read_b128 v[76:79], v5 offset:3072
    ds_read_b128 v[156:159], v2 offset:23920
    s_barrier
    s_waitcnt lgkmcnt(2)
    v_mfma_f32_32x32x16_bf16 v[16:31], v[64:67], v[144:147], v[16:31]
    ds_read_b128 v[48:51], v5 offset:8192
    ds_read_b128 v[128:131], v2 offset:24960
    v_mfma_f32_32x32x16_bf16 v[16:31], v[68:71], v[148:151], v[16:31]
    ds_read_b128 v[52:55], v5 offset:9216
    ds_read_b128 v[132:135], v2 offset:26000
    v_mfma_f32_32x32x16_bf16 v[16:31], v[72:75], v[152:155], v[16:31]
    ds_read_b128 v[56:59], v5 offset:10240
    ds_read_b128 v[136:139], v2 offset:27040
    s_waitcnt lgkmcnt(6)
    v_mfma_f32_32x32x16_bf16 v[16:31], v[76:79], v[156:159], v[16:31]
    ds_read_b128 v[60:63], v5 offset:11264
    ds_read_b128 v[140:143], v2 offset:28080
    s_barrier
    s_waitcnt lgkmcnt(2)
    v_mfma_f32_32x32x16_bf16 v[16:31], v[48:51], v[128:131], v[16:31]
    ds_read_b128 v[64:67], v5 offset:16384
    ds_read_b128 v[144:147], v2 offset:29120
    v_mfma_f32_32x32x16_bf16 v[16:31], v[52:55], v[132:135], v[16:31]
    ds_read_b128 v[68:71], v5 offset:17408
    ds_read_b128 v[148:151], v2 offset:30160
    v_mfma_f32_32x32x16_bf16 v[16:31], v[56:59], v[136:139], v[16:31]
    ds_read_b128 v[72:75], v5 offset:18432
    ds_read_b128 v[152:155], v2 offset:31200
    s_waitcnt lgkmcnt(6)
    v_mfma_f32_32x32x16_bf16 v[16:31], v[60:63], v[140:143], v[16:31]
    ds_read_b128 v[76:79], v5 offset:19456
    ds_read_b128 v[156:159], v2 offset:32240
    s_barrier
    s_waitcnt lgkmcnt(2)
    v_mfma_f32_32x32x16_bf16 v[16:31], v[64:67], v[144:147], v[16:31]
    ds_read_b128 v[48:51], v5 offset:24576
    ds_read_b128 v[128:131], v2 offset:0
    v_mfma_f32_32x32x16_bf16 v[16:31], v[68:71], v[148:151], v[16:31]
    ds_read_b128 v[52:55], v5 offset:25600
    ds_read_b128 v[132:135], v2 offset:1040
    v_mfma_f32_32x32x16_bf16 v[16:31], v[72:75], v[152:155], v[16:31]
    ds_read_b128 v[56:59], v5 offset:26624
    ds_read_b128 v[136:139], v2 offset:2080
    s_waitcnt lgkmcnt(6)
    v_mfma_f32_32x32x16_bf16 v[16:31], v[76:79], v[156:159], v[16:31]
    ds_read_b128 v[60:63], v5 offset:27648
    ds_read_b128 v[140:143], v2 offset:3120
    s_barrier
    s_waitcnt lgkmcnt(2)
    v_mfma_f32_32x32x16_bf16 v[16:31], v[48:51], v[128:131], v[16:31]
    ds_read_b128 v[64:67], v5 offset:32768
    ds_read_b128 v[144:147], v2 offset:4160
    v_mfma_f32_32x32x16_bf16 v[16:31], v[52:55], v[132:135], v[16:31]
    ds_read_b128 v[68:71], v5 offset:33792
    ds_read_b128 v[148:151], v2 offset:5200
    v_mfma_f32_32x32x16_bf16 v[16:31], v[56:59], v[136:139], v[16:31]
    ds_read_b128 v[72:75], v5 offset:34816
    ds_read_b128 v[152:155], v2 offset:6240
    s_waitcnt lgkmcnt(6)
    v_mfma_f32_32x32x16_bf16 v[16:31], v[60:63], v[140:143], v[16:31]
    ds_read_b128 v[76:79], v5 offset:35840
    ds_read_b128 v[156:159], v2 offset:7280
    s_barrier
    s_waitcnt lgkmcnt(2)
    v_mfma_f32_32x32x16_bf16 v[16:31], v[64:67], v[144:147], v[16:31]
    ds_read_b128 v[48:51], v5 offset:40960
    ds_read_b128 v[128:131], v2 offset:8320
    v_mfma_f32_32x32x16_bf16 v[16:31], v[68:71], v[148:151], v[16:31]
    ds_read_b128 v[52:55], v5 offset:41984
    ds_read_b128 v[132:135], v2 offset:9360
    v_mfma_f32_32x32x16_bf16 v[16:31], v[72:75], v[152:155], v[16:31]
    ds_read_b128 v[56:59], v5 offset:43008
    ds_read_b128 v[136:139], v2 offset:10400
    s_waitcnt lgkmcnt(6)
    v_mfma_f32_32x32x16_bf16 v[16:31], v[76:79], v[156:159], v[16:31]
    ds_read_b128 v[60:63], v5 offset:44032
    ds_read_b128 v[140:143], v2 offset:11440
    s_barrier
    s_waitcnt lgkmcnt(2)
    v_mfma_f32_32x32x16_bf16 v[16:31], v[48:51], v[128:131], v[16:31]
    ds_read_b128 v[64:67], v5 offset:49152
    ds_read_b128 v[144:147], v2 offset:12480
    v_mfma_f32_32x32x16_bf16 v[16:31], v[52:55], v[132:135], v[16:31]
    ds_read_b128 v[68:71], v5 offset:50176
    ds_read_b128 v[148:151], v2 offset:13520
    v_mfma_f32_32x32x16_bf16 v[16:31], v[56:59], v[136:139], v[16:31]
    ds_read_b128 v[72:75], v5 offset:51200
    ds_read_b128 v[152:155], v2 offset:14560
    s_waitcnt lgkmcnt(6)
    v_mfma_f32_32x32x16_bf16 v[16:31], v[60:63], v[140:143], v[16:31]
    ds_read_b128 v[76:79], v5 offset:52224
    ds_read_b128 v[156:159], v2 offset:15600
    s_waitcnt lgkmcnt(2)
    v_mfma_f32_32x32x16_bf16 v[16:31], v[64:67], v[144:147], v[16:31]
    v_mfma_f32_32x32x16_bf16 v[16:31], v[68:71], v[148:151], v[16:31]
    v_mfma_f32_32x32x16_bf16 v[16:31], v[72:75], v[152:155], v[16:31]
    s_waitcnt lgkmcnt(0)
    v_mfma_f32_32x32x16_bf16 v[16:31], v[76:79], v[156:159], v[16:31]
    s_nop 11
    v_cvt_pk_bf16_f32 v116, v16, v17
    v_cvt_pk_bf16_f32 v117, v18, v19
    v_cvt_pk_bf16_f32 v118, v20, v21
    v_cvt_pk_bf16_f32 v119, v22, v23
    v_cvt_pk_bf16_f32 v120, v24, v25
    v_cvt_pk_bf16_f32 v121, v26, v27
    v_cvt_pk_bf16_f32 v122, v28, v29
    v_cvt_pk_bf16_f32 v123, v30, v31
    s_cmp_eq_u32 s49, 1
    s_cbranch_scc1 LS7_out_50
    s_cmp_eq_u32 s52, 0
    s_cbranch_scc1 Lst_safe_52
    buffer_store_dwordx4 v[116:119], v7, s[4:7], s98 offen
    buffer_store_dwordx4 v[120:123], v7, s[4:7], s98 offen offset:1024
    s_branch Lst_done_53
Lst_safe_52:
    buffer_store_dwordx4 v[116:119], v7, s[4:7], s98 offen sc1
    buffer_store_dwordx4 v[120:123], v7, s[4:7], s98 offen offset:1024 sc1
Lst_done_53:
    v_pk_add_f32 v[112:113], v[16:17], v[18:19]
    v_pk_mul_f32 v[114:115], v[16:17], v[16:17]
    v_pk_fma_f32 v[114:115], v[18:19], v[18:19], v[114:115]
    v_pk_add_f32 v[112:113], v[112:113], v[20:21]
    v_pk_fma_f32 v[114:115], v[20:21], v[20:21], v[114:115]
    v_pk_add_f32 v[112:113], v[112:113], v[22:23]
    v_pk_fma_f32 v[114:115], v[22:23], v[22:23], v[114:115]
    v_pk_add_f32 v[112:113], v[112:113], v[24:25]
    v_pk_fma_f32 v[114:115], v[24:25], v[24:25], v[114:115]
    v_pk_add_f32 v[112:113], v[112:113], v[26:27]
    v_pk_fma_f32 v[114:115], v[26:27], v[26:27], v[114:115]
    v_pk_add_f32 v[112:113], v[112:113], v[28:29]
    v_pk_fma_f32 v[114:115], v[28:29], v[28:29], v[114:115]
    v_pk_add_f32 v[112:113], v[112:113], v[30:31]
    v_pk_fma_f32 v[114:115], v[30:31], v[30:31], v[114:115]
    v_add_f32 v112, v112, v113
    v_add_f32 v113, v114, v115
    v_mov_b32 v114, v112
    v_mov_b32 v115, v113
    s_nop 0
    v_permlane32_swap_b32 v112, v114
    v_permlane32_swap_b32 v113, v115
    v_add_f32 v112, v112, v114
    v_add_f32 v113, v113, v115
    s_cmp_eq_u32 s52, 0
    s_cbranch_scc1 Lst_safe_54
    buffer_store_dwordx2 v[112:113], v9, s[4:7], s99 offen
    s_branch Lst_done_55
Lst_safe_54:
    buffer_store_dwordx2 v[112:113], v9, s[4:7], s99 offen sc1
Lst_done_55:
    s_branch LS7_j_51
LS7_out_50:
    s_lshl_b32 s56, s51, 15
    s_add_u32 s56, s56, s54
    v_lshrrev_b32 v112, 5, v1
    v_lshlrev_b32 v112, 3, v112
    v_add_u32 v112, v112, v8
    v_permlane32_swap_b32 v116, v118
    v_permlane32_swap_b32 v117, v119
    v_permlane32_swap_b32 v120, v122
    v_permlane32_swap_b32 v121, v123
    buffer_store_dwordx4 v[116:119], v112, s[12:15], s56 offen offset:0
    buffer_store_dwordx4 v[120:123], v112, s[12:15], s56 offen offset:32
LS7_j_51:
    s_waitcnt vmcnt(0)
    s_barrier
    s_cmp_eq_u32 s49, 1
    s_cbranch_scc1 L_END
    s_add_u32 s49, s49, 1
    s_add_u32 s87, s87, 8
    s_branch L_C
L_LA:
    s_setprio 3
    s_cmp_eq_u32 s49, 0
    s_cbranch_scc1 LskipA_56
    s_mul_i32 s91, s51, 32768
    s_add_u32 s91, s91, s50
    s_add_u32 s91, s91, 14680064
    s_add_u32 s56, s87, 4294967295
    s_cmp_lg_u32 s53, 0
    s_cbranch_scc1 Lpoll_done_58
    s_mov_b32 s86, 0x40000
Lpoll_57:
    buffer_load_dword v22, v10, s[4:7], 0 offen sc1
    s_waitcnt vmcnt(0)
    v_cmp_le_u32 vcc, s56, v22
    s_nop 0
    s_and_b64 vcc, vcc, s[68:69]
    s_cmp_eq_u64 vcc, s[68:69]
    s_cbranch_scc1 Lpoll_done_58
    s_sub_u32 s86, s86, 1
    s_cmp_lg_u32 s86, 0
    s_cbranch_scc1 Lpoll_57
    s_mov_b32 s53, 1
Lpoll_done_58:
    s_lshl_b32 s56, s51, 12
    s_add_u32 s56, s56, s50
    s_add_u32 s56, s56, 25690112
    buffer_load_dwordx2 v[24:25], v8, s[4:7], s56 offen offset:0 sc1
    buffer_load_dwordx2 v[26:27], v8, s[4:7], s56 offen offset:256 sc1
    buffer_load_dwordx2 v[28:29], v8, s[4:7], s56 offen offset:512 sc1
    buffer_load_dwordx2 v[30:31], v8, s[4:7], s56 offen offset:768 sc1
    buffer_load_dwordx2 v[32:33], v8, s[4:7], s56 offen offset:1024 sc1
    buffer_load_dwordx2 v[34:35], v8, s[4:7], s56 offen offset:1280 sc1
    buffer_load_dwordx2 v[36:37], v8, s[4:7], s56 offen offset:1536 sc1
    buffer_load_dwordx2 v[38:39], v8, s[4:7], s56 offen offset:1792 sc1
    s_add_u32 s56, s91, 0
    s_add_u32 m0, s76, 0
    s_nop 0
    buffer_load_dwordx4 v2, s[4:7], s56 offen offset:0 sc1 lds
    s_add_u32 m0, s76, 16
    s_nop 0
    buffer_load_dwordx4 v2, s[4:7], s56 offen offset:1024 sc1 lds
    s_add_u32 m0, s76, 32
    s_nop 0
    buffer_load_dwordx4 v2, s[4:7], s56 offen offset:2048 sc1 lds
    s_add_u32 m0, s76, 48
    s_nop 0
    buffer_load_dwordx4 v2, s[4:7], s56 offen offset:3072 sc1 lds
    s_add_u32 s56, s91, 4096
    s_add_u32 m0, s76, 4160
    s_nop 0
    buffer_load_dwordx4 v2, s[4:7], s56 offen offset:0 sc1 lds
    s_add_u32 m0, s76, 4176
    s_nop 0
    buffer_load_dwordx4 v2, s[4:7], s56 offen offset:1024 sc1 lds
    s_add_u32 m0, s76, 4192
    s_nop 0
    buffer_load_dwordx4 v2, s[4:7], s56 offen offset:2048 sc1 lds
    s_add_u32 m0, s76, 4208
    s_nop 0
    buffer_load_dwordx4 v2, s[4:7], s56 offen offset:3072 sc1 lds
    s_add_u32 s56, s91, 8192
    s_add_u32 m0, s76, 8320
    s_nop 0
    buffer_load_dwordx4 v2, s[4:7], s56 offen offset:0 sc1 lds
    s_add_u32 m0, s76, 8336
    s_nop 0
    buffer_load_dwordx4 v2, s[4:7], s56 offen offset:1024 sc1 lds
    s_add_u32 m0, s76, 8352
    s_nop 0
    buffer_load_dwordx4 v2, s[4:7], s56 offen offset:2048 sc1 lds
    s_add_u32 m0, s76, 8368
    s_nop 0
    buffer_load_dwordx4 v2, s[4:7], s56 offen offset:3072 sc1 lds
    s_add_u32 s56, s91, 12288
    s_add_u32 m0, s76, 12480
    s_nop 0
    buffer_load_dwordx4 v2, s[4:7], s56 offen offset:0 sc1 lds
    s_add_u32 m0, s76, 12496
    s_nop 0
    buffer_load_dwordx4 v2, s[4:7], s56 offen offset:1024 sc1 lds
    s_add_u32 m0, s76, 12512
    s_nop 0
    buffer_load_dwordx4 v2, s[4:7], s56 offen offset:2048 sc1 lds
    s_add_u32 m0, s76, 12528
    s_nop 0
    buffer_load_dwordx4 v2, s[4:7], s56 offen offset:3072 sc1 lds
    s_add_u32 s56, s91, 16384
    s_add_u32 m0, s76, 16640
    s_nop 0
    buffer_load_dwordx4 v2, s[4:7], s56 offen offset:0 sc1 lds
    s_add_u32 m0, s76, 16656
    s_nop 0
    buffer_load_dwordx4 v2, s[4:7], s56 offen offset:1024 sc1 lds
    s_add_u32 m0, s76, 16672
    s_nop 0
    buffer_load_dwordx4 v2, s[4:7], s56 offen offset:2048 sc1 lds
    s_add_u32 m0, s76, 16688
    s_nop 0
    buffer_load_dwordx4 v2, s[4:7], s56 offen offset:3072 sc1 lds
LskipA_56:
    s_cmp_eq_u32 s49, 0
    s_cbranch_scc1 Ls1l0_59
    s_waitcnt vmcnt(16)
Ls1l0_59:
    s_barrier
    s_cmp_eq_u32 s49, 0
    s_cbranch_scc1 Ls1l0_60
    s_add_u32 s56, s91, 20480
    s_add_u32 m0, s76, 20800
    s_nop 0
    buffer_load_dwordx4 v2, s[4:7], s56 offen offset:0 sc1 lds
    s_add_u32 m0, s76, 20816
    s_nop 0
    buffer_load_dwordx4 v2, s[4:7], s56 offen offset:1024 sc1 lds
    s_add_u32 m0, s76, 20832
    s_nop 0
    buffer_load_dwordx4 v2, s[4:7], s56 offen offset:2048 sc1 lds
    s_add_u32 m0, s76, 20848
    s_nop 0
    buffer_load_dwordx4 v2, s[4:7], s56 offen offset:3072 sc1 lds
Ls1l0_60:
    s_cmp_eq_u32 s49, 0
    s_cbranch_scc1 Ls1l0_61
    s_waitcnt vmcnt(16)
Ls1l0_61:
    s_barrier
    s_cmp_eq_u32 s49, 0
    s_cbranch_scc1 Ls1l0_62
    s_add_u32 s56, s91, 24576
    s_add_u32 m0, s76, 24960
    s_nop 0
    buffer_load_dwordx4 v2, s[4:7], s56 offen offset:0 sc1 lds
    s_add_u32 m0, s76, 24976
    s_nop 0
    buffer_load_dwordx4 v2, s[4:7], s56 offen offset:1024 sc1 lds
    s_add_u32 m0, s76, 24992
    s_nop 0
    buffer_load_dwordx4 v2, s[4:7], s56 offen offset:2048 sc1 lds
    s_add_u32 m0, s76, 25008
    s_nop 0
    buffer_load_dwordx4 v2, s[4:7], s56 offen offset:3072 sc1 lds
Ls1l0_62:
    s_cmp_eq_u32 s49, 0
    s_cbranch_scc1 Ls1l0_63
    s_waitcnt vmcnt(16)
Ls1l0_63:
    s_barrier
    s_cmp_eq_u32 s49, 0
    s_cbranch_scc1 Ls1l0_64
    s_add_u32 s56, s91, 28672
    s_add_u32 m0, s76, 29120
    s_nop 0
    buffer_load_dwordx4 v2, s[4:7], s56 offen offset:0 sc1 lds
    s_add_u32 m0, s76, 29136
    s_nop 0
    buffer_load_dwordx4 v2, s[4:7], s56 offen offset:1024 sc1 lds
    s_add_u32 m0, s76, 29152
    s_nop 0
    buffer_load_dwordx4 v2, s[4:7], s56 offen offset:2048 sc1 lds
    s_add_u32 m0, s76, 29168
    s_nop 0
    buffer_load_dwordx4 v2, s[4:7], s56 offen offset:3072 sc1 lds
Ls1l0_64:
    s_cmp_eq_u32 s49, 0
    s_cbranch_scc1 Ls1l0_65
    s_waitcnt vmcnt(16)
Ls1l0_65:
    s_barrier
    s_cmp_eq_u32 s49, 0
    s_cbranch_scc1 Ls1l0_66
Ls1l0_66:
    s_cmp_eq_u32 s49, 0
    s_cbranch_scc1 Ls1l0_67
    s_waitcnt vmcnt(12)
Ls1l0_67:
    s_barrier
    s_cmp_eq_u32 s49, 0
    s_cbranch_scc1 Ls1l0_68
    s_waitcnt vmcnt(32)
    v_add_f32 v24, v24, v32
    v_add_f32 v25, v25, v33
    v_add_f32 v26, v26, v34
    v_add_f32 v27, v27, v35
    v_add_f32 v28, v28, v36
    v_add_f32 v29, v29, v37
    v_add_f32 v30, v30, v38
    v_add_f32 v31, v31, v39
    v_add_f32 v24, v24, v28
    v_add_f32 v25, v25, v29
    v_add_f32 v26, v26, v30
    v_add_f32 v27, v27, v31
    v_add_f32 v24, v24, v26
    v_add_f32 v25, v25, v27
Ls1l0_68:
    s_cmp_eq_u32 s49, 0
    s_cbranch_scc1 Ls1l0_69
    s_waitcnt vmcnt(8)
Ls1l0_69:
    s_barrier
    s_cmp_eq_u32 s49, 0
    s_cbranch_scc1 Ls1l0_70
    v_mov_b32 v26, v24
    v_mov_b32 v27, v25
    s_nop 0
    v_permlane32_swap_b32 v24, v26
    v_permlane32_swap_b32 v25, v27
    v_add_f32 v24, v24, v26
    v_add_f32 v25, v25, v27
    v_mul_f32 v24, 0x3b000000, v24
    v_mul_f32 v25, 0x3b000000, v25
    v_fma_f32 v25, -v24, v24, v25
    v_max_f32 v25, 0, v25
    v_add_f32 v26, 0x3727c5ac, v25
    v_rsq_f32 v26, v26
    v_sub_f32 v28, 0, v24
Ls1l0_70:
    s_cmp_eq_u32 s49, 0
    s_cbranch_scc1 Ls1l0_71
    s_waitcnt vmcnt(4)
Ls1l0_71:
    s_barrier
    s_cmp_eq_u32 s49, 0
    s_cbranch_scc1 Ls1l0_72
    ds_write_b32 v9, v28 offset:1280
    ds_write_b32 v9, v26 offset:1536
    s_waitcnt lgkmcnt(0)
Ls1l0_72:
    s_cmp_eq_u32 s49, 0
    s_cbranch_scc1 Ls1l0_73
    s_waitcnt vmcnt(0)
Ls1l0_73:
    s_barrier
    s_cmp_eq_u32 s49, 0
    s_cbranch_scc1 Ls1l0_74
Ls1l0_74:
    s_barrier
    s_barrier
    s_barrier
    s_barrier
    s_barrier
    s_cmp_lg_u32 s49, 0
    s_cbranch_scc1 Lnl0_75
    v_and_b32 v24, 7, v1
    v_lshlrev_b32 v24, 5, v24
    buffer_load_dwordx2 v[26:27], v24, s[16:19], 0 offen sc1
Lnl0_75:
    s_barrier
    s_barrier
    s_barrier
    s_barrier
    s_barrier
    s_barrier
    s_barrier
    s_cmp_lg_u32 s49, 0
    s_cbranch_scc1 Lnl0_76
    s_mov_b32 s86, 0x40000
    s_branch Lsu_first_79
Lsu_77:
    buffer_load_dwordx2 v[26:27], v24, s[16:19], 0 offen sc1
Lsu_first_79:
    s_waitcnt vmcnt(0)
    v_sad_u8 v28, v26, 0, 0
    v_sad_u8 v28, v27, 0, v28
    v_cmp_eq_u32 vcc, 32, v28
    s_nop 0
    s_cmp_eq_u64 vcc, -1
    s_cbranch_scc1 Lsu_done_78
    s_sub_u32 s86, s86, 1
    s_cmp_lg_u32 s86, 0
    s_cbranch_scc1 Lsu_77
    s_mov_b32 s53, 1
Lsu_done_78:
    v_bcnt_u32_b32 v28, v26, 0
    v_bcnt_u32_b32 v28, v27, v28
    s_nop 0
    v_readlane_b32 s56, v28, s44
    s_nop 0
    s_cmp_eq_u32 s56, 1
    s_cselect_b32 s52, 1, 0
    v_mov_b32 v24, 159364
    v_mov_b32 v25, s52
    ds_write_b32 v24, v25
    s_waitcnt lgkmcnt(0)
Lnl0_76:
    s_barrier
    s_barrier
    s_barrier
    s_barrier
    s_cmp_lg_u32 s49, 0
    s_cbranch_scc1 Lnl0_80
    s_waitcnt vmcnt(0)
Lnl0_80:
    s_barrier
    s_lshr_b32 s59, s45, 2
    s_lshl_b32 s64, 0x01010101, s59
    s_mov_b32 s65, 0
    s_add_u32 s56, s87, 1
    s_cmp_lg_u32 s53, 0
    s_cbranch_scc1 Lpoll_done_82
    s_mov_b32 s86, 0x40000
Lpoll_81:
    buffer_load_dword v22, v10, s[4:7], 0 offen sc1
    s_waitcnt vmcnt(0)
    v_cmp_le_u32 vcc, s56, v22
    s_nop 0
    s_and_b64 vcc, vcc, s[64:65]
    s_cmp_eq_u64 vcc, s[64:65]
    s_cbranch_scc1 Lpoll_done_82
    s_sub_u32 s86, s86, 1
    s_cmp_lg_u32 s86, 0
    s_cbranch_scc1 Lpoll_81
    s_mov_b32 s53, 1
Lpoll_done_82:
    s_lshl_b32 s80, s45, 16
    s_add_u32 s80, s80, s50
    s_lshl_b32 s56, s44, 13
    s_add_u32 s56, s56, s80
    s_lshl_b32 s57, s74, 12
    s_add_u32 s56, s56, s57
    s_add_u32 m0, s57, 49152
    s_nop 0
    buffer_load_dwordx4 v13, s[4:7], s56 offen offset:0 sc1 lds
    buffer_load_dwordx4 v13, s[4:7], s56 offen offset:1024 sc1 lds
    buffer_load_dwordx4 v13, s[4:7], s56 offen offset:2048 sc1 lds
    buffer_load_dwordx4 v13, s[4:7], s56 offen offset:3072 sc1 lds
    s_add_u32 s80, s80, 2097152
    s_mul_i32 s56, s49, 24117248
    s_add_u32 s80, s80, s56
    s_add_u32 s56, s44, 0
    s_and_b32 s56, s56, 7
    s_lshl_b32 s56, s56, 13
    s_add_u32 s56, s56, s80
    s_lshl_b32 s57, s74, 12
    s_add_u32 m0, s57, 0
    s_add_u32 s56, s56, s57
    buffer_load_dwordx4 v13, s[4:7], s56 offen offset:0 sc1 lds
    buffer_load_dwordx4 v13, s[4:7], s56 offen offset:1024 sc1 lds
    buffer_load_dwordx4 v13, s[4:7], s56 offen offset:2048 sc1 lds
    buffer_load_dwordx4 v13, s[4:7], s56 offen offset:3072 sc1 lds
    s_add_u32 m0, s57, 8192
    s_add_u32 s56, s56, 2097152
    buffer_load_dwordx4 v13, s[4:7], s56 offen offset:0 sc1 lds
    buffer_load_dwordx4 v13, s[4:7], s56 offen offset:1024 sc1 lds
    buffer_load_dwordx4 v13, s[4:7], s56 offen offset:2048 sc1 lds
    buffer_load_dwordx4 v13, s[4:7], s56 offen offset:3072 sc1 lds
    s_add_u32 s59, s44, 1
    s_and_b32 s59, s59, 7
    s_lshl_b32 s59, s59, 2
    s_lshl_b32 s64, 15, s59
    s_mov_b32 s65, 0
    s_mov_b64 s[92:93], exec
    s_mov_b64 exec, s[64:65]
    s_add_u32 s56, s87, 1
    s_cmp_lg_u32 s53, 0
    s_cbranch_scc1 Lpoll_done_84
    s_mov_b32 s86, 0x40000
Lpoll_83:
    buffer_load_dword v22, v11, s[4:7], 0 offen sc1
    s_waitcnt vmcnt(0)
    v_cmp_le_u32 vcc, s56, v22
    s_nop 0
    s_and_b64 vcc, vcc, s[64:65]
    s_cmp_eq_u64 vcc, s[64:65]
    s_cbranch_scc1 Lpoll_done_84
    s_sub_u32 s86, s86, 1
    s_cmp_lg_u32 s86, 0
    s_cbranch_scc1 Lpoll_83
    s_mov_b32 s53, 1
Lpoll_done_84:
    s_mov_b64 exec, s[92:93]
    s_waitcnt vmcnt(0)
    s_add_u32 s56, s44, 1
    s_and_b32 s56, s56, 7
    s_lshl_b32 s56, s56, 13
    s_add_u32 s56, s56, s80
    s_lshl_b32 s57, s74, 12
    s_add_u32 m0, s57, 16384
    s_add_u32 s56, s56, s57
    buffer_load_dwordx4 v13, s[4:7], s56 offen offset:0 sc1 lds
    buffer_load_dwordx4 v13, s[4:7], s56 offen offset:1024 sc1 lds
    buffer_load_dwordx4 v13, s[4:7], s56 offen offset:2048 sc1 lds
    buffer_load_dwordx4 v13, s[4:7], s56 offen offset:3072 sc1 lds
    s_add_u32 m0, s57, 24576
    s_add_u32 s56, s56, 2097152
    buffer_load_dwordx4 v13, s[4:7], s56 offen offset:0 sc1 lds
    buffer_load_dwordx4 v13, s[4:7], s56 offen offset:1024 sc1 lds
    buffer_load_dwordx4 v13, s[4:7], s56 offen offset:2048 sc1 lds
    buffer_load_dwordx4 v13, s[4:7], s56 offen offset:3072 sc1 lds
    s_barrier
    v_mov_b32 v24, 159364
    ds_read_b32 v25, v24
    s_waitcnt lgkmcnt(0)
    v_readfirstlane_b32 s52, v25
    s_waitcnt vmcnt(0)
    s_barrier
    s_add_u32 s59, s44, 2
    s_and_b32 s59, s59, 7
    s_lshl_b32 s59, s59, 2
    s_lshl_b32 s64, 15, s59
    s_mov_b32 s65, 0
    s_mov_b64 s[92:93], exec
    s_mov_b64 exec, s[64:65]
    s_add_u32 s56, s87, 1
    s_cmp_lg_u32 s53, 0
    s_cbranch_scc1 Lpoll_done_86
    s_mov_b32 s86, 0x40000
Lpoll_85:
    buffer_load_dword v22, v11, s[4:7], 0 offen sc1
    s_waitcnt vmcnt(0)
    v_cmp_le_u32 vcc, s56, v22
    s_nop 0
    s_and_b64 vcc, vcc, s[64:65]
    s_cmp_eq_u64 vcc, s[64:65]
    s_cbranch_scc1 Lpoll_done_86
    s_sub_u32 s86, s86, 1
    s_cmp_lg_u32 s86, 0
    s_cbranch_scc1 Lpoll_85
    s_mov_b32 s53, 1
Lpoll_done_86:
    s_mov_b64 exec, s[92:93]
    s_add_u32 s56, s44, 2
    s_and_b32 s56, s56, 7
    s_lshl_b32 s56, s56, 13
    s_add_u32 s56, s56, s80
    s_lshl_b32 s57, s74, 12
    s_add_u32 m0, s57, 32768
    s_add_u32 s56, s56, s57
    buffer_load_dwordx4 v13, s[4:7], s56 offen offset:0 sc1 lds
    buffer_load_dwordx4 v13, s[4:7], s56 offen offset:1024 sc1 lds
    buffer_load_dwordx4 v13, s[4:7], s56 offen offset:2048 sc1 lds
    buffer_load_dwordx4 v13, s[4:7], s56 offen offset:3072 sc1 lds
    s_add_u32 m0, s57, 40960
    s_add_u32 s56, s56, 2097152
    buffer_load_dwordx4 v13, s[4:7], s56 offen offset:0 sc1 lds
    buffer_load_dwordx4 v13, s[4:7], s56 offen offset:1024 sc1 lds
    buffer_load_dwordx4 v13, s[4:7], s56 offen offset:2048 sc1 lds
    buffer_load_dwordx4 v13, s[4:7], s56 offen offset:3072 sc1 lds
    s_waitcnt vmcnt(0)
    s_barrier
    s_add_u32 s59, s44, 3
    s_and_b32 s59, s59, 7
    s_lshl_b32 s59, s59, 2
    s_lshl_b32 s64, 15, s59
    s_mov_b32 s65, 0
    s_mov_b64 s[92:93], exec
    s_mov_b64 exec, s[64:65]
    s_add_u32 s56, s87, 1
    s_cmp_lg_u32 s53, 0
    s_cbranch_scc1 Lpoll_done_88
    s_mov_b32 s86, 0x40000
Lpoll_87:
    buffer_load_dword v22, v11, s[4:7], 0 offen sc1
    s_waitcnt vmcnt(0)
    v_cmp_le_u32 vcc, s56, v22
    s_nop 0
    s_and_b64 vcc, vcc, s[64:65]
    s_cmp_eq_u64 vcc, s[64:65]
    s_cbranch_scc1 Lpoll_done_88
    s_sub_u32 s86, s86, 1
    s_cmp_lg_u32 s86, 0
    s_cbranch_scc1 Lpoll_87
    s_mov_b32 s53, 1
Lpoll_done_88:
    s_mov_b64 exec, s[92:93]
    s_add_u32 s56, s44, 3
    s_and_b32 s56, s56, 7
    s_lshl_b32 s56, s56, 13
    s_add_u32 s56, s56, s80
    s_lshl_b32 s57, s74, 12
    s_add_u32 m0, s57, 0
    s_add_u32 s56, s56, s57
    buffer_load_dwordx4 v13, s[4:7], s56 offen offset:0 sc1 lds
    buffer_load_dwordx4 v13, s[4:7], s56 offen offset:1024 sc1 lds
    buffer_load_dwordx4 v13, s[4:7], s56 offen offset:2048 sc1 lds
    buffer_load_dwordx4 v13, s[4:7], s56 offen offset:3072 sc1 lds
    s_add_u32 m0, s57, 8192
    s_add_u32 s56, s56, 2097152
    buffer_load_dwordx4 v13, s[4:7], s56 offen offset:0 sc1 lds
    buffer_load_dwordx4 v13, s[4:7], s56 offen offset:1024 sc1 lds
    buffer_load_dwordx4 v13, s[4:7], s56 offen offset:2048 sc1 lds
    buffer_load_dwordx4 v13, s[4:7], s56 offen offset:3072 sc1 lds
    s_waitcnt vmcnt(0)
    s_barrier
    s_add_u32 s59, s44, 4
    s_and_b32 s59, s59, 7
    s_lshl_b32 s59, s59, 2
    s_lshl_b32 s64, 15, s59
    s_mov_b32 s65, 0
    s_mov_b64 s[92:93], exec
    s_mov_b64 exec, s[64:65]
    s_add_u32 s56, s87, 1
    s_cmp_lg_u32 s53, 0
    s_cbranch_scc1 Lpoll_done_90
    s_mov_b32 s86, 0x40000
Lpoll_89:
    buffer_load_dword v22, v11, s[4:7], 0 offen sc1
    s_waitcnt vmcnt(0)
    v_cmp_le_u32 vcc, s56, v22
    s_nop 0
    s_and_b64 vcc, vcc, s[64:65]
    s_cmp_eq_u64 vcc, s[64:65]
    s_cbranch_scc1 Lpoll_done_90
    s_sub_u32 s86, s86, 1
    s_cmp_lg_u32 s86, 0
    s_cbranch_scc1 Lpoll_89
    s_mov_b32 s53, 1
Lpoll_done_90:
    s_mov_b64 exec, s[92:93]
    s_add_u32 s56, s44, 4
    s_and_b32 s56, s56, 7
    s_lshl_b32 s56, s56, 13
    s_add_u32 s56, s56, s80
    s_lshl_b32 s57, s74, 12
    s_add_u32 m0, s57, 16384
    s_add_u32 s56, s56, s57
    buffer_load_dwordx4 v13, s[4:7], s56 offen offset:0 sc1 lds
    buffer_load_dwordx4 v13, s[4:7], s56 offen offset:1024 sc1 lds
    buffer_load_dwordx4 v13, s[4:7], s56 offen offset:2048 sc1 lds
    buffer_load_dwordx4 v13, s[4:7], s56 offen offset:3072 sc1 lds
    s_add_u32 m0, s57, 24576
    s_add_u32 s56, s56, 2097152
    buffer_load_dwordx4 v13, s[4:7], s56 offen offset:0 sc1 lds
    buffer_load_dwordx4 v13, s[4:7], s56 offen offset:1024 sc1 lds
    buffer_load_dwordx4 v13, s[4:7], s56 offen offset:2048 sc1 lds
    buffer_load_dwordx4 v13, s[4:7], s56 offen offset:3072 sc1 lds
    s_waitcnt vmcnt(0)
    s_barrier
    s_add_u32 s59, s44, 5
    s_and_b32 s59, s59, 7
    s_lshl_b32 s59, s59, 2
    s_lshl_b32 s64, 15, s59
    s_mov_b32 s65, 0
    s_mov_b64 s[92:93], exec
    s_mov_b64 exec, s[64:65]
    s_add_u32 s56, s87, 1
    s_cmp_lg_u32 s53, 0
    s_cbranch_scc1 Lpoll_done_92
    s_mov_b32 s86, 0x40000
Lpoll_91:
    buffer_load_dword v22, v11, s[4:7], 0 offen sc1
    s_waitcnt vmcnt(0)
    v_cmp_le_u32 vcc, s56, v22
    s_nop 0
    s_and_b64 vcc, vcc, s[64:65]
    s_cmp_eq_u64 vcc, s[64:65]
    s_cbranch_scc1 Lpoll_done_92
    s_sub_u32 s86, s86, 1
    s_cmp_lg_u32 s86, 0
    s_cbranch_scc1 Lpoll_91
    s_mov_b32 s53, 1
Lpoll_done_92:
    s_mov_b64 exec, s[92:93]
    s_add_u32 s56, s44, 5
    s_and_b32 s56, s56, 7
    s_lshl_b32 s56, s56, 13
    s_add_u32 s56, s56, s80
    s_lshl_b32 s57, s74, 12
    s_add_u32 m0, s57, 32768
    s_add_u32 s56, s56, s57
    buffer_load_dwordx4 v13, s[4:7], s56 offen offset:0 sc1 lds
    buffer_load_dwordx4 v13, s[4:7], s56 offen offset:1024 sc1 lds
    buffer_load_dwordx4 v13, s[4:7], s56 offen offset:2048 sc1 lds
    buffer_load_dwordx4 v13, s[4:7], s56 offen offset:3072 sc1 lds
    s_add_u32 m0, s57, 40960
    s_add_u32 s56, s56, 2097152
    buffer_load_dwordx4 v13, s[4:7], s56 offen offset:0 sc1 lds
    buffer_load_dwordx4 v13, s[4:7], s56 offen offset:1024 sc1 lds
    buffer_load_dwordx4 v13, s[4:7], s56 offen offset:2048 sc1 lds
    buffer_load_dwordx4 v13, s[4:7], s56 offen offset:3072 sc1 lds
    s_waitcnt vmcnt(0)
    s_barrier
    s_add_u32 s59, s44, 6
    s_and_b32 s59, s59, 7
    s_lshl_b32 s59, s59, 2
    s_lshl_b32 s64, 15, s59
    s_mov_b32 s65, 0
    s_mov_b64 s[92:93], exec
    s_mov_b64 exec, s[64:65]
    s_add_u32 s56, s87, 1
    s_cmp_lg_u32 s53, 0
    s_cbranch_scc1 Lpoll_done_94
    s_mov_b32 s86, 0x40000
Lpoll_93:
    buffer_load_dword v22, v11, s[4:7], 0 offen sc1
    s_waitcnt vmcnt(0)
    v_cmp_le_u32 vcc, s56, v22
    s_nop 0
    s_and_b64 vcc, vcc, s[64:65]
    s_cmp_eq_u64 vcc, s[64:65]
    s_cbranch_scc1 Lpoll_done_94
    s_sub_u32 s86, s86, 1
    s_cmp_lg_u32 s86, 0
    s_cbranch_scc1 Lpoll_93
    s_mov_b32 s53, 1
Lpoll_done_94:
    s_mov_b64 exec, s[92:93]
    s_add_u32 s56, s44, 6
    s_and_b32 s56, s56, 7
    s_lshl_b32 s56, s56, 13
    s_add_u32 s56, s56, s80
    s_lshl_b32 s57, s74, 12
    s_add_u32 m0, s57, 0
    s_add_u32 s56, s56, s57
    buffer_load_dwordx4 v13, s[4:7], s56 offen offset:0 sc1 lds
    buffer_load_dwordx4 v13, s[4:7], s56 offen offset:1024 sc1 lds
    buffer_load_dwordx4 v13, s[4:7], s56 offen offset:2048 sc1 lds
    buffer_load_dwordx4 v13, s[4:7], s56 offen offset:3072 sc1 lds
    s_add_u32 m0, s57, 8192
    s_add_u32 s56, s56, 2097152
    buffer_load_dwordx4 v13, s[4:7], s56 offen offset:0 sc1 lds
    buffer_load_dwordx4 v13, s[4:7], s56 offen offset:1024 sc1 lds
    buffer_load_dwordx4 v13, s[4:7], s56 offen offset:2048 sc1 lds
    buffer_load_dwordx4 v13, s[4:7], s56 offen offset:3072 sc1 lds
    s_waitcnt vmcnt(0)
    s_barrier
    s_add_u32 s59, s44, 7
    s_and_b32 s59, s59, 7
    s_lshl_b32 s59, s59, 2
    s_lshl_b32 s64, 15, s59
    s_mov_b32 s65, 0
    s_mov_b64 s[92:93], exec
    s_mov_b64 exec, s[64:65]
    s_add_u32 s56, s87, 1
    s_cmp_lg_u32 s53, 0
    s_cbranch_scc1 Lpoll_done_96
    s_mov_b32 s86, 0x40000
Lpoll_95:
    buffer_load_dword v22, v11, s[4:7], 0 offen sc1
    s_waitcnt vmcnt(0)
    v_cmp_le_u32 vcc, s56, v22
    s_nop 0
    s_and_b64 vcc, vcc, s[64:65]
    s_cmp_eq_u64 vcc, s[64:65]
    s_cbranch_scc1 Lpoll_done_96
    s_sub_u32 s86, s86, 1
    s_cmp_lg_u32 s86, 0
    s_cbranch_scc1 Lpoll_95
    s_mov_b32 s53, 1
Lpoll_done_96:
    s_mov_b64 exec, s[92:93]
    s_add_u32 s56, s44, 7
    s_and_b32 s56, s56, 7
    s_lshl_b32 s56, s56, 13
    s_add_u32 s56, s56, s80
    s_lshl_b32 s57, s74, 12
    s_add_u32 m0, s57, 16384
    s_add_u32 s56, s56, s57
    buffer_load_dwordx4 v13, s[4:7], s56 offen offset:0 sc1 lds
    buffer_load_dwordx4 v13, s[4:7], s56 offen offset:1024 sc1 lds
    buffer_load_dwordx4 v13, s[4:7], s56 offen offset:2048 sc1 lds
    buffer_load_dwordx4 v13, s[4:7], s56 offen offset:3072 sc1 lds
    s_add_u32 m0, s57, 24576
    s_add_u32 s56, s56, 2097152
    buffer_load_dwordx4 v13, s[4:7], s56 offen offset:0 sc1 lds
    buffer_load_dwordx4 v13, s[4:7], s56 offen offset:1024 sc1 lds
    buffer_load_dwordx4 v13, s[4:7], s56 offen offset:2048 sc1 lds
    buffer_load_dwordx4 v13, s[4:7], s56 offen offset:3072 sc1 lds
    s_waitcnt vmcnt(0)
    s_barrier
    s_barrier
    s_barrier
    v_mov_b32 v24, 159360
    ds_read_b32 v25, v24
    s_waitcnt lgkmcnt(0)
    v_readfirstlane_b32 s56, v25
    s_nop 0
    s_cmp_eq_u32 s56, 0
    s_cbranch_scc1 Lnoslow_97
    s_barrier
Lnoslow_97:
    s_mul_i32 s91, s51, 32768
    s_add_u32 s91, s91, s50
    s_add_u32 s91, s91, 6291456
    s_add_u32 s56, s87, 2
    s_cmp_lg_u32 s53, 0
    s_cbranch_scc1 Lpoll_done_99
    s_mov_b32 s86, 0x40000
Lpoll_98:
    buffer_load_dword v22, v10, s[4:7], 0 offen sc1
    s_waitcnt vmcnt(0)
    v_cmp_le_u32 vcc, s56, v22
    s_nop 0
    s_and_b64 vcc, vcc, s[96:97]
    s_cmp_eq_u64 vcc, s[96:97]
    s_cbranch_scc1 Lpoll_done_99
    s_sub_u32 s86, s86, 1
    s_cmp_lg_u32 s86, 0
    s_cbranch_scc1 Lpoll_98
    s_mov_b32 s53, 1
Lpoll_done_99:
    s_add_u32 s56, s91, 0
    s_add_u32 m0, s76, 0
    s_nop 0
    buffer_load_dwordx4 v2, s[4:7], s56 offen offset:0 sc1 lds
    s_add_u32 m0, s76, 16
    s_nop 0
    buffer_load_dwordx4 v2, s[4:7], s56 offen offset:1024 sc1 lds
    s_add_u32 m0, s76, 32
    s_nop 0
    buffer_load_dwordx4 v2, s[4:7], s56 offen offset:2048 sc1 lds
    s_add_u32 m0, s76, 48
    s_nop 0
    buffer_load_dwordx4 v2, s[4:7], s56 offen offset:3072 sc1 lds
    s_add_u32 s56, s91, 4096
    s_add_u32 m0, s76, 4160
    s_nop 0
    buffer_load_dwordx4 v2, s[4:7], s56 offen offset:0 sc1 lds
    s_add_u32 m0, s76, 4176
    s_nop 0
    buffer_load_dwordx4 v2, s[4:7], s56 offen offset:1024 sc1 lds
    s_add_u32 m0, s76, 4192
    s_nop 0
    buffer_load_dwordx4 v2, s[4:7], s56 offen offset:2048 sc1 lds
    s_add_u32 m0, s76, 4208
    s_nop 0
    buffer_load_dwordx4 v2, s[4:7], s56 offen offset:3072 sc1 lds
    s_add_u32 s56, s91, 8192
    s_add_u32 m0, s76, 8320
    s_nop 0
    buffer_load_dwordx4 v2, s[4:7], s56 offen offset:0 sc1 lds
    s_add_u32 m0, s76, 8336
    s_nop 0
    buffer_load_dwordx4 v2, s[4:7], s56 offen offset:1024 sc1 lds
    s_add_u32 m0, s76, 8352
    s_nop 0
    buffer_load_dwordx4 v2, s[4:7], s56 offen offset:2048 sc1 lds
    s_add_u32 m0, s76, 8368
    s_nop 0
    buffer_load_dwordx4 v2, s[4:7], s56 offen offset:3072 sc1 lds
    s_add_u32 s56, s91, 12288
    s_add_u32 m0, s76, 12480
    s_nop 0
    buffer_load_dwordx4 v2, s[4:7], s56 offen offset:0 sc1 lds
    s_add_u32 m0, s76, 12496
    s_nop 0
    buffer_load_dwordx4 v2, s[4:7], s56 offen offset:1024 sc1 lds
    s_add_u32 m0, s76, 12512
    s_nop 0
    buffer_load_dwordx4 v2, s[4:7], s56 offen offset:2048 sc1 lds
    s_add_u32 m0, s76, 12528
    s_nop 0
    buffer_load_dwordx4 v2, s[4:7], s56 offen offset:3072 sc1 lds
    s_add_u32 s56, s91, 16384
    s_add_u32 m0, s76, 16640
    s_nop 0
    buffer_load_dwordx4 v2, s[4:7], s56 offen offset:0 sc1 lds
    s_add_u32 m0, s76, 16656
    s_nop 0
    buffer_load_dwordx4 v2, s[4:7], s56 offen offset:1024 sc1 lds
    s_add_u32 m0, s76, 16672
    s_nop 0
    buffer_load_dwordx4 v2, s[4:7], s56 offen offset:2048 sc1 lds
    s_add_u32 m0, s76, 16688
    s_nop 0
    buffer_load_dwordx4 v2, s[4:7], s56 offen offset:3072 sc1 lds
    s_waitcnt vmcnt(16)
    s_barrier
    s_add_u32 s56, s91, 20480
    s_add_u32 m0, s76, 20800
    s_nop 0
    buffer_load_dwordx4 v2, s[4:7], s56 offen offset:0 sc1 lds
    s_add_u32 m0, s76, 20816
    s_nop 0
    buffer_load_dwordx4 v2, s[4:7], s56 offen offset:1024 sc1 lds
    s_add_u32 m0, s76, 20832
    s_nop 0
    buffer_load_dwordx4 v2, s[4:7], s56 offen offset:2048 sc1 lds
    s_add_u32 m0, s76, 20848
    s_nop 0
    buffer_load_dwordx4 v2, s[4:7], s56 offen offset:3072 sc1 lds
    s_waitcnt vmcnt(16)
    s_barrier
    s_add_u32 s56, s91, 24576
    s_add_u32 m0, s76, 24960
    s_nop 0
    buffer_load_dwordx4 v2, s[4:7], s56 offen offset:0 sc1 lds
    s_add_u32 m0, s76, 24976
    s_nop 0
    buffer_load_dwordx4 v2, s[4:7], s56 offen offset:1024 sc1 lds
    s_add_u32 m0, s76, 24992
    s_nop 0
    buffer_load_dwordx4 v2, s[4:7], s56 offen offset:2048 sc1 lds
    s_add_u32 m0, s76, 25008
    s_nop 0
    buffer_load_dwordx4 v2, s[4:7], s56 offen offset:3072 sc1 lds
    s_waitcnt vmcnt(16)
    s_barrier
    s_add_u32 s56, s91, 28672
    s_add_u32 m0, s76, 29120
    s_nop 0
    buffer_load_dwordx4 v2, s[4:7], s56 offen offset:0 sc1 lds
    s_add_u32 m0, s76, 29136
    s_nop 0
    buffer_load_dwordx4 v2, s[4:7], s56 offen offset:1024 sc1 lds
    s_add_u32 m0, s76, 29152
    s_nop 0
    buffer_load_dwordx4 v2, s[4:7], s56 offen offset:2048 sc1 lds
    s_add_u32 m0, s76, 29168
    s_nop 0
    buffer_load_dwordx4 v2, s[4:7], s56 offen offset:3072 sc1 lds
    s_waitcnt vmcnt(16)
    s_barrier
    s_waitcnt vmcnt(12)
    s_barrier
    s_waitcnt vmcnt(8)
    s_barrier
    s_waitcnt vmcnt(4)
    s_barrier
    s_waitcnt vmcnt(0)
    s_barrier
    s_barrier
    s_mul_i32 s91, s51, 32768
    s_add_u32 s91, s91, s50
    s_add_u32 s91, s91, 8388608
    s_add_u32 s56, s87, 3
    s_cmp_lg_u32 s53, 0
    s_cbranch_scc1 Lpoll_done_101
    s_mov_b32 s86, 0x40000
Lpoll_100:
    buffer_load_dword v22, v10, s[4:7], 0 offen sc1
    s_waitcnt vmcnt(0)
    v_cmp_le_u32 vcc, s56, v22
    s_nop 0
    s_and_b64 vcc, vcc, s[68:69]
    s_cmp_eq_u64 vcc, s[68:69]
    s_cbranch_scc1 Lpoll_done_101
    s_sub_u32 s86, s86, 1
    s_cmp_lg_u32 s86, 0
    s_cbranch_scc1 Lpoll_100
    s_mov_b32 s53, 1
Lpoll_done_101:
    s_lshl_b32 s56, s51, 12
    s_add_u32 s56, s56, s50
    s_add_u32 s56, s56, 25165824
    buffer_load_dwordx2 v[24:25], v8, s[4:7], s56 offen offset:0 sc1
    buffer_load_dwordx2 v[26:27], v8, s[4:7], s56 offen offset:256 sc1
    buffer_load_dwordx2 v[28:29], v8, s[4:7], s56 offen offset:512 sc1
    buffer_load_dwordx2 v[30:31], v8, s[4:7], s56 offen offset:768 sc1
    buffer_load_dwordx2 v[32:33], v8, s[4:7], s56 offen offset:1024 sc1
    buffer_load_dwordx2 v[34:35], v8, s[4:7], s56 offen offset:1280 sc1
    buffer_load_dwordx2 v[36:37], v8, s[4:7], s56 offen offset:1536 sc1
    buffer_load_dwordx2 v[38:39], v8, s[4:7], s56 offen offset:1792 sc1
    s_add_u32 s56, s91, 0
    s_add_u32 m0, s76, 0
    s_nop 0
    buffer_load_dwordx4 v2, s[4:7], s56 offen offset:0 sc1 lds
    s_add_u32 m0, s76, 16
    s_nop 0
    buffer_load_dwordx4 v2, s[4:7], s56 offen offset:1024 sc1 lds
    s_add_u32 m0, s76, 32
    s_nop 0
    buffer_load_dwordx4 v2, s[4:7], s56 offen offset:2048 sc1 lds
    s_add_u32 m0, s76, 48
    s_nop 0
    buffer_load_dwordx4 v2, s[4:7], s56 offen offset:3072 sc1 lds
    s_add_u32 s56, s91, 4096
    s_add_u32 m0, s76, 4160
    s_nop 0
    buffer_load_dwordx4 v2, s[4:7], s56 offen offset:0 sc1 lds
    s_add_u32 m0, s76, 4176
    s_nop 0
    buffer_load_dwordx4 v2, s[4:7], s56 offen offset:1024 sc1 lds
    s_add_u32 m0, s76, 4192
    s_nop 0
    buffer_load_dwordx4 v2, s[4:7], s56 offen offset:2048 sc1 lds
    s_add_u32 m0, s76, 4208
    s_nop 0
    buffer_load_dwordx4 v2, s[4:7], s56 offen offset:3072 sc1 lds
    s_add_u32 s56, s91, 8192
    s_add_u32 m0, s76, 8320
    s_nop 0
    buffer_load_dwordx4 v2, s[4:7], s56 offen offset:0 sc1 lds
    s_add_u32 m0, s76, 8336
    s_nop 0
    buffer_load_dwordx4 v2, s[4:7], s56 offen offset:1024 sc1 lds
    s_add_u32 m0, s76, 8352
    s_nop 0
    buffer_load_dwordx4 v2, s[4:7], s56 offen offset:2048 sc1 lds
    s_add_u32 m0, s76, 8368
    s_nop 0
    buffer_load_dwordx4 v2, s[4:7], s56 offen offset:3072 sc1 lds
    s_add_u32 s56, s91, 12288
    s_add_u32 m0, s76, 12480
    s_nop 0
    buffer_load_dwordx4 v2, s[4:7], s56 offen offset:0 sc1 lds
    s_add_u32 m0, s76, 12496
    s_nop 0
    buffer_load_dwordx4 v2, s[4:7], s56 offen offset:1024 sc1 lds
    s_add_u32 m0, s76, 12512
    s_nop 0
    buffer_load_dwordx4 v2, s[4:7], s56 offen offset:2048 sc1 lds
    s_add_u32 m0, s76, 12528
    s_nop 0
    buffer_load_dwordx4 v2, s[4:7], s56 offen offset:3072 sc1 lds
    s_add_u32 s56, s91, 16384
    s_add_u32 m0, s76, 16640
    s_nop 0
    buffer_load_dwordx4 v2, s[4:7], s56 offen offset:0 sc1 lds
    s_add_u32 m0, s76, 16656
    s_nop 0
    buffer_load_dwordx4 v2, s[4:7], s56 offen offset:1024 sc1 lds
    s_add_u32 m0, s76, 16672
    s_nop 0
    buffer_load_dwordx4 v2, s[4:7], s56 offen offset:2048 sc1 lds
    s_add_u32 m0, s76, 16688
    s_nop 0
    buffer_load_dwordx4 v2, s[4:7], s56 offen offset:3072 sc1 lds
    s_waitcnt vmcnt(16)
    s_barrier
    s_add_u32 s56, s91, 20480
    s_add_u32 m0, s76, 20800
    s_nop 0
    buffer_load_dwordx4 v2, s[4:7], s56 offen offset:0 sc1 lds
    s_add_u32 m0, s76, 20816
    s_nop 0
    buffer_load_dwordx4 v2, s[4:7], s56 offen offset:1024 sc1 lds
    s_add_u32 m0, s76, 20832
    s_nop 0
    buffer_load_dwordx4 v2, s[4:7], s56 offen offset:2048 sc1 lds
    s_add_u32 m0, s76, 20848
    s_nop 0
    buffer_load_dwordx4 v2, s[4:7], s56 offen offset:3072 sc1 lds
    s_waitcnt vmcnt(16)
    s_barrier
    s_add_u32 s56, s91, 24576
    s_add_u32 m0, s76, 24960
    s_nop 0
    buffer_load_dwordx4 v2, s[4:7], s56 offen offset:0 sc1 lds
    s_add_u32 m0, s76, 24976
    s_nop 0
    buffer_load_dwordx4 v2, s[4:7], s56 offen offset:1024 sc1 lds
    s_add_u32 m0, s76, 24992
    s_nop 0
    buffer_load_dwordx4 v2, s[4:7], s56 offen offset:2048 sc1 lds
    s_add_u32 m0, s76, 25008
    s_nop 0
    buffer_load_dwordx4 v2, s[4:7], s56 offen offset:3072 sc1 lds
    s_waitcnt vmcnt(16)
    s_barrier
    s_add_u32 s56, s91, 28672
    s_add_u32 m0, s76, 29120
    s_nop 0
    buffer_load_dwordx4 v2, s[4:7], s56 offen offset:0 sc1 lds
    s_add_u32 m0, s76, 29136
    s_nop 0
    buffer_load_dwordx4 v2, s[4:7], s56 offen offset:1024 sc1 lds
    s_add_u32 m0, s76, 29152
    s_nop 0
    buffer_load_dwordx4 v2, s[4:7], s56 offen offset:2048 sc1 lds
    s_add_u32 m0, s76, 29168
    s_nop 0
    buffer_load_dwordx4 v2, s[4:7], s56 offen offset:3072 sc1 lds
    s_waitcnt vmcnt(16)
    s_barrier
    s_waitcnt vmcnt(12)
    s_barrier
    s_waitcnt vmcnt(32)
    v_add_f32 v24, v24, v32
    v_add_f32 v25, v25, v33
    v_add_f32 v26, v26, v34
    v_add_f32 v27, v27, v35
    v_add_f32 v28, v28, v36
    v_add_f32 v29, v29, v37
    v_add_f32 v30, v30, v38
    v_add_f32 v31, v31, v39
    v_add_f32 v24, v24, v28
    v_add_f32 v25, v25, v29
    v_add_f32 v26, v26, v30
    v_add_f32 v27, v27, v31
    v_add_f32 v24, v24, v26
    v_add_f32 v25, v25, v27
    s_waitcnt vmcnt(8)
    s_barrier
    v_mov_b32 v26, v24
    v_mov_b32 v27, v25
    s_nop 0
    v_permlane32_swap_b32 v24, v26
    v_permlane32_swap_b32 v25, v27
    v_add_f32 v24, v24, v26
    v_add_f32 v25, v25, v27
    v_mul_f32 v24, 0x3b000000, v24
    v_mul_f32 v25, 0x3b000000, v25
    v_fma_f32 v25, -v24, v24, v25
    v_max_f32 v25, 0, v25
    v_add_f32 v26, 0x3727c5ac, v25
    v_rsq_f32 v26, v26
    v_sub_f32 v28, 0, v24
    s_waitcnt vmcnt(4)
    s_barrier
    ds_write_b32 v9, v28 offset:0
    ds_write_b32 v9, v26 offset:256
    v_mul_f32 v27, v26, v26
    v_mul_f32 v27, v27, v25
    v_add_f32 v27, 0x3727c5ac, v27
    v_rsq_f32 v27, v27
    s_nop 0
    v_mul_f32 v27, v27, v26
    ds_write_b32 v9, v27 offset:512
    s_waitcnt lgkmcnt(0)
    s_waitcnt vmcnt(0)
    s_barrier
    s_barrier
    s_mov_b32 s91, 0
    s_add_u32 s91, s91, s50
    s_add_u32 s91, s91, 10485760
    s_mul_i32 s56, s49, 24117248
    s_add_u32 s91, s91, s56
    s_add_u32 s56, s87, 4
    s_cmp_lg_u32 s53, 0
    s_cbranch_scc1 Lpoll_done_103
    s_mov_b32 s86, 0x40000
Lpoll_102:
    buffer_load_dword v22, v10, s[4:7], 0 offen sc1
    s_waitcnt vmcnt(0)
    v_cmp_le_u32 vcc, s56, v22
    s_nop 0
    s_and_b64 vcc, vcc, s[70:71]
    s_cmp_eq_u64 vcc, s[70:71]
    s_cbranch_scc1 Lpoll_done_103
    s_sub_u32 s86, s86, 1
    s_cmp_lg_u32 s86, 0
    s_cbranch_scc1 Lpoll_102
    s_mov_b32 s53, 1
Lpoll_done_103:
    s_add_u32 s56, s87, 4
    s_cmp_lg_u32 s53, 0
    s_cbranch_scc1 Lpoll_done_105
    s_mov_b32 s86, 0x40000
Lpoll_104:
    buffer_load_dword v22, v12, s[4:7], 0 offen sc1
    s_waitcnt vmcnt(0)
    v_cmp_le_u32 vcc, s56, v22
    s_nop 0
    s_and_b64 vcc, vcc, s[72:73]
    s_cmp_eq_u64 vcc, s[72:73]
    s_cbranch_scc1 Lpoll_done_105
    s_sub_u32 s86, s86, 1
    s_cmp_lg_u32 s86, 0
    s_cbranch_scc1 Lpoll_104
    s_mov_b32 s53, 1
Lpoll_done_105:
    s_add_u32 s56, s91, 0
    s_add_u32 m0, s76, 0
    s_nop 0
    buffer_load_dwordx4 v4, s[4:7], s56 offen offset:0 sc1 lds
    s_add_u32 m0, s76, 16
    s_nop 0
    buffer_load_dwordx4 v4, s[4:7], s56 offen offset:1024 sc1 lds
    s_add_u32 m0, s76, 32
    s_nop 0
    buffer_load_dwordx4 v4, s[4:7], s56 offen offset:2048 sc1 lds
    s_add_u32 m0, s76, 48
    s_nop 0
    buffer_load_dwordx4 v4, s[4:7], s56 offen offset:3072 sc1 lds
    s_add_u32 s56, s91, 4096
    s_add_u32 m0, s76, 4160
    s_nop 0
    buffer_load_dwordx4 v4, s[4:7], s56 offen offset:0 sc1 lds
    s_add_u32 m0, s76, 4176
    s_nop 0
    buffer_load_dwordx4 v4, s[4:7], s56 offen offset:1024 sc1 lds
    s_add_u32 m0, s76, 4192
    s_nop 0
    buffer_load_dwordx4 v4, s[4:7], s56 offen offset:2048 sc1 lds
    s_add_u32 m0, s76, 4208
    s_nop 0
    buffer_load_dwordx4 v4, s[4:7], s56 offen offset:3072 sc1 lds
    s_add_u32 s56, s91, 8192
    s_add_u32 m0, s76, 8320
    s_nop 0
    buffer_load_dwordx4 v5, s[4:7], s56 offen offset:0 sc1 lds
    s_add_u32 m0, s76, 8336
    s_nop 0
    buffer_load_dwordx4 v5, s[4:7], s56 offen offset:1024 sc1 lds
    s_add_u32 m0, s76, 8352
    s_nop 0
    buffer_load_dwordx4 v5, s[4:7], s56 offen offset:2048 sc1 lds
    s_add_u32 m0, s76, 8368
    s_nop 0
    buffer_load_dwordx4 v5, s[4:7], s56 offen offset:3072 sc1 lds
    s_add_u32 s56, s91, 12288
    s_add_u32 m0, s76, 12480
    s_nop 0
    buffer_load_dwordx4 v5, s[4:7], s56 offen offset:0 sc1 lds
    s_add_u32 m0, s76, 12496
    s_nop 0
    buffer_load_dwordx4 v5, s[4:7], s56 offen offset:1024 sc1 lds
    s_add_u32 m0, s76, 12512
    s_nop 0
    buffer_load_dwordx4 v5, s[4:7], s56 offen offset:2048 sc1 lds
    s_add_u32 m0, s76, 12528
    s_nop 0
    buffer_load_dwordx4 v5, s[4:7], s56 offen offset:3072 sc1 lds
    s_add_u32 s56, s91, 16384
    s_add_u32 m0, s76, 16640
    s_nop 0
    buffer_load_dwordx4 v6, s[4:7], s56 offen offset:0 sc1 lds
    s_add_u32 m0, s76, 16656
    s_nop 0
    buffer_load_dwordx4 v6, s[4:7], s56 offen offset:1024 sc1 lds
    s_add_u32 m0, s76, 16672
    s_nop 0
    buffer_load_dwordx4 v6, s[4:7], s56 offen offset:2048 sc1 lds
    s_add_u32 m0, s76, 16688
    s_nop 0
    buffer_load_dwordx4 v6, s[4:7], s56 offen offset:3072 sc1 lds
    s_waitcnt vmcnt(16)
    s_barrier
    s_add_u32 s56, s91, 20480
    s_add_u32 m0, s76, 20800
    s_nop 0
    buffer_load_dwordx4 v6, s[4:7], s56 offen offset:0 sc1 lds
    s_add_u32 m0, s76, 20816
    s_nop 0
    buffer_load_dwordx4 v6, s[4:7], s56 offen offset:1024 sc1 lds
    s_add_u32 m0, s76, 20832
    s_nop 0
    buffer_load_dwordx4 v6, s[4:7], s56 offen offset:2048 sc1 lds
    s_add_u32 m0, s76, 20848
    s_nop 0
    buffer_load_dwordx4 v6, s[4:7], s56 offen offset:3072 sc1 lds
    s_waitcnt vmcnt(16)
    s_barrier
    s_add_u32 s56, s91, 24576
    s_add_u32 m0, s76, 24960
    s_nop 0
    buffer_load_dwordx4 v7, s[4:7], s56 offen offset:0 sc1 lds
    s_add_u32 m0, s76, 24976
    s_nop 0
    buffer_load_dwordx4 v7, s[4:7], s56 offen offset:1024 sc1 lds
    s_add_u32 m0, s76, 24992
    s_nop 0
    buffer_load_dwordx4 v7, s[4:7], s56 offen offset:2048 sc1 lds
    s_add_u32 m0, s76, 25008
    s_nop 0
    buffer_load_dwordx4 v7, s[4:7], s56 offen offset:3072 sc1 lds
    s_waitcnt vmcnt(16)
    s_barrier
    s_add_u32 s56, s91, 28672
    s_add_u32 m0, s76, 29120
    s_nop 0
    buffer_load_dwordx4 v7, s[4:7], s56 offen offset:0 sc1 lds
    s_add_u32 m0, s76, 29136
    s_nop 0
    buffer_load_dwordx4 v7, s[4:7], s56 offen offset:1024 sc1 lds
    s_add_u32 m0, s76, 29152
    s_nop 0
    buffer_load_dwordx4 v7, s[4:7], s56 offen offset:2048 sc1 lds
    s_add_u32 m0, s76, 29168
    s_nop 0
    buffer_load_dwordx4 v7, s[4:7], s56 offen offset:3072 sc1 lds
    s_waitcnt vmcnt(16)
    s_barrier
    s_waitcnt vmcnt(12)
    s_barrier
    s_waitcnt vmcnt(8)
    s_barrier
    s_waitcnt vmcnt(4)
    s_barrier
    s_waitcnt vmcnt(0)
    s_barrier
    s_barrier
    s_mul_i32 s91, s51, 32768
    s_add_u32 s91, s91, s50
    s_add_u32 s91, s91, 12582912
    s_add_u32 s56, s87, 5
    s_cmp_lg_u32 s53, 0
    s_cbranch_scc1 Lpoll_done_107
    s_mov_b32 s86, 0x40000
Lpoll_106:
    buffer_load_dword v22, v10, s[4:7], 0 offen sc1
    s_waitcnt vmcnt(0)
    v_cmp_le_u32 vcc, s56, v22
    s_nop 0
    s_and_b64 vcc, vcc, s[68:69]
    s_cmp_eq_u64 vcc, s[68:69]
    s_cbranch_scc1 Lpoll_done_107
    s_sub_u32 s86, s86, 1
    s_cmp_lg_u32 s86, 0
    s_cbranch_scc1 Lpoll_106
    s_mov_b32 s53, 1
Lpoll_done_107:
    s_lshl_b32 s56, s51, 12
    s_add_u32 s56, s56, s50
    s_add_u32 s56, s56, 25427968
    buffer_load_dwordx2 v[24:25], v8, s[4:7], s56 offen offset:0 sc1
    buffer_load_dwordx2 v[26:27], v8, s[4:7], s56 offen offset:256 sc1
    buffer_load_dwordx2 v[28:29], v8, s[4:7], s56 offen offset:512 sc1
    buffer_load_dwordx2 v[30:31], v8, s[4:7], s56 offen offset:768 sc1
    buffer_load_dwordx2 v[32:33], v8, s[4:7], s56 offen offset:1024 sc1
    buffer_load_dwordx2 v[34:35], v8, s[4:7], s56 offen offset:1280 sc1
    buffer_load_dwordx2 v[36:37], v8, s[4:7], s56 offen offset:1536 sc1
    buffer_load_dwordx2 v[38:39], v8, s[4:7], s56 offen offset:1792 sc1
    s_add_u32 s56, s91, 0
    s_add_u32 m0, s76, 0
    s_nop 0
    buffer_load_dwordx4 v2, s[4:7], s56 offen offset:0 sc1 lds
    s_add_u32 m0, s76, 16
    s_nop 0
    buffer_load_dwordx4 v2, s[4:7], s56 offen offset:1024 sc1 lds
    s_add_u32 m0, s76, 32
    s_nop 0
    buffer_load_dwordx4 v2, s[4:7], s56 offen offset:2048 sc1 lds
    s_add_u32 m0, s76, 48
    s_nop 0
    buffer_load_dwordx4 v2, s[4:7], s56 offen offset:3072 sc1 lds
    s_add_u32 s56, s91, 4096
    s_add_u32 m0, s76, 4160
    s_nop 0
    buffer_load_dwordx4 v2, s[4:7], s56 offen offset:0 sc1 lds
    s_add_u32 m0, s76, 4176
    s_nop 0
    buffer_load_dwordx4 v2, s[4:7], s56 offen offset:1024 sc1 lds
    s_add_u32 m0, s76, 4192
    s_nop 0
    buffer_load_dwordx4 v2, s[4:7], s56 offen offset:2048 sc1 lds
    s_add_u32 m0, s76, 4208
    s_nop 0
    buffer_load_dwordx4 v2, s[4:7], s56 offen offset:3072 sc1 lds
    s_add_u32 s56, s91, 8192
    s_add_u32 m0, s76, 8320
    s_nop 0
    buffer_load_dwordx4 v2, s[4:7], s56 offen offset:0 sc1 lds
    s_add_u32 m0, s76, 8336
    s_nop 0
    buffer_load_dwordx4 v2, s[4:7], s56 offen offset:1024 sc1 lds
    s_add_u32 m0, s76, 8352
    s_nop 0
    buffer_load_dwordx4 v2, s[4:7], s56 offen offset:2048 sc1 lds
    s_add_u32 m0, s76, 8368
    s_nop 0
    buffer_load_dwordx4 v2, s[4:7], s56 offen offset:3072 sc1 lds
    s_add_u32 s56, s91, 12288
    s_add_u32 m0, s76, 12480
    s_nop 0
    buffer_load_dwordx4 v2, s[4:7], s56 offen offset:0 sc1 lds
    s_add_u32 m0, s76, 12496
    s_nop 0
    buffer_load_dwordx4 v2, s[4:7], s56 offen offset:1024 sc1 lds
    s_add_u32 m0, s76, 12512
    s_nop 0
    buffer_load_dwordx4 v2, s[4:7], s56 offen offset:2048 sc1 lds
    s_add_u32 m0, s76, 12528
    s_nop 0
    buffer_load_dwordx4 v2, s[4:7], s56 offen offset:3072 sc1 lds
    s_add_u32 s56, s91, 16384
    s_add_u32 m0, s76, 16640
    s_nop 0
    buffer_load_dwordx4 v2, s[4:7], s56 offen offset:0 sc1 lds
    s_add_u32 m0, s76, 16656
    s_nop 0
    buffer_load_dwordx4 v2, s[4:7], s56 offen offset:1024 sc1 lds
    s_add_u32 m0, s76, 16672
    s_nop 0
    buffer_load_dwordx4 v2, s[4:7], s56 offen offset:2048 sc1 lds
    s_add_u32 m0, s76, 16688
    s_nop 0
    buffer_load_dwordx4 v2, s[4:7], s56 offen offset:3072 sc1 lds
    s_waitcnt vmcnt(16)
    s_barrier
    s_add_u32 s56, s91, 20480
    s_add_u32 m0, s76, 20800
    s_nop 0
    buffer_load_dwordx4 v2, s[4:7], s56 offen offset:0 sc1 lds
    s_add_u32 m0, s76, 20816
    s_nop 0
    buffer_load_dwordx4 v2, s[4:7], s56 offen offset:1024 sc1 lds
    s_add_u32 m0, s76, 20832
    s_nop 0
    buffer_load_dwordx4 v2, s[4:7], s56 offen offset:2048 sc1 lds
    s_add_u32 m0, s76, 20848
    s_nop 0
    buffer_load_dwordx4 v2, s[4:7], s56 offen offset:3072 sc1 lds
    s_waitcnt vmcnt(16)
    s_barrier
    s_add_u32 s56, s91, 24576
    s_add_u32 m0, s76, 24960
    s_nop 0
    buffer_load_dwordx4 v2, s[4:7], s56 offen offset:0 sc1 lds
    s_add_u32 m0, s76, 24976
    s_nop 0
    buffer_load_dwordx4 v2, s[4:7], s56 offen offset:1024 sc1 lds
    s_add_u32 m0, s76, 24992
    s_nop 0
    buffer_load_dwordx4 v2, s[4:7], s56 offen offset:2048 sc1 lds
    s_add_u32 m0, s76, 25008
    s_nop 0
    buffer_load_dwordx4 v2, s[4:7], s56 offen offset:3072 sc1 lds
    s_waitcnt vmcnt(16)
    s_barrier
    s_add_u32 s56, s91, 28672
    s_add_u32 m0, s76, 29120
    s_nop 0
    buffer_load_dwordx4 v2, s[4:7], s56 offen offset:0 sc1 lds
    s_add_u32 m0, s76, 29136
    s_nop 0
    buffer_load_dwordx4 v2, s[4:7], s56 offen offset:1024 sc1 lds
    s_add_u32 m0, s76, 29152
    s_nop 0
    buffer_load_dwordx4 v2, s[4:7], s56 offen offset:2048 sc1 lds
    s_add_u32 m0, s76, 29168
    s_nop 0
    buffer_load_dwordx4 v2, s[4:7], s56 offen offset:3072 sc1 lds
    s_waitcnt vmcnt(16)
    s_barrier
    s_waitcnt vmcnt(12)
    s_barrier
    s_waitcnt vmcnt(32)
    v_add_f32 v24, v24, v32
    v_add_f32 v25, v25, v33
    v_add_f32 v26, v26, v34
    v_add_f32 v27, v27, v35
    v_add_f32 v28, v28, v36
    v_add_f32 v29, v29, v37
    v_add_f32 v30, v30, v38
    v_add_f32 v31, v31, v39
    v_add_f32 v24, v24, v28
    v_add_f32 v25, v25, v29
    v_add_f32 v26, v26, v30
    v_add_f32 v27, v27, v31
    v_add_f32 v24, v24, v26
    v_add_f32 v25, v25, v27
    s_waitcnt vmcnt(8)
    s_barrier
    v_mov_b32 v26, v24
    v_mov_b32 v27, v25
    s_nop 0
    v_permlane32_swap_b32 v24, v26
    v_permlane32_swap_b32 v25, v27
    v_add_f32 v24, v24, v26
    v_add_f32 v25, v25, v27
    v_mul_f32 v24, 0x3b000000, v24
    v_mul_f32 v25, 0x3b000000, v25
    v_fma_f32 v25, -v24, v24, v25
    v_max_f32 v25, 0, v25
    v_add_f32 v26, 0x3727c5ac, v25
    v_rsq_f32 v26, v26
    v_sub_f32 v28, 0, v24
    s_waitcnt vmcnt(4)
    s_barrier
    ds_write_b32 v9, v28 offset:768
    ds_write_b32 v9, v26 offset:1024
    s_waitcnt lgkmcnt(0)
    s_waitcnt vmcnt(0)
    s_barrier
    s_barrier
    s_barrier
    s_barrier
    s_mul_i32 s56, s47, 851968
    s_lshl_b32 s57, s74, 12
    s_add_u32 s56, s56, s57
    s_add_u32 m0, s57, 0
    s_add_u32 s56, s56, 38264832
    buffer_load_dwordx4 v13, s[4:7], s56 offen offset:0 lds
    buffer_load_dwordx4 v13, s[4:7], s56 offen offset:1024 lds
    buffer_load_dwordx4 v13, s[4:7], s56 offen offset:2048 lds
    buffer_load_dwordx4 v13, s[4:7], s56 offen offset:3072 lds
    s_barrier
    s_barrier
    s_mul_i32 s56, s47, 851968
    s_lshl_b32 s57, s74, 12
    s_add_u32 s56, s56, s57
    s_add_u32 m0, s57, 8192
    s_add_u32 s56, s56, 38273024
    buffer_load_dwordx4 v13, s[4:7], s56 offen offset:0 lds
    buffer_load_dwordx4 v13, s[4:7], s56 offen offset:1024 lds
    buffer_load_dwordx4 v13, s[4:7], s56 offen offset:2048 lds
    buffer_load_dwordx4 v13, s[4:7], s56 offen offset:3072 lds
    s_barrier
    s_barrier
    s_mul_i32 s56, s47, 851968
    s_lshl_b32 s57, s74, 12
    s_add_u32 s56, s56, s57
    s_add_u32 m0, s57, 16384
    s_add_u32 s56, s56, 38281216
    buffer_load_dwordx4 v13, s[4:7], s56 offen offset:0 lds
    buffer_load_dwordx4 v13, s[4:7], s56 offen offset:1024 lds
    buffer_load_dwordx4 v13, s[4:7], s56 offen offset:2048 lds
    buffer_load_dwordx4 v13, s[4:7], s56 offen offset:3072 lds
    s_barrier
    s_barrier
    s_mul_i32 s56, s47, 851968
    s_lshl_b32 s57, s74, 12
    s_add_u32 s56, s56, s57
    s_add_u32 m0, s57, 24576
    s_add_u32 s56, s56, 38289408
    buffer_load_dwordx4 v13, s[4:7], s56 offen offset:0 lds
    buffer_load_dwordx4 v13, s[4:7], s56 offen offset:1024 lds
    buffer_load_dwordx4 v13, s[4:7], s56 offen offset:2048 lds
    buffer_load_dwordx4 v13, s[4:7], s56 offen offset:3072 lds
    s_barrier
    s_barrier
    s_mul_i32 s56, s47, 851968
    s_lshl_b32 s57, s74, 12
    s_add_u32 s56, s56, s57
    s_add_u32 m0, s57, 32768
    s_add_u32 s56, s56, 38297600
    buffer_load_dwordx4 v13, s[4:7], s56 offen offset:0 lds
    buffer_load_dwordx4 v13, s[4:7], s56 offen offset:1024 lds
    buffer_load_dwordx4 v13, s[4:7], s56 offen offset:2048 lds
    buffer_load_dwordx4 v13, s[4:7], s56 offen offset:3072 lds
    s_barrier
    s_barrier
    s_mul_i32 s56, s47, 851968
    s_lshl_b32 s57, s74, 12
    s_add_u32 s56, s56, s57
    s_add_u32 m0, s57, 40960
    s_add_u32 s56, s56, 38305792
    buffer_load_dwordx4 v13, s[4:7], s56 offen offset:0 lds
    buffer_load_dwordx4 v13, s[4:7], s56 offen offset:1024 lds
    buffer_load_dwordx4 v13, s[4:7], s56 offen offset:2048 lds
    buffer_load_dwordx4 v13, s[4:7], s56 offen offset:3072 lds
    s_barrier
    s_barrier
    s_mul_i32 s56, s47, 851968
    s_lshl_b32 s57, s74, 12
    s_add_u32 s56, s56, s57
    s_add_u32 m0, s57, 49152
    s_add_u32 s56, s56, 38313984
    buffer_load_dwordx4 v13, s[4:7], s56 offen offset:0 lds
    buffer_load_dwordx4 v13, s[4:7], s56 offen offset:1024 lds
    buffer_load_dwordx4 v13, s[4:7], s56 offen offset:2048 lds
    buffer_load_dwordx4 v13, s[4:7], s56 offen offset:3072 lds
    s_barrier
    s_barrier
    s_barrier
    s_barrier
    s_barrier
    s_waitcnt vmcnt(0)
    s_barrier
    s_barrier
    s_mul_i32 s91, s51, 114688
    s_add_u32 s91, s91, s50
    s_add_u32 s91, s91, 16777216
    s_add_u32 s56, s87, 6
    s_cmp_lg_u32 s53, 0
    s_cbranch_scc1 Lpoll_done_109
    s_mov_b32 s86, 0x40000
Lpoll_108:
    buffer_load_dword v22, v10, s[4:7], 0 offen sc1
    s_waitcnt vmcnt(0)
    v_cmp_le_u32 vcc, s56, v22
    s_nop 0
    s_and_b64 vcc, vcc, s[68:69]
    s_cmp_eq_u64 vcc, s[68:69]
    s_cbranch_scc1 Lpoll_done_109
    s_sub_u32 s86, s86, 1
    s_cmp_lg_u32 s86, 0
    s_cbranch_scc1 Lpoll_108
    s_mov_b32 s53, 1
Lpoll_done_109:
    s_barrier
    s_add_u32 s56, s91, 0
    s_add_u32 m0, s76, 0
    s_nop 0
    buffer_load_dwordx4 v3, s[4:7], s56 offen offset:0 sc1 lds
    s_add_u32 m0, s76, 16
    s_nop 0
    buffer_load_dwordx4 v3, s[4:7], s56 offen offset:1024 sc1 lds
    s_add_u32 m0, s76, 32
    s_nop 0
    buffer_load_dwordx4 v3, s[4:7], s56 offen offset:2048 sc1 lds
    s_add_u32 m0, s76, 48
    s_nop 0
    buffer_load_dwordx4 v3, s[4:7], s56 offen offset:3072 sc1 lds
    s_add_u32 s56, s91, 4096
    s_add_u32 m0, s76, 4160
    s_nop 0
    buffer_load_dwordx4 v3, s[4:7], s56 offen offset:0 sc1 lds
    s_add_u32 m0, s76, 4176
    s_nop 0
    buffer_load_dwordx4 v3, s[4:7], s56 offen offset:1024 sc1 lds
    s_add_u32 m0, s76, 4192
    s_nop 0
    buffer_load_dwordx4 v3, s[4:7], s56 offen offset:2048 sc1 lds
    s_add_u32 m0, s76, 4208
    s_nop 0
    buffer_load_dwordx4 v3, s[4:7], s56 offen offset:3072 sc1 lds
    s_add_u32 s56, s91, 8192
    s_add_u32 m0, s76, 8320
    s_nop 0
    buffer_load_dwordx4 v3, s[4:7], s56 offen offset:0 sc1 lds
    s_add_u32 m0, s76, 8336
    s_nop 0
    buffer_load_dwordx4 v3, s[4:7], s56 offen offset:1024 sc1 lds
    s_add_u32 m0, s76, 8352
    s_nop 0
    buffer_load_dwordx4 v3, s[4:7], s56 offen offset:2048 sc1 lds
    s_add_u32 m0, s76, 8368
    s_nop 0
    buffer_load_dwordx4 v3, s[4:7], s56 offen offset:3072 sc1 lds
    s_add_u32 s56, s91, 12288
    s_add_u32 m0, s76, 12480
    s_nop 0
    buffer_load_dwordx4 v3, s[4:7], s56 offen offset:0 sc1 lds
    s_add_u32 m0, s76, 12496
    s_nop 0
    buffer_load_dwordx4 v3, s[4:7], s56 offen offset:1024 sc1 lds
    s_add_u32 m0, s76, 12512
    s_nop 0
    buffer_load_dwordx4 v3, s[4:7], s56 offen offset:2048 sc1 lds
    s_add_u32 m0, s76, 12528
    s_nop 0
    buffer_load_dwordx4 v3, s[4:7], s56 offen offset:3072 sc1 lds
    s_add_u32 s56, s91, 16384
    s_add_u32 m0, s76, 16640
    s_nop 0
    buffer_load_dwordx4 v3, s[4:7], s56 offen offset:0 sc1 lds
    s_add_u32 m0, s76, 16656
    s_nop 0
    buffer_load_dwordx4 v3, s[4:7], s56 offen offset:1024 sc1 lds
    s_add_u32 m0, s76, 16672
    s_nop 0
    buffer_load_dwordx4 v3, s[4:7], s56 offen offset:2048 sc1 lds
    s_add_u32 m0, s76, 16688
    s_nop 0
    buffer_load_dwordx4 v3, s[4:7], s56 offen offset:3072 sc1 lds
    s_add_u32 s56, s91, 20480
    s_add_u32 m0, s76, 20800
    s_nop 0
    buffer_load_dwordx4 v3, s[4:7], s56 offen offset:0 sc1 lds
    s_add_u32 m0, s76, 20816
    s_nop 0
    buffer_load_dwordx4 v3, s[4:7], s56 offen offset:1024 sc1 lds
    s_add_u32 m0, s76, 20832
    s_nop 0
    buffer_load_dwordx4 v3, s[4:7], s56 offen offset:2048 sc1 lds
    s_add_u32 m0, s76, 20848
    s_nop 0
    buffer_load_dwordx4 v3, s[4:7], s56 offen offset:3072 sc1 lds
    s_waitcnt vmcnt(20)
    s_barrier
    s_add_u32 s56, s91, 24576
    s_add_u32 m0, s76, 24960
    s_nop 0
    buffer_load_dwordx4 v3, s[4:7], s56 offen offset:0 sc1 lds
    s_add_u32 m0, s76, 24976
    s_nop 0
    buffer_load_dwordx4 v3, s[4:7], s56 offen offset:1024 sc1 lds
    s_add_u32 m0, s76, 24992
    s_nop 0
    buffer_load_dwordx4 v3, s[4:7], s56 offen offset:2048 sc1 lds
    s_add_u32 m0, s76, 25008
    s_nop 0
    buffer_load_dwordx4 v3, s[4:7], s56 offen offset:3072 sc1 lds
    s_waitcnt vmcnt(20)
    s_barrier
    s_add_u32 s56, s91, 28672
    s_add_u32 m0, s76, 29120
    s_nop 0
    buffer_load_dwordx4 v3, s[4:7], s56 offen offset:0 sc1 lds
    s_add_u32 m0, s76, 29136
    s_nop 0
    buffer_load_dwordx4 v3, s[4:7], s56 offen offset:1024 sc1 lds
    s_add_u32 m0, s76, 29152
    s_nop 0
    buffer_load_dwordx4 v3, s[4:7], s56 offen offset:2048 sc1 lds
    s_add_u32 m0, s76, 29168
    s_nop 0
    buffer_load_dwordx4 v3, s[4:7], s56 offen offset:3072 sc1 lds
    s_waitcnt vmcnt(20)
    s_barrier
    s_add_u32 s56, s91, 32768
    s_add_u32 m0, s76, 0
    s_nop 0
    buffer_load_dwordx4 v3, s[4:7], s56 offen offset:0 sc1 lds
    s_add_u32 m0, s76, 16
    s_nop 0
    buffer_load_dwordx4 v3, s[4:7], s56 offen offset:1024 sc1 lds
    s_add_u32 m0, s76, 32
    s_nop 0
    buffer_load_dwordx4 v3, s[4:7], s56 offen offset:2048 sc1 lds
    s_add_u32 m0, s76, 48
    s_nop 0
    buffer_load_dwordx4 v3, s[4:7], s56 offen offset:3072 sc1 lds
    s_waitcnt vmcnt(20)
    s_barrier
    s_add_u32 s56, s91, 36864
    s_add_u32 m0, s76, 4160
    s_nop 0
    buffer_load_dwordx4 v3, s[4:7], s56 offen offset:0 sc1 lds
    s_add_u32 m0, s76, 4176
    s_nop 0
    buffer_load_dwordx4 v3, s[4:7], s56 offen offset:1024 sc1 lds
    s_add_u32 m0, s76, 4192
    s_nop 0
    buffer_load_dwordx4 v3, s[4:7], s56 offen offset:2048 sc1 lds
    s_add_u32 m0, s76, 4208
    s_nop 0
    buffer_load_dwordx4 v3, s[4:7], s56 offen offset:3072 sc1 lds
    s_waitcnt vmcnt(20)
    s_barrier
    s_add_u32 s56, s91, 40960
    s_add_u32 m0, s76, 8320
    s_nop 0
    buffer_load_dwordx4 v3, s[4:7], s56 offen offset:0 sc1 lds
    s_add_u32 m0, s76, 8336
    s_nop 0
    buffer_load_dwordx4 v3, s[4:7], s56 offen offset:1024 sc1 lds
    s_add_u32 m0, s76, 8352
    s_nop 0
    buffer_load_dwordx4 v3, s[4:7], s56 offen offset:2048 sc1 lds
    s_add_u32 m0, s76, 8368
    s_nop 0
    buffer_load_dwordx4 v3, s[4:7], s56 offen offset:3072 sc1 lds
    s_waitcnt vmcnt(20)
    s_barrier
    s_add_u32 s56, s91, 45056
    s_add_u32 m0, s76, 12480
    s_nop 0
    buffer_load_dwordx4 v3, s[4:7], s56 offen offset:0 sc1 lds
    s_add_u32 m0, s76, 12496
    s_nop 0
    buffer_load_dwordx4 v3, s[4:7], s56 offen offset:1024 sc1 lds
    s_add_u32 m0, s76, 12512
    s_nop 0
    buffer_load_dwordx4 v3, s[4:7], s56 offen offset:2048 sc1 lds
    s_add_u32 m0, s76, 12528
    s_nop 0
    buffer_load_dwordx4 v3, s[4:7], s56 offen offset:3072 sc1 lds
    s_waitcnt vmcnt(20)
    s_barrier
    s_add_u32 s56, s91, 49152
    s_add_u32 m0, s76, 16640
    s_nop 0
    buffer_load_dwordx4 v3, s[4:7], s56 offen offset:0 sc1 lds
    s_add_u32 m0, s76, 16656
    s_nop 0
    buffer_load_dwordx4 v3, s[4:7], s56 offen offset:1024 sc1 lds
    s_add_u32 m0, s76, 16672
    s_nop 0
    buffer_load_dwordx4 v3, s[4:7], s56 offen offset:2048 sc1 lds
    s_add_u32 m0, s76, 16688
    s_nop 0
    buffer_load_dwordx4 v3, s[4:7], s56 offen offset:3072 sc1 lds
    s_waitcnt vmcnt(20)
    s_barrier
    s_add_u32 s56, s91, 53248
    s_add_u32 m0, s76, 20800
    s_nop 0
    buffer_load_dwordx4 v3, s[4:7], s56 offen offset:0 sc1 lds
    s_add_u32 m0, s76, 20816
    s_nop 0
    buffer_load_dwordx4 v3, s[4:7], s56 offen offset:1024 sc1 lds
    s_add_u32 m0, s76, 20832
    s_nop 0
    buffer_load_dwordx4 v3, s[4:7], s56 offen offset:2048 sc1 lds
    s_add_u32 m0, s76, 20848
    s_nop 0
    buffer_load_dwordx4 v3, s[4:7], s56 offen offset:3072 sc1 lds
    s_waitcnt vmcnt(20)
    s_barrier
    s_add_u32 s56, s91, 57344
    s_add_u32 m0, s76, 24960
    s_nop 0
    buffer_load_dwordx4 v3, s[4:7], s56 offen offset:0 sc1 lds
    s_add_u32 m0, s76, 24976
    s_nop 0
    buffer_load_dwordx4 v3, s[4:7], s56 offen offset:1024 sc1 lds
    s_add_u32 m0, s76, 24992
    s_nop 0
    buffer_load_dwordx4 v3, s[4:7], s56 offen offset:2048 sc1 lds
    s_add_u32 m0, s76, 25008
    s_nop 0
    buffer_load_dwordx4 v3, s[4:7], s56 offen offset:3072 sc1 lds
    s_waitcnt vmcnt(20)
    s_barrier
    s_add_u32 s56, s91, 61440
    s_add_u32 m0, s76, 29120
    s_nop 0
    buffer_load_dwordx4 v3, s[4:7], s56 offen offset:0 sc1 lds
    s_add_u32 m0, s76, 29136
    s_nop 0
    buffer_load_dwordx4 v3, s[4:7], s56 offen offset:1024 sc1 lds
    s_add_u32 m0, s76, 29152
    s_nop 0
    buffer_load_dwordx4 v3, s[4:7], s56 offen offset:2048 sc1 lds
    s_add_u32 m0, s76, 29168
    s_nop 0
    buffer_load_dwordx4 v3, s[4:7], s56 offen offset:3072 sc1 lds
    s_waitcnt vmcnt(20)
    s_barrier
    s_add_u32 s56, s91, 65536
    s_add_u32 m0, s76, 0
    s_nop 0
    buffer_load_dwordx4 v3, s[4:7], s56 offen offset:0 sc1 lds
    s_add_u32 m0, s76, 16
    s_nop 0
    buffer_load_dwordx4 v3, s[4:7], s56 offen offset:1024 sc1 lds
    s_add_u32 m0, s76, 32
    s_nop 0
    buffer_load_dwordx4 v3, s[4:7], s56 offen offset:2048 sc1 lds
    s_add_u32 m0, s76, 48
    s_nop 0
    buffer_load_dwordx4 v3, s[4:7], s56 offen offset:3072 sc1 lds
    s_waitcnt vmcnt(20)
    s_barrier
    s_add_u32 s56, s91, 69632
    s_add_u32 m0, s76, 4160
    s_nop 0
    buffer_load_dwordx4 v3, s[4:7], s56 offen offset:0 sc1 lds
    s_add_u32 m0, s76, 4176
    s_nop 0
    buffer_load_dwordx4 v3, s[4:7], s56 offen offset:1024 sc1 lds
    s_add_u32 m0, s76, 4192
    s_nop 0
    buffer_load_dwordx4 v3, s[4:7], s56 offen offset:2048 sc1 lds
    s_add_u32 m0, s76, 4208
    s_nop 0
    buffer_load_dwordx4 v3, s[4:7], s56 offen offset:3072 sc1 lds
    s_waitcnt vmcnt(20)
    s_barrier
    s_add_u32 s56, s91, 73728
    s_add_u32 m0, s76, 8320
    s_nop 0
    buffer_load_dwordx4 v3, s[4:7], s56 offen offset:0 sc1 lds
    s_add_u32 m0, s76, 8336
    s_nop 0
    buffer_load_dwordx4 v3, s[4:7], s56 offen offset:1024 sc1 lds
    s_add_u32 m0, s76, 8352
    s_nop 0
    buffer_load_dwordx4 v3, s[4:7], s56 offen offset:2048 sc1 lds
    s_add_u32 m0, s76, 8368
    s_nop 0
    buffer_load_dwordx4 v3, s[4:7], s56 offen offset:3072 sc1 lds
    s_waitcnt vmcnt(20)
    s_barrier
    s_add_u32 s56, s91, 77824
    s_add_u32 m0, s76, 12480
    s_nop 0
    buffer_load_dwordx4 v3, s[4:7], s56 offen offset:0 sc1 lds
    s_add_u32 m0, s76, 12496
    s_nop 0
    buffer_load_dwordx4 v3, s[4:7], s56 offen offset:1024 sc1 lds
    s_add_u32 m0, s76, 12512
    s_nop 0
    buffer_load_dwordx4 v3, s[4:7], s56 offen offset:2048 sc1 lds
    s_add_u32 m0, s76, 12528
    s_nop 0
    buffer_load_dwordx4 v3, s[4:7], s56 offen offset:3072 sc1 lds
    s_waitcnt vmcnt(20)
    s_barrier
    s_add_u32 s56, s91, 81920
    s_add_u32 m0, s76, 16640
    s_nop 0
    buffer_load_dwordx4 v3, s[4:7], s56 offen offset:0 sc1 lds
    s_add_u32 m0, s76, 16656
    s_nop 0
    buffer_load_dwordx4 v3, s[4:7], s56 offen offset:1024 sc1 lds
    s_add_u32 m0, s76, 16672
    s_nop 0
    buffer_load_dwordx4 v3, s[4:7], s56 offen offset:2048 sc1 lds
    s_add_u32 m0, s76, 16688
    s_nop 0
    buffer_load_dwordx4 v3, s[4:7], s56 offen offset:3072 sc1 lds
    s_waitcnt vmcnt(20)
    s_barrier
    s_add_u32 s56, s91, 86016
    s_add_u32 m0, s76, 20800
    s_nop 0
    buffer_load_dwordx4 v3, s[4:7], s56 offen offset:0 sc1 lds
    s_add_u32 m0, s76, 20816
    s_nop 0
    buffer_load_dwordx4 v3, s[4:7], s56 offen offset:1024 sc1 lds
    s_add_u32 m0, s76, 20832
    s_nop 0
    buffer_load_dwordx4 v3, s[4:7], s56 offen offset:2048 sc1 lds
    s_add_u32 m0, s76, 20848
    s_nop 0
    buffer_load_dwordx4 v3, s[4:7], s56 offen offset:3072 sc1 lds
    s_waitcnt vmcnt(20)
    s_barrier
    s_add_u32 s56, s91, 90112
    s_add_u32 m0, s76, 24960
    s_nop 0
    buffer_load_dwordx4 v3, s[4:7], s56 offen offset:0 sc1 lds
    s_add_u32 m0, s76, 24976
    s_nop 0
    buffer_load_dwordx4 v3, s[4:7], s56 offen offset:1024 sc1 lds
    s_add_u32 m0, s76, 24992
    s_nop 0
    buffer_load_dwordx4 v3, s[4:7], s56 offen offset:2048 sc1 lds
    s_add_u32 m0, s76, 25008
    s_nop 0
    buffer_load_dwordx4 v3, s[4:7], s56 offen offset:3072 sc1 lds
    s_waitcnt vmcnt(20)
    s_barrier
    s_add_u32 s56, s91, 94208
    s_add_u32 m0, s76, 29120
    s_nop 0
    buffer_load_dwordx4 v3, s[4:7], s56 offen offset:0 sc1 lds
    s_add_u32 m0, s76, 29136
    s_nop 0
    buffer_load_dwordx4 v3, s[4:7], s56 offen offset:1024 sc1 lds
    s_add_u32 m0, s76, 29152
    s_nop 0
    buffer_load_dwordx4 v3, s[4:7], s56 offen offset:2048 sc1 lds
    s_add_u32 m0, s76, 29168
    s_nop 0
    buffer_load_dwordx4 v3, s[4:7], s56 offen offset:3072 sc1 lds
    s_waitcnt vmcnt(20)
    s_barrier
    s_add_u32 s56, s91, 98304
    s_add_u32 m0, s76, 0
    s_nop 0
    buffer_load_dwordx4 v3, s[4:7], s56 offen offset:0 sc1 lds
    s_add_u32 m0, s76, 16
    s_nop 0
    buffer_load_dwordx4 v3, s[4:7], s56 offen offset:1024 sc1 lds
    s_add_u32 m0, s76, 32
    s_nop 0
    buffer_load_dwordx4 v3, s[4:7], s56 offen offset:2048 sc1 lds
    s_add_u32 m0, s76, 48
    s_nop 0
    buffer_load_dwordx4 v3, s[4:7], s56 offen offset:3072 sc1 lds
    s_waitcnt vmcnt(20)
    s_barrier
    s_add_u32 s56, s91, 102400
    s_add_u32 m0, s76, 4160
    s_nop 0
    buffer_load_dwordx4 v3, s[4:7], s56 offen offset:0 sc1 lds
    s_add_u32 m0, s76, 4176
    s_nop 0
    buffer_load_dwordx4 v3, s[4:7], s56 offen offset:1024 sc1 lds
    s_add_u32 m0, s76, 4192
    s_nop 0
    buffer_load_dwordx4 v3, s[4:7], s56 offen offset:2048 sc1 lds
    s_add_u32 m0, s76, 4208
    s_nop 0
    buffer_load_dwordx4 v3, s[4:7], s56 offen offset:3072 sc1 lds
    s_waitcnt vmcnt(20)
    s_barrier
    s_add_u32 s56, s91, 106496
    s_add_u32 m0, s76, 8320
    s_nop 0
    buffer_load_dwordx4 v3, s[4:7], s56 offen offset:0 sc1 lds
    s_add_u32 m0, s76, 8336
    s_nop 0
    buffer_load_dwordx4 v3, s[4:7], s56 offen offset:1024 sc1 lds
    s_add_u32 m0, s76, 8352
    s_nop 0
    buffer_load_dwordx4 v3, s[4:7], s56 offen offset:2048 sc1 lds
    s_add_u32 m0, s76, 8368
    s_nop 0
    buffer_load_dwordx4 v3, s[4:7], s56 offen offset:3072 sc1 lds
    s_waitcnt vmcnt(20)
    s_barrier
    s_add_u32 s56, s91, 110592
    s_add_u32 m0, s76, 12480
    s_nop 0
    buffer_load_dwordx4 v3, s[4:7], s56 offen offset:0 sc1 lds
    s_add_u32 m0, s76, 12496
    s_nop 0
    buffer_load_dwordx4 v3, s[4:7], s56 offen offset:1024 sc1 lds
    s_add_u32 m0, s76, 12512
    s_nop 0
    buffer_load_dwordx4 v3, s[4:7], s56 offen offset:2048 sc1 lds
    s_add_u32 m0, s76, 12528
    s_nop 0
    buffer_load_dwordx4 v3, s[4:7], s56 offen offset:3072 sc1 lds
    s_waitcnt vmcnt(20)
    s_barrier
    s_waitcnt vmcnt(16)
    s_barrier
    s_waitcnt vmcnt(12)
    s_barrier
    s_waitcnt vmcnt(8)
    s_barrier
    s_waitcnt vmcnt(4)
    s_barrier
    s_waitcnt vmcnt(0)
    s_barrier
    s_barrier
    s_cmp_eq_u32 s49, 1
    s_cbranch_scc1 L_LA_FIN
    s_add_u32 s49, s49, 1
    s_add_u32 s87, s87, 8
    s_branch L_LA
L_LA_FIN:
    s_waitcnt vmcnt(0)
    s_endpgm
L_LW:
    s_setprio 3
    s_waitcnt vmcnt(12)
    s_barrier
    s_cmp_lg_u32 s49, 0
    s_cbranch_scc1 Lnl0_110
    s_add_u32 s56, s54, 786432
    s_add_u32 m0, s76, 0
    s_nop 0
    buffer_load_dwordx4 v3, s[20:23], s56 offen lds
    s_add_u32 m0, s76, 1024
    s_add_u32 s56, s56, 24576
    buffer_load_dwordx4 v3, s[20:23], s56 offen lds
    s_add_u32 m0, s76, 2048
    s_add_u32 s56, s56, 24576
    buffer_load_dwordx4 v3, s[20:23], s56 offen lds
    s_add_u32 m0, s76, 3072
    s_add_u32 s56, s56, 24576
    buffer_load_dwordx4 v3, s[20:23], s56 offen lds
Lnl0_110:
    s_waitcnt vmcnt(12)
    s_barrier
    s_cmp_lg_u32 s49, 0
    s_cbranch_scc1 Lnl0_111
    s_add_u32 s56, s54, 983040
    s_add_u32 m0, s76, 8192
    s_nop 0
    buffer_load_dwordx4 v3, s[20:23], s56 offen lds
    s_add_u32 m0, s76, 9216
    s_add_u32 s56, s56, 24576
    buffer_load_dwordx4 v3, s[20:23], s56 offen lds
    s_add_u32 m0, s76, 10240
    s_add_u32 s56, s56, 24576
    buffer_load_dwordx4 v3, s[20:23], s56 offen lds
    s_add_u32 m0, s76, 11264
    s_add_u32 s56, s56, 24576
    buffer_load_dwordx4 v3, s[20:23], s56 offen lds
Lnl0_111:
    s_waitcnt vmcnt(12)
    s_barrier
    s_cmp_lg_u32 s49, 0
    s_cbranch_scc1 Lnl0_112
    s_add_u32 s56, s54, 1179648
    s_add_u32 m0, s76, 16384
    s_nop 0
    buffer_load_dwordx4 v3, s[20:23], s56 offen lds
    s_add_u32 m0, s76, 17408
    s_add_u32 s56, s56, 24576
    buffer_load_dwordx4 v3, s[20:23], s56 offen lds
    s_add_u32 m0, s76, 18432
    s_add_u32 s56, s56, 24576
    buffer_load_dwordx4 v3, s[20:23], s56 offen lds
    s_add_u32 m0, s76, 19456
    s_add_u32 s56, s56, 24576
    buffer_load_dwordx4 v3, s[20:23], s56 offen lds
Lnl0_112:
    s_waitcnt vmcnt(12)
    s_barrier
    s_cmp_lg_u32 s49, 0
    s_cbranch_scc1 Lnl0_113
    s_add_u32 s56, s54, 1376256
    s_add_u32 m0, s76, 24576
    s_nop 0
    buffer_load_dwordx4 v3, s[20:23], s56 offen lds
    s_add_u32 m0, s76, 25600
    s_add_u32 s56, s56, 24576
    buffer_load_dwordx4 v3, s[20:23], s56 offen lds
    s_add_u32 m0, s76, 26624
    s_add_u32 s56, s56, 24576
    buffer_load_dwordx4 v3, s[20:23], s56 offen lds
    s_add_u32 m0, s76, 27648
    s_add_u32 s56, s56, 24576
    buffer_load_dwordx4 v3, s[20:23], s56 offen lds
Lnl0_113:
    s_cmp_eq_u32 s49, 0
    s_cbranch_scc1 Lwraw_114
    s_add_u32 m0, s76, 57344
    s_add_u32 s56, s77, 745472
    buffer_load_dwordx4 v6, s[4:7], s56 offen offset:0  lds
    buffer_load_dwordx4 v6, s[4:7], s56 offen offset:1024  lds
    buffer_load_dwordx4 v6, s[4:7], s56 offen offset:2048  lds
    buffer_load_dwordx4 v6, s[4:7], s56 offen offset:3072  lds
    s_branch Lwj_115
Lwraw_114:
    s_add_u32 s56, s54, 590848
    s_add_u32 m0, s76, 57344
    s_nop 0
    buffer_load_dwordx4 v3, s[20:23], s56 offen lds
    s_add_u32 m0, s76, 58368
    s_add_u32 s56, s56, 24576
    buffer_load_dwordx4 v3, s[20:23], s56 offen lds
    s_add_u32 m0, s76, 59392
    s_add_u32 s56, s56, 24576
    buffer_load_dwordx4 v3, s[20:23], s56 offen lds
    s_add_u32 m0, s76, 60416
    s_add_u32 s56, s56, 24576
    buffer_load_dwordx4 v3, s[20:23], s56 offen lds
Lwj_115:
    s_cmp_eq_u32 s49, 0
    s_cbranch_scc1 Lwraw_116
    s_add_u32 m0, s76, 65536
    s_add_u32 s56, s77, 753664
    buffer_load_dwordx4 v6, s[4:7], s56 offen offset:0  lds
    buffer_load_dwordx4 v6, s[4:7], s56 offen offset:1024  lds
    buffer_load_dwordx4 v6, s[4:7], s56 offen offset:2048  lds
    buffer_load_dwordx4 v6, s[4:7], s56 offen offset:3072  lds
    s_branch Lwj_117
Lwraw_116:
    s_add_u32 s56, s54, 787456
    s_add_u32 m0, s76, 65536
    s_nop 0
    buffer_load_dwordx4 v3, s[20:23], s56 offen lds
    s_add_u32 m0, s76, 66560
    s_add_u32 s56, s56, 24576
    buffer_load_dwordx4 v3, s[20:23], s56 offen lds
    s_add_u32 m0, s76, 67584
    s_add_u32 s56, s56, 24576
    buffer_load_dwordx4 v3, s[20:23], s56 offen lds
    s_add_u32 m0, s76, 68608
    s_add_u32 s56, s56, 24576
    buffer_load_dwordx4 v3, s[20:23], s56 offen lds
Lwj_117:
    s_waitcnt vmcnt(20)
    s_barrier
    s_cmp_lg_u32 s49, 0
    s_cbranch_scc1 Lnl0_118
    s_add_u32 s56, s54, 1024
    s_add_u32 m0, s76, 32768
    s_nop 0
    buffer_load_dwordx4 v3, s[20:23], s56 offen lds
    s_add_u32 m0, s76, 33792
    s_add_u32 s56, s56, 24576
    buffer_load_dwordx4 v3, s[20:23], s56 offen lds
    s_add_u32 m0, s76, 34816
    s_add_u32 s56, s56, 24576
    buffer_load_dwordx4 v3, s[20:23], s56 offen lds
    s_add_u32 m0, s76, 35840
    s_add_u32 s56, s56, 24576
    buffer_load_dwordx4 v3, s[20:23], s56 offen lds
Lnl0_118:
    s_cmp_eq_u32 s49, 0
    s_cbranch_scc1 Lwraw_119
    s_add_u32 m0, s76, 73728
    s_add_u32 s56, s77, 761856
    buffer_load_dwordx4 v6, s[4:7], s56 offen offset:0  lds
    buffer_load_dwordx4 v6, s[4:7], s56 offen offset:1024  lds
    buffer_load_dwordx4 v6, s[4:7], s56 offen offset:2048  lds
    buffer_load_dwordx4 v6, s[4:7], s56 offen offset:3072  lds
    s_branch Lwj_120
Lwraw_119:
    s_add_u32 s56, s54, 984064
    s_add_u32 m0, s76, 73728
    s_nop 0
    buffer_load_dwordx4 v3, s[20:23], s56 offen lds
    s_add_u32 m0, s76, 74752
    s_add_u32 s56, s56, 24576
    buffer_load_dwordx4 v3, s[20:23], s56 offen lds
    s_add_u32 m0, s76, 75776
    s_add_u32 s56, s56, 24576
    buffer_load_dwordx4 v3, s[20:23], s56 offen lds
    s_add_u32 m0, s76, 76800
    s_add_u32 s56, s56, 24576
    buffer_load_dwordx4 v3, s[20:23], s56 offen lds
Lwj_120:
    s_waitcnt vmcnt(24)
    s_barrier
    s_cmp_lg_u32 s49, 0
    s_cbranch_scc1 Lnl0_121
    s_add_u32 s56, s54, 197632
    s_add_u32 m0, s76, 40960
    s_nop 0
    buffer_load_dwordx4 v3, s[20:23], s56 offen lds
    s_add_u32 m0, s76, 41984
    s_add_u32 s56, s56, 24576
    buffer_load_dwordx4 v3, s[20:23], s56 offen lds
    s_add_u32 m0, s76, 43008
    s_add_u32 s56, s56, 24576
    buffer_load_dwordx4 v3, s[20:23], s56 offen lds
    s_add_u32 m0, s76, 44032
    s_add_u32 s56, s56, 24576
    buffer_load_dwordx4 v3, s[20:23], s56 offen lds
Lnl0_121:
    s_cmp_eq_u32 s49, 0
    s_cbranch_scc1 Lwraw_122
    s_add_u32 m0, s76, 81920
    s_add_u32 s56, s77, 770048
    buffer_load_dwordx4 v6, s[4:7], s56 offen offset:0  lds
    buffer_load_dwordx4 v6, s[4:7], s56 offen offset:1024  lds
    buffer_load_dwordx4 v6, s[4:7], s56 offen offset:2048  lds
    buffer_load_dwordx4 v6, s[4:7], s56 offen offset:3072  lds
    s_branch Lwj_123
Lwraw_122:
    s_add_u32 s56, s54, 1180672
    s_add_u32 m0, s76, 81920
    s_nop 0
    buffer_load_dwordx4 v3, s[20:23], s56 offen lds
    s_add_u32 m0, s76, 82944
    s_add_u32 s56, s56, 24576
    buffer_load_dwordx4 v3, s[20:23], s56 offen lds
    s_add_u32 m0, s76, 83968
    s_add_u32 s56, s56, 24576
    buffer_load_dwordx4 v3, s[20:23], s56 offen lds
    s_add_u32 m0, s76, 84992
    s_add_u32 s56, s56, 24576
    buffer_load_dwordx4 v3, s[20:23], s56 offen lds
Lwj_123:
    s_waitcnt vmcnt(28)
    s_barrier
    s_cmp_lg_u32 s49, 0
    s_cbranch_scc1 Lnl0_124
    s_add_u32 s56, s54, 394240
    s_add_u32 m0, s76, 49152
    s_nop 0
    buffer_load_dwordx4 v3, s[20:23], s56 offen lds
    s_add_u32 m0, s76, 50176
    s_add_u32 s56, s56, 24576
    buffer_load_dwordx4 v3, s[20:23], s56 offen lds
    s_add_u32 m0, s76, 51200
    s_add_u32 s56, s56, 24576
    buffer_load_dwordx4 v3, s[20:23], s56 offen lds
    s_add_u32 m0, s76, 52224
    s_add_u32 s56, s56, 24576
    buffer_load_dwordx4 v3, s[20:23], s56 offen lds
Lnl0_124:
    s_cmp_eq_u32 s49, 0
    s_cbranch_scc1 Lwraw_125
    s_add_u32 m0, s76, 0
    s_add_u32 s56, s77, 778240
    buffer_load_dwordx4 v6, s[4:7], s56 offen offset:0  lds
    buffer_load_dwordx4 v6, s[4:7], s56 offen offset:1024  lds
    buffer_load_dwordx4 v6, s[4:7], s56 offen offset:2048  lds
    buffer_load_dwordx4 v6, s[4:7], s56 offen offset:3072  lds
    s_branch Lwj_126
Lwraw_125:
    s_add_u32 s56, s54, 1377280
    s_add_u32 m0, s76, 0
    s_nop 0
    buffer_load_dwordx4 v3, s[20:23], s56 offen lds
    s_add_u32 m0, s76, 1024
    s_add_u32 s56, s56, 24576
    buffer_load_dwordx4 v3, s[20:23], s56 offen lds
    s_add_u32 m0, s76, 2048
    s_add_u32 s56, s56, 24576
    buffer_load_dwordx4 v3, s[20:23], s56 offen lds
    s_add_u32 m0, s76, 3072
    s_add_u32 s56, s56, 24576
    buffer_load_dwordx4 v3, s[20:23], s56 offen lds
Lwj_126:
    s_waitcnt vmcnt(32)
    s_barrier
    s_cmp_eq_u32 s49, 0
    s_cbranch_scc1 Lwraw_127
    s_add_u32 m0, s76, 8192
    s_add_u32 s56, s77, 786432
    buffer_load_dwordx4 v6, s[4:7], s56 offen offset:0  lds
    buffer_load_dwordx4 v6, s[4:7], s56 offen offset:1024  lds
    buffer_load_dwordx4 v6, s[4:7], s56 offen offset:2048  lds
    buffer_load_dwordx4 v6, s[4:7], s56 offen offset:3072  lds
    s_branch Lwj_128
Lwraw_127:
    s_add_u32 s56, s54, 2048
    s_add_u32 m0, s76, 8192
    s_nop 0
    buffer_load_dwordx4 v3, s[20:23], s56 offen lds
    s_add_u32 m0, s76, 9216
    s_add_u32 s56, s56, 24576
    buffer_load_dwordx4 v3, s[20:23], s56 offen lds
    s_add_u32 m0, s76, 10240
    s_add_u32 s56, s56, 24576
    buffer_load_dwordx4 v3, s[20:23], s56 offen lds
    s_add_u32 m0, s76, 11264
    s_add_u32 s56, s56, 24576
    buffer_load_dwordx4 v3, s[20:23], s56 offen lds
Lwj_128:
    s_waitcnt vmcnt(24)
    s_barrier
    s_cmp_eq_u32 s49, 0
    s_cbranch_scc1 Lwraw_129
    s_add_u32 m0, s76, 16384
    s_add_u32 s56, s77, 794624
    buffer_load_dwordx4 v6, s[4:7], s56 offen offset:0  lds
    buffer_load_dwordx4 v6, s[4:7], s56 offen offset:1024  lds
    buffer_load_dwordx4 v6, s[4:7], s56 offen offset:2048  lds
    buffer_load_dwordx4 v6, s[4:7], s56 offen offset:3072  lds
    s_branch Lwj_130
Lwraw_129:
    s_add_u32 s56, s54, 198656
    s_add_u32 m0, s76, 16384
    s_nop 0
    buffer_load_dwordx4 v3, s[20:23], s56 offen lds
    s_add_u32 m0, s76, 17408
    s_add_u32 s56, s56, 24576
    buffer_load_dwordx4 v3, s[20:23], s56 offen lds
    s_add_u32 m0, s76, 18432
    s_add_u32 s56, s56, 24576
    buffer_load_dwordx4 v3, s[20:23], s56 offen lds
    s_add_u32 m0, s76, 19456
    s_add_u32 s56, s56, 24576
    buffer_load_dwordx4 v3, s[20:23], s56 offen lds
Lwj_130:
    s_waitcnt vmcnt(20)
    s_barrier
    s_cmp_eq_u32 s49, 0
    s_cbranch_scc1 Lwraw_131
    s_add_u32 m0, s76, 24576
    s_add_u32 s56, s77, 802816
    buffer_load_dwordx4 v6, s[4:7], s56 offen offset:0  lds
    buffer_load_dwordx4 v6, s[4:7], s56 offen offset:1024  lds
    buffer_load_dwordx4 v6, s[4:7], s56 offen offset:2048  lds
    buffer_load_dwordx4 v6, s[4:7], s56 offen offset:3072  lds
    s_branch Lwj_132
Lwraw_131:
    s_add_u32 s56, s54, 395264
    s_add_u32 m0, s76, 24576
    s_nop 0
    buffer_load_dwordx4 v3, s[20:23], s56 offen lds
    s_add_u32 m0, s76, 25600
    s_add_u32 s56, s56, 24576
    buffer_load_dwordx4 v3, s[20:23], s56 offen lds
    s_add_u32 m0, s76, 26624
    s_add_u32 s56, s56, 24576
    buffer_load_dwordx4 v3, s[20:23], s56 offen lds
    s_add_u32 m0, s76, 27648
    s_add_u32 s56, s56, 24576
    buffer_load_dwordx4 v3, s[20:23], s56 offen lds
Lwj_132:
    s_waitcnt vmcnt(16)
    s_barrier
    s_cmp_eq_u32 s49, 0
    s_cbranch_scc1 Lwraw_133
    s_add_u32 m0, s76, 32768
    s_add_u32 s56, s77, 811008
    buffer_load_dwordx4 v6, s[4:7], s56 offen offset:0  lds
    buffer_load_dwordx4 v6, s[4:7], s56 offen offset:1024  lds
    buffer_load_dwordx4 v6, s[4:7], s56 offen offset:2048  lds
    buffer_load_dwordx4 v6, s[4:7], s56 offen offset:3072  lds
    s_branch Lwj_134
Lwraw_133:
    s_add_u32 s56, s54, 591872
    s_add_u32 m0, s76, 32768
    s_nop 0
    buffer_load_dwordx4 v3, s[20:23], s56 offen lds
    s_add_u32 m0, s76, 33792
    s_add_u32 s56, s56, 24576
    buffer_load_dwordx4 v3, s[20:23], s56 offen lds
    s_add_u32 m0, s76, 34816
    s_add_u32 s56, s56, 24576
    buffer_load_dwordx4 v3, s[20:23], s56 offen lds
    s_add_u32 m0, s76, 35840
    s_add_u32 s56, s56, 24576
    buffer_load_dwordx4 v3, s[20:23], s56 offen lds
Lwj_134:
    s_waitcnt vmcnt(32)
    s_barrier
    s_cmp_eq_u32 s49, 0
    s_cbranch_scc1 Lwraw_135
    s_add_u32 m0, s76, 40960
    s_add_u32 s56, s77, 819200
    buffer_load_dwordx4 v6, s[4:7], s56 offen offset:0  lds
    buffer_load_dwordx4 v6, s[4:7], s56 offen offset:1024  lds
    buffer_load_dwordx4 v6, s[4:7], s56 offen offset:2048  lds
    buffer_load_dwordx4 v6, s[4:7], s56 offen offset:3072  lds
    s_branch Lwj_136
Lwraw_135:
    s_add_u32 s56, s54, 788480
    s_add_u32 m0, s76, 40960
    s_nop 0
    buffer_load_dwordx4 v3, s[20:23], s56 offen lds
    s_add_u32 m0, s76, 41984
    s_add_u32 s56, s56, 24576
    buffer_load_dwordx4 v3, s[20:23], s56 offen lds
    s_add_u32 m0, s76, 43008
    s_add_u32 s56, s56, 24576
    buffer_load_dwordx4 v3, s[20:23], s56 offen lds
    s_add_u32 m0, s76, 44032
    s_add_u32 s56, s56, 24576
    buffer_load_dwordx4 v3, s[20:23], s56 offen lds
Lwj_136:
    s_waitcnt vmcnt(32)
    s_barrier
    s_cmp_eq_u32 s49, 0
    s_cbranch_scc1 Lwraw_137
    s_add_u32 m0, s76, 49152
    s_add_u32 s56, s77, 827392
    buffer_load_dwordx4 v6, s[4:7], s56 offen offset:0  lds
    buffer_load_dwordx4 v6, s[4:7], s56 offen offset:1024  lds
    buffer_load_dwordx4 v6, s[4:7], s56 offen offset:2048  lds
    buffer_load_dwordx4 v6, s[4:7], s56 offen offset:3072  lds
    s_branch Lwj_138
Lwraw_137:
    s_add_u32 s56, s54, 985088
    s_add_u32 m0, s76, 49152
    s_nop 0
    buffer_load_dwordx4 v3, s[20:23], s56 offen lds
    s_add_u32 m0, s76, 50176
    s_add_u32 s56, s56, 24576
    buffer_load_dwordx4 v3, s[20:23], s56 offen lds
    s_add_u32 m0, s76, 51200
    s_add_u32 s56, s56, 24576
    buffer_load_dwordx4 v3, s[20:23], s56 offen lds
    s_add_u32 m0, s76, 52224
    s_add_u32 s56, s56, 24576
    buffer_load_dwordx4 v3, s[20:23], s56 offen lds
Lwj_138:
    s_waitcnt vmcnt(32)
    s_barrier
    s_cmp_eq_u32 s49, 0
    s_cbranch_scc1 Lwraw_139
    s_add_u32 m0, s76, 57344
    s_add_u32 s56, s77, 835584
    buffer_load_dwordx4 v6, s[4:7], s56 offen offset:0  lds
    buffer_load_dwordx4 v6, s[4:7], s56 offen offset:1024  lds
    buffer_load_dwordx4 v6, s[4:7], s56 offen offset:2048  lds
    buffer_load_dwordx4 v6, s[4:7], s56 offen offset:3072  lds
    s_branch Lwj_140
Lwraw_139:
    s_add_u32 s56, s54, 1181696
    s_add_u32 m0, s76, 57344
    s_nop 0
    buffer_load_dwordx4 v3, s[20:23], s56 offen lds
    s_add_u32 m0, s76, 58368
    s_add_u32 s56, s56, 24576
    buffer_load_dwordx4 v3, s[20:23], s56 offen lds
    s_add_u32 m0, s76, 59392
    s_add_u32 s56, s56, 24576
    buffer_load_dwordx4 v3, s[20:23], s56 offen lds
    s_add_u32 m0, s76, 60416
    s_add_u32 s56, s56, 24576
    buffer_load_dwordx4 v3, s[20:23], s56 offen lds
Lwj_140:
    s_waitcnt vmcnt(32)
    s_barrier
    s_cmp_eq_u32 s49, 0
    s_cbranch_scc1 Lwraw_141
    s_add_u32 m0, s76, 65536
    s_add_u32 s56, s77, 843776
    buffer_load_dwordx4 v6, s[4:7], s56 offen offset:0  lds
    buffer_load_dwordx4 v6, s[4:7], s56 offen offset:1024  lds
    buffer_load_dwordx4 v6, s[4:7], s56 offen offset:2048  lds
    buffer_load_dwordx4 v6, s[4:7], s56 offen offset:3072  lds
    s_branch Lwj_142
Lwraw_141:
    s_add_u32 s56, s54, 1378304
    s_add_u32 m0, s76, 65536
    s_nop 0
    buffer_load_dwordx4 v3, s[20:23], s56 offen lds
    s_add_u32 m0, s76, 66560
    s_add_u32 s56, s56, 24576
    buffer_load_dwordx4 v3, s[20:23], s56 offen lds
    s_add_u32 m0, s76, 67584
    s_add_u32 s56, s56, 24576
    buffer_load_dwordx4 v3, s[20:23], s56 offen lds
    s_add_u32 m0, s76, 68608
    s_add_u32 s56, s56, 24576
    buffer_load_dwordx4 v3, s[20:23], s56 offen lds
Lwj_142:
    s_waitcnt vmcnt(32)
    s_barrier
    s_waitcnt vmcnt(28)
    s_barrier
    s_waitcnt vmcnt(24)
    s_barrier
    s_waitcnt vmcnt(20)
    s_barrier
    s_waitcnt vmcnt(16)
    s_barrier
    s_waitcnt vmcnt(12)
    s_barrier
    s_waitcnt vmcnt(8)
    s_barrier
    s_cmp_lg_u32 s49, 0
    s_cbranch_scc1 Lnl0_143
    v_mov_b32 v24, 159364
    ds_read_b32 v25, v24
    s_waitcnt lgkmcnt(0)
    v_readfirstlane_b32 s52, v25
Lnl0_143:
    s_waitcnt vmcnt(4)
    s_barrier
    s_waitcnt vmcnt(0)
    s_barrier
    s_barrier
    s_cmp_lg_u32 s48, 6
    s_cbranch_scc1 Lnotw_144
    s_add_u32 s56, s87, 1
    v_mov_b32 v20, s56
    s_lshl_b32 s57, s44, 8
    s_lshl_b32 s58, s45, 2
    s_add_u32 s57, s57, s58
    v_mov_b32 v21, 0
    s_mov_b64 s[92:93], exec
    s_mov_b64 exec, 1
    s_cmp_eq_u32 s52, 0
    s_cbranch_scc1 Lst_safe_145
    buffer_store_dword v20, v21, s[4:7], s57 offen
    s_branch Lst_done_146
Lst_safe_145:
    buffer_store_dword v20, v21, s[4:7], s57 offen sc1
Lst_done_146:
    s_mov_b64 exec, s[92:93]
Lnotw_144:
    s_cmp_lg_u32 s48, 7
    s_cbranch_scc1 Lnotw_147
    s_add_u32 s56, s87, 1
    v_mov_b32 v20, s56
    s_lshl_b32 s57, s44, 5
    s_add_u32 s57, s57, s45
    s_lshl_b32 s57, s57, 7
    s_add_u32 s57, s57, 32768
    v_mov_b32 v21, 0
    s_mov_b64 s[92:93], exec
    s_mov_b64 exec, 1
    buffer_store_dword v20, v21, s[4:7], s57 offen sc1
    s_mov_b64 exec, s[92:93]
Lnotw_147:
    s_barrier
    v_mov_b32 v24, 159364
    ds_read_b32 v25, v24
    s_waitcnt lgkmcnt(0)
    v_readfirstlane_b32 s52, v25
    s_cmp_lg_u32 s49, 0
    s_cbranch_scc1 Lnl0_148
    s_add_u32 s60, s45, 0
    s_cmp_lt_u32 s60, 8
    s_cbranch_scc1 Lselo_152
    s_cmp_lt_u32 s60, 16
    s_cbranch_scc1 Lsel1_153
    s_cmp_lt_u32 s60, 24
    s_cbranch_scc1 Lsel2_154
    s_cmp_lt_u32 s60, 52
    s_cbranch_scc1 Lsel3_155
    s_cmp_lt_u32 s60, 80
    s_cbranch_scc1 Lsel4_156
Lselq_157:
    s_mov_b32 s56, s20
    s_mov_b32 s57, s21
    s_mov_b32 s58, s22
    s_sub_u32 s61, s60, 80
    s_lshr_b32 s62, s61, 3
    s_and_b32 s61, s61, 7
    s_mul_i32 s62, s62, 1024
    s_mul_i32 s61, s61, 196608
    s_add_u32 s62, s62, s61
    s_mul_i32 s61, s44, 128
    s_add_u32 s62, s62, s61
    s_mov_b32 s63, 3072
    s_branch Lselgo_158
Lselo_152:
    s_mov_b32 s56, s24
    s_mov_b32 s57, s25
    s_mov_b32 s58, s26
    s_sub_u32 s61, s60, 0
    s_mov_b32 s62, 0
    s_mul_i32 s61, s61, 65536
    s_add_u32 s62, s62, s61
    s_mul_i32 s61, s44, 128
    s_add_u32 s62, s62, s61
    s_mov_b32 s63, 1024
    s_branch Lselgo_158
Lsel1_153:
    s_mov_b32 s56, s28
    s_mov_b32 s57, s29
    s_mov_b32 s58, s30
    s_sub_u32 s61, s60, 8
    s_mov_b32 s62, 0
    s_mul_i32 s61, s61, 65536
    s_add_u32 s62, s62, s61
    s_mul_i32 s61, s44, 128
    s_add_u32 s62, s62, s61
    s_mov_b32 s63, 1024
    s_branch Lselgo_158
Lsel2_154:
    s_mov_b32 s56, s32
    s_mov_b32 s57, s33
    s_mov_b32 s58, s34
    s_sub_u32 s61, s60, 16
    s_mov_b32 s62, 0
    s_mul_i32 s61, s61, 65536
    s_add_u32 s62, s62, s61
    s_mul_i32 s61, s44, 128
    s_add_u32 s62, s62, s61
    s_mov_b32 s63, 1024
    s_branch Lselgo_158
Lsel3_155:
    s_mov_b32 s56, s36
    s_mov_b32 s57, s37
    s_mov_b32 s58, s38
    s_sub_u32 s61, s60, 24
    s_lshr_b32 s62, s61, 3
    s_and_b32 s61, s61, 7
    s_mul_i32 s62, s62, 128
    s_mul_i32 s61, s61, 229376
    s_add_u32 s62, s62, s61
    s_mul_i32 s61, s44, 448
    s_add_u32 s62, s62, s61
    s_mov_b32 s63, 3584
    s_branch Lselgo_158
Lsel4_156:
    s_mov_b32 s56, s40
    s_mov_b32 s57, s41
    s_mov_b32 s58, s42
    s_sub_u32 s61, s60, 52
    s_mov_b32 s62, 0
    s_mul_i32 s61, s61, 65536
    s_add_u32 s62, s62, s61
    s_mul_i32 s61, s44, 128
    s_add_u32 s62, s62, s61
    s_mov_b32 s63, 1024
    s_branch Lselgo_158
Lselgo_158:
    s_mov_b32 s59, 0x00020000
    v_mul_lo_u32 v28, v11, s63
    v_add_u32 v28, v28, v12
    s_lshl_b32 s61, s74, 6
    s_add_u32 s62, s62, s61
    s_lshl_b32 s63, s63, 4
    s_lshl_b32 s61, s74, 12
    s_add_u32 m0, s61, 66560
    s_nop 0
    buffer_load_dwordx4 v28, s[56:59], s62 offen lds
    s_add_u32 m0, s61, 67584
    s_add_u32 s62, s62, s63
    buffer_load_dwordx4 v28, s[56:59], s62 offen lds
    s_add_u32 m0, s61, 68608
    s_add_u32 s62, s62, s63
    buffer_load_dwordx4 v28, s[56:59], s62 offen lds
    s_add_u32 m0, s61, 69632
    s_add_u32 s62, s62, s63
    buffer_load_dwordx4 v28, s[56:59], s62 offen lds
    s_branch Lprep_done_149
Lprep_done_149:
    s_add_u32 s60, s45, 32
    s_cmp_lt_u32 s60, 8
    s_cbranch_scc1 Lselo_162
    s_cmp_lt_u32 s60, 16
    s_cbranch_scc1 Lsel1_163
    s_cmp_lt_u32 s60, 24
    s_cbranch_scc1 Lsel2_164
    s_cmp_lt_u32 s60, 52
    s_cbranch_scc1 Lsel3_165
    s_cmp_lt_u32 s60, 80
    s_cbranch_scc1 Lsel4_166
Lselq_167:
    s_mov_b32 s56, s20
    s_mov_b32 s57, s21
    s_mov_b32 s58, s22
    s_sub_u32 s61, s60, 80
    s_lshr_b32 s62, s61, 3
    s_and_b32 s61, s61, 7
    s_mul_i32 s62, s62, 1024
    s_mul_i32 s61, s61, 196608
    s_add_u32 s62, s62, s61
    s_mul_i32 s61, s44, 128
    s_add_u32 s62, s62, s61
    s_mov_b32 s63, 3072
    s_branch Lselgo_168
Lselo_162:
    s_mov_b32 s56, s24
    s_mov_b32 s57, s25
    s_mov_b32 s58, s26
    s_sub_u32 s61, s60, 0
    s_mov_b32 s62, 0
    s_mul_i32 s61, s61, 65536
    s_add_u32 s62, s62, s61
    s_mul_i32 s61, s44, 128
    s_add_u32 s62, s62, s61
    s_mov_b32 s63, 1024
    s_branch Lselgo_168
Lsel1_163:
    s_mov_b32 s56, s28
    s_mov_b32 s57, s29
    s_mov_b32 s58, s30
    s_sub_u32 s61, s60, 8
    s_mov_b32 s62, 0
    s_mul_i32 s61, s61, 65536
    s_add_u32 s62, s62, s61
    s_mul_i32 s61, s44, 128
    s_add_u32 s62, s62, s61
    s_mov_b32 s63, 1024
    s_branch Lselgo_168
Lsel2_164:
    s_mov_b32 s56, s32
    s_mov_b32 s57, s33
    s_mov_b32 s58, s34
    s_sub_u32 s61, s60, 16
    s_mov_b32 s62, 0
    s_mul_i32 s61, s61, 65536
    s_add_u32 s62, s62, s61
    s_mul_i32 s61, s44, 128
    s_add_u32 s62, s62, s61
    s_mov_b32 s63, 1024
    s_branch Lselgo_168
Lsel3_165:
    s_mov_b32 s56, s36
    s_mov_b32 s57, s37
    s_mov_b32 s58, s38
    s_sub_u32 s61, s60, 24
    s_lshr_b32 s62, s61, 3
    s_and_b32 s61, s61, 7
    s_mul_i32 s62, s62, 128
    s_mul_i32 s61, s61, 229376
    s_add_u32 s62, s62, s61
    s_mul_i32 s61, s44, 448
    s_add_u32 s62, s62, s61
    s_mov_b32 s63, 3584
    s_branch Lselgo_168
Lsel4_166:
    s_mov_b32 s56, s40
    s_mov_b32 s57, s41
    s_mov_b32 s58, s42
    s_sub_u32 s61, s60, 52
    s_mov_b32 s62, 0
    s_mul_i32 s61, s61, 65536
    s_add_u32 s62, s62, s61
    s_mul_i32 s61, s44, 128
    s_add_u32 s62, s62, s61
    s_mov_b32 s63, 1024
    s_branch Lselgo_168
Lselgo_168:
    s_mov_b32 s59, 0x00020000
    v_mul_lo_u32 v28, v11, s63
    v_add_u32 v28, v28, v12
    s_cmp_ge_u32 s60, 48
    s_cselect_b32 s94, 1, 0
    s_cmp_lt_u32 s60, 52
    s_cselect_b32 s94, s94, 0
    s_mov_b32 s61, 64
    s_cmp_eq_u32 s94, 1
    s_cselect_b32 s61, 917504, s61
    s_mul_i32 s61, s61, s74
    s_add_u32 s62, s62, s61
    s_lshl_b32 s63, s63, 4
    s_lshl_b32 s61, s74, 12
    s_add_u32 m0, s61, 74752
    s_nop 0
    buffer_load_dwordx4 v28, s[56:59], s62 offen lds
    s_add_u32 m0, s61, 75776
    s_add_u32 s62, s62, s63
    buffer_load_dwordx4 v28, s[56:59], s62 offen lds
    s_add_u32 m0, s61, 76800
    s_add_u32 s62, s62, s63
    buffer_load_dwordx4 v28, s[56:59], s62 offen lds
    s_add_u32 m0, s61, 77824
    s_add_u32 s62, s62, s63
    buffer_load_dwordx4 v28, s[56:59], s62 offen lds
    s_branch Lprep_done_159
Lprep_done_159:
    s_add_u32 s60, s45, 64
    s_cmp_lt_u32 s60, 8
    s_cbranch_scc1 Lselo_172
    s_cmp_lt_u32 s60, 16
    s_cbranch_scc1 Lsel1_173
    s_cmp_lt_u32 s60, 24
    s_cbranch_scc1 Lsel2_174
    s_cmp_lt_u32 s60, 52
    s_cbranch_scc1 Lsel3_175
    s_cmp_lt_u32 s60, 80
    s_cbranch_scc1 Lsel4_176
Lselq_177:
    s_mov_b32 s56, s20
    s_mov_b32 s57, s21
    s_mov_b32 s58, s22
    s_sub_u32 s61, s60, 80
    s_lshr_b32 s62, s61, 3
    s_and_b32 s61, s61, 7
    s_mul_i32 s62, s62, 1024
    s_mul_i32 s61, s61, 196608
    s_add_u32 s62, s62, s61
    s_mul_i32 s61, s44, 128
    s_add_u32 s62, s62, s61
    s_mov_b32 s63, 3072
    s_branch Lselgo_178
Lselo_172:
    s_mov_b32 s56, s24
    s_mov_b32 s57, s25
    s_mov_b32 s58, s26
    s_sub_u32 s61, s60, 0
    s_mov_b32 s62, 0
    s_mul_i32 s61, s61, 65536
    s_add_u32 s62, s62, s61
    s_mul_i32 s61, s44, 128
    s_add_u32 s62, s62, s61
    s_mov_b32 s63, 1024
    s_branch Lselgo_178
Lsel1_173:
    s_mov_b32 s56, s28
    s_mov_b32 s57, s29
    s_mov_b32 s58, s30
    s_sub_u32 s61, s60, 8
    s_mov_b32 s62, 0
    s_mul_i32 s61, s61, 65536
    s_add_u32 s62, s62, s61
    s_mul_i32 s61, s44, 128
    s_add_u32 s62, s62, s61
    s_mov_b32 s63, 1024
    s_branch Lselgo_178
Lsel2_174:
    s_mov_b32 s56, s32
    s_mov_b32 s57, s33
    s_mov_b32 s58, s34
    s_sub_u32 s61, s60, 16
    s_mov_b32 s62, 0
    s_mul_i32 s61, s61, 65536
    s_add_u32 s62, s62, s61
    s_mul_i32 s61, s44, 128
    s_add_u32 s62, s62, s61
    s_mov_b32 s63, 1024
    s_branch Lselgo_178
Lsel3_175:
    s_mov_b32 s56, s36
    s_mov_b32 s57, s37
    s_mov_b32 s58, s38
    s_sub_u32 s61, s60, 24
    s_lshr_b32 s62, s61, 3
    s_and_b32 s61, s61, 7
    s_mul_i32 s62, s62, 128
    s_mul_i32 s61, s61, 229376
    s_add_u32 s62, s62, s61
    s_mul_i32 s61, s44, 448
    s_add_u32 s62, s62, s61
    s_mov_b32 s63, 3584
    s_branch Lselgo_178
Lsel4_176:
    s_mov_b32 s56, s40
    s_mov_b32 s57, s41
    s_mov_b32 s58, s42
    s_sub_u32 s61, s60, 52
    s_mov_b32 s62, 0
    s_mul_i32 s61, s61, 65536
    s_add_u32 s62, s62, s61
    s_mul_i32 s61, s44, 128
    s_add_u32 s62, s62, s61
    s_mov_b32 s63, 1024
    s_branch Lselgo_178
Lselgo_178:
    s_mov_b32 s59, 0x00020000
    s_cmp_ge_u32 s60, 80
    s_cbranch_scc1 Lprep_raw_170
    v_mul_lo_u32 v28, v11, s63
    v_add_u32 v28, v28, v12
    s_lshl_b32 s61, s74, 6
    s_add_u32 s62, s62, s61
    s_lshl_b32 s63, s63, 4
    s_lshl_b32 s61, s74, 12
    s_add_u32 m0, s61, 82944
    s_nop 0
    buffer_load_dwordx4 v28, s[56:59], s62 offen lds
    s_add_u32 m0, s61, 83968
    s_add_u32 s62, s62, s63
    buffer_load_dwordx4 v28, s[56:59], s62 offen lds
    s_add_u32 m0, s61, 84992
    s_add_u32 s62, s62, s63
    buffer_load_dwordx4 v28, s[56:59], s62 offen lds
    s_add_u32 m0, s61, 86016
    s_add_u32 s62, s62, s63
    buffer_load_dwordx4 v28, s[56:59], s62 offen lds
    s_branch Lprep_done_169
Lprep_raw_170:
    v_mul_lo_u32 v28, v7, s63
    v_add_u32 v28, v28, v8
    s_lshl_b32 s63, s63, 3
    buffer_load_dwordx4 v[64:67], v28, s[56:59], s62 offen
    s_add_u32 s62, s62, s63
    buffer_load_dwordx4 v[68:71], v28, s[56:59], s62 offen
    s_add_u32 s62, s62, s63
    buffer_load_dwordx4 v[72:75], v28, s[56:59], s62 offen
    s_add_u32 s62, s62, s63
    buffer_load_dwordx4 v[76:79], v28, s[56:59], s62 offen
Lprep_done_169:
    s_add_u32 s60, s45, 96
    s_cmp_ge_u32 s60, 104
    s_cbranch_scc1 Lprep_done_179
    s_cmp_lt_u32 s60, 8
    s_cbranch_scc1 Lselo_182
    s_cmp_lt_u32 s60, 16
    s_cbranch_scc1 Lsel1_183
    s_cmp_lt_u32 s60, 24
    s_cbranch_scc1 Lsel2_184
    s_cmp_lt_u32 s60, 52
    s_cbranch_scc1 Lsel3_185
    s_cmp_lt_u32 s60, 80
    s_cbranch_scc1 Lsel4_186
Lselq_187:
    s_mov_b32 s56, s20
    s_mov_b32 s57, s21
    s_mov_b32 s58, s22
    s_sub_u32 s61, s60, 80
    s_lshr_b32 s62, s61, 3
    s_and_b32 s61, s61, 7
    s_mul_i32 s62, s62, 1024
    s_mul_i32 s61, s61, 196608
    s_add_u32 s62, s62, s61
    s_mul_i32 s61, s44, 128
    s_add_u32 s62, s62, s61
    s_mov_b32 s63, 3072
    s_branch Lselgo_188
Lselo_182:
    s_mov_b32 s56, s24
    s_mov_b32 s57, s25
    s_mov_b32 s58, s26
    s_sub_u32 s61, s60, 0
    s_mov_b32 s62, 0
    s_mul_i32 s61, s61, 65536
    s_add_u32 s62, s62, s61
    s_mul_i32 s61, s44, 128
    s_add_u32 s62, s62, s61
    s_mov_b32 s63, 1024
    s_branch Lselgo_188
Lsel1_183:
    s_mov_b32 s56, s28
    s_mov_b32 s57, s29
    s_mov_b32 s58, s30
    s_sub_u32 s61, s60, 8
    s_mov_b32 s62, 0
    s_mul_i32 s61, s61, 65536
    s_add_u32 s62, s62, s61
    s_mul_i32 s61, s44, 128
    s_add_u32 s62, s62, s61
    s_mov_b32 s63, 1024
    s_branch Lselgo_188
Lsel2_184:
    s_mov_b32 s56, s32
    s_mov_b32 s57, s33
    s_mov_b32 s58, s34
    s_sub_u32 s61, s60, 16
    s_mov_b32 s62, 0
    s_mul_i32 s61, s61, 65536
    s_add_u32 s62, s62, s61
    s_mul_i32 s61, s44, 128
    s_add_u32 s62, s62, s61
    s_mov_b32 s63, 1024
    s_branch Lselgo_188
Lsel3_185:
    s_mov_b32 s56, s36
    s_mov_b32 s57, s37
    s_mov_b32 s58, s38
    s_sub_u32 s61, s60, 24
    s_lshr_b32 s62, s61, 3
    s_and_b32 s61, s61, 7
    s_mul_i32 s62, s62, 128
    s_mul_i32 s61, s61, 229376
    s_add_u32 s62, s62, s61
    s_mul_i32 s61, s44, 448
    s_add_u32 s62, s62, s61
    s_mov_b32 s63, 3584
    s_branch Lselgo_188
Lsel4_186:
    s_mov_b32 s56, s40
    s_mov_b32 s57, s41
    s_mov_b32 s58, s42
    s_sub_u32 s61, s60, 52
    s_mov_b32 s62, 0
    s_mul_i32 s61, s61, 65536
    s_add_u32 s62, s62, s61
    s_mul_i32 s61, s44, 128
    s_add_u32 s62, s62, s61
    s_mov_b32 s63, 1024
    s_branch Lselgo_188
Lselgo_188:
    s_mov_b32 s59, 0x00020000
    s_cmp_ge_u32 s60, 80
    s_cbranch_scc1 Lprep_raw_180
Lprep_raw_180:
    v_mul_lo_u32 v28, v7, s63
    v_add_u32 v28, v28, v8
    s_lshl_b32 s63, s63, 3
    buffer_load_dwordx4 v[80:83], v28, s[56:59], s62 offen
    s_add_u32 s62, s62, s63
    buffer_load_dwordx4 v[84:87], v28, s[56:59], s62 offen
    s_add_u32 s62, s62, s63
    buffer_load_dwordx4 v[88:91], v28, s[56:59], s62 offen
    s_add_u32 s62, s62, s63
    buffer_load_dwordx4 v[92:95], v28, s[56:59], s62 offen
Lprep_done_179:
Lnl0_148:
    s_barrier
    s_cmp_lg_u32 s49, 0
    s_cbranch_scc1 Lnl0_189
    s_waitcnt vmcnt(0)
    s_add_u32 s60, s45, 0
    s_mul_i32 s61, s44, 104
    s_add_u32 s61, s61, s60
    s_lshl_b32 s61, s61, 13
    s_add_u32 s61, s61, 37748736
    s_lshl_b32 s62, s74, 12
    ds_read_b64_tr_b16 v[32:33], v10 offset:0
    ds_read_b64_tr_b16 v[34:35], v10 offset:512
    ds_read_b64_tr_b16 v[36:37], v10 offset:1024
    ds_read_b64_tr_b16 v[38:39], v10 offset:1536
    ds_read_b64_tr_b16 v[40:41], v10 offset:2048
    ds_read_b64_tr_b16 v[42:43], v10 offset:2560
    ds_read_b64_tr_b16 v[44:45], v10 offset:3072
    ds_read_b64_tr_b16 v[46:47], v10 offset:3584
    s_add_u32 s61, s61, s62
    s_waitcnt lgkmcnt(0)
    buffer_store_dwordx4 v[32:35], v6, s[4:7], s61 offen offset:0 sc1
    buffer_store_dwordx4 v[36:39], v6, s[4:7], s61 offen offset:1024 sc1
    buffer_store_dwordx4 v[40:43], v6, s[4:7], s61 offen offset:2048 sc1
    buffer_store_dwordx4 v[44:47], v6, s[4:7], s61 offen offset:3072 sc1
    s_branch Lpst_done_190
Lpst_done_190:
    s_add_u32 s60, s45, 32
    s_mul_i32 s61, s44, 104
    s_add_u32 s61, s61, s60
    s_lshl_b32 s61, s61, 13
    s_add_u32 s61, s61, 37748736
    s_lshl_b32 s62, s74, 12
    ds_read_b64_tr_b16 v[48:49], v10 offset:8192
    ds_read_b64_tr_b16 v[50:51], v10 offset:8704
    ds_read_b64_tr_b16 v[52:53], v10 offset:9216
    ds_read_b64_tr_b16 v[54:55], v10 offset:9728
    ds_read_b64_tr_b16 v[56:57], v10 offset:10240
    ds_read_b64_tr_b16 v[58:59], v10 offset:10752
    ds_read_b64_tr_b16 v[60:61], v10 offset:11264
    ds_read_b64_tr_b16 v[62:63], v10 offset:11776
    s_add_u32 s61, s61, s62
    s_waitcnt lgkmcnt(0)
    buffer_store_dwordx4 v[48:51], v6, s[4:7], s61 offen offset:0 sc1
    buffer_store_dwordx4 v[52:55], v6, s[4:7], s61 offen offset:1024 sc1
    buffer_store_dwordx4 v[56:59], v6, s[4:7], s61 offen offset:2048 sc1
    buffer_store_dwordx4 v[60:63], v6, s[4:7], s61 offen offset:3072 sc1
    s_branch Lpst_done_193
Lpst_done_193:
    s_add_u32 s60, s45, 64
    s_mul_i32 s61, s44, 104
    s_add_u32 s61, s61, s60
    s_lshl_b32 s61, s61, 13
    s_add_u32 s61, s61, 37748736
    s_lshl_b32 s62, s74, 12
    s_cmp_ge_u32 s60, 80
    s_cbranch_scc1 Lpst_raw_197
    ds_read_b64_tr_b16 v[64:65], v10 offset:16384
    ds_read_b64_tr_b16 v[66:67], v10 offset:16896
    ds_read_b64_tr_b16 v[68:69], v10 offset:17408
    ds_read_b64_tr_b16 v[70:71], v10 offset:17920
    ds_read_b64_tr_b16 v[72:73], v10 offset:18432
    ds_read_b64_tr_b16 v[74:75], v10 offset:18944
    ds_read_b64_tr_b16 v[76:77], v10 offset:19456
    ds_read_b64_tr_b16 v[78:79], v10 offset:19968
    s_add_u32 s61, s61, s62
    s_waitcnt lgkmcnt(0)
    buffer_store_dwordx4 v[64:67], v6, s[4:7], s61 offen offset:0 sc1
    buffer_store_dwordx4 v[68:71], v6, s[4:7], s61 offen offset:1024 sc1
    buffer_store_dwordx4 v[72:75], v6, s[4:7], s61 offen offset:2048 sc1
    buffer_store_dwordx4 v[76:79], v6, s[4:7], s61 offen offset:3072 sc1
    s_branch Lpst_done_196
Lpst_raw_197:
    s_add_u32 s61, s61, s62
    buffer_store_dwordx4 v[64:67], v6, s[4:7], s61 offen offset:0 sc1
    buffer_store_dwordx4 v[68:71], v6, s[4:7], s61 offen offset:1024 sc1
    buffer_store_dwordx4 v[72:75], v6, s[4:7], s61 offen offset:2048 sc1
    buffer_store_dwordx4 v[76:79], v6, s[4:7], s61 offen offset:3072 sc1
Lpst_done_196:
    s_add_u32 s60, s45, 96
    s_cmp_ge_u32 s60, 104
    s_cbranch_scc1 Lpst_done_199
    s_mul_i32 s61, s44, 104
    s_add_u32 s61, s61, s60
    s_lshl_b32 s61, s61, 13
    s_add_u32 s61, s61, 37748736
    s_lshl_b32 s62, s74, 12
    s_cmp_ge_u32 s60, 80
    s_cbranch_scc1 Lpst_raw_200
Lpst_raw_200:
    s_add_u32 s61, s61, s62
    buffer_store_dwordx4 v[80:83], v6, s[4:7], s61 offen offset:0 sc1
    buffer_store_dwordx4 v[84:87], v6, s[4:7], s61 offen offset:1024 sc1
    buffer_store_dwordx4 v[88:91], v6, s[4:7], s61 offen offset:2048 sc1
    buffer_store_dwordx4 v[92:95], v6, s[4:7], s61 offen offset:3072 sc1
Lpst_done_199:
Lnl0_189:
    s_cmp_lg_u32 s49, 0
    s_cbranch_scc1 Lnl0_202
    s_cmp_lg_u32 s48, 7
    s_cbranch_scc1 Lnotw_203
    s_cmp_lt_u32 s45, 12
    s_cbranch_scc1 Lcq_204
    s_cmp_lt_u32 s45, 16
    s_cbranch_scc1 Lc1_205
Lc3_206:
    s_mov_b32 s56, s36
    s_mov_b32 s57, s37
    s_mov_b32 s58, 1835008
    s_mov_b32 s60, 3584
    s_sub_u32 s61, s45, 16
    s_lshl_b32 s61, s61, 4
    s_mul_i32 s62, s44, 224
    s_add_u32 s61, s61, s62
    s_add_u32 s78, s61, 2048
    s_branch Lcgo_207
Lc1_205:
    s_mov_b32 s56, s28
    s_mov_b32 s57, s29
    s_mov_b32 s58, 524288
    s_mov_b32 s60, 1024
    s_sub_u32 s61, s45, 12
    s_lshl_b32 s61, s61, 4
    s_lshl_b32 s62, s44, 6
    s_add_u32 s61, s61, s62
    s_add_u32 s78, s61, 1536
    s_branch Lcgo_207
Lcq_204:
    s_mov_b32 s56, s20
    s_mov_b32 s57, s21
    s_mov_b32 s58, 1572864
    s_mov_b32 s60, 3072
    s_lshr_b32 s61, s45, 2
    s_lshl_b32 s61, s61, 9
    s_and_b32 s62, s45, 3
    s_lshl_b32 s62, s62, 4
    s_add_u32 s61, s61, s62
    s_lshl_b32 s62, s44, 6
    s_add_u32 s61, s61, s62
    s_mov_b32 s78, s61
Lcgo_207:
    s_cmp_lt_u32 s45, 30
    s_cselect_b32 s58, s58, 0
    s_mov_b32 s59, 0x00020000
    s_lshl_b32 s61, s61, 1
    v_and_b32 v100, 31, v1
    v_mul_lo_u32 v100, v100, s60
    v_lshrrev_b32 v101, 5, v1
    v_lshlrev_b32 v101, 4, v101
    v_add_u32 v100, v100, v101
    s_lshl_b32 s62, s60, 5
    buffer_load_dwordx4 v[128:131], v100, s[56:59], s61 offen
    s_add_u32 s61, s61, s62
    buffer_load_dwordx4 v[132:135], v100, s[56:59], s61 offen
    s_add_u32 s61, s61, s62
    buffer_load_dwordx4 v[136:139], v100, s[56:59], s61 offen
    s_add_u32 s61, s61, s62
    buffer_load_dwordx4 v[140:143], v100, s[56:59], s61 offen
    s_add_u32 s61, s61, s62
    buffer_load_dwordx4 v[144:147], v100, s[56:59], s61 offen
    s_add_u32 s61, s61, s62
    buffer_load_dwordx4 v[148:151], v100, s[56:59], s61 offen
    s_add_u32 s61, s61, s62
    buffer_load_dwordx4 v[152:155], v100, s[56:59], s61 offen
    s_add_u32 s61, s61, s62
    buffer_load_dwordx4 v[156:159], v100, s[56:59], s61 offen
    s_add_u32 s61, s61, s62
    buffer_load_dwordx4 v[160:163], v100, s[56:59], s61 offen
    s_add_u32 s61, s61, s62
    buffer_load_dwordx4 v[164:167], v100, s[56:59], s61 offen
    s_add_u32 s61, s61, s62
    buffer_load_dwordx4 v[168:171], v100, s[56:59], s61 offen
    s_add_u32 s61, s61, s62
    buffer_load_dwordx4 v[172:175], v100, s[56:59], s61 offen
    s_add_u32 s61, s61, s62
    buffer_load_dwordx4 v[176:179], v100, s[56:59], s61 offen
    s_add_u32 s61, s61, s62
    buffer_load_dwordx4 v[180:183], v100, s[56:59], s61 offen
    s_add_u32 s61, s61, s62
    buffer_load_dwordx4 v[184:187], v100, s[56:59], s61 offen
    s_add_u32 s61, s61, s62
    buffer_load_dwordx4 v[188:191], v100, s[56:59], s61 offen
Lnotw_203:
Lnl0_202:
    s_barrier
    s_cmp_lg_u32 s49, 0
    s_cbranch_scc1 Lnl0_208
    s_cmp_lg_u32 s48, 7
    s_cbranch_scc1 Lnotw_209
    v_and_b32 v100, 31, v1
    v_lshrrev_b32 v101, 5, v1
    v_lshlrev_b32 v101, 3, v101
    v_sub_u32 v100, v100, v101
    v_and_b32 v101, 1, v100
    v_lshlrev_b32 v101, 4, v101
    v_mov_b32 v102, 0x3f80
    v_lshlrev_b32 v101, v101, v102
    v_lshrrev_b32 v100, 1, v100
    v_cmp_eq_u32 vcc, 0, v100
    s_nop 1
    v_cndmask_b32 v104, 0, v101, vcc
    v_cmp_eq_u32 vcc, 1, v100
    s_nop 1
    v_cndmask_b32 v105, 0, v101, vcc
    v_cmp_eq_u32 vcc, 2, v100
    s_nop 1
    v_cndmask_b32 v106, 0, v101, vcc
    v_cmp_eq_u32 vcc, 3, v100
    s_nop 1
    v_cndmask_b32 v107, 0, v101, vcc
    s_waitcnt vmcnt(0)
    s_nop 0
    v_mfma_f32_32x32x16_bf16 v[192:207], v[128:131], v[104:107], 0
    v_mfma_f32_32x32x16_bf16 v[192:207], v[132:135], v[104:107], v[192:207]
    v_mfma_f32_32x32x16_bf16 v[192:207], v[136:139], v[104:107], v[192:207]
    v_mfma_f32_32x32x16_bf16 v[192:207], v[140:143], v[104:107], v[192:207]
    v_mfma_f32_32x32x16_bf16 v[192:207], v[144:147], v[104:107], v[192:207]
    v_mfma_f32_32x32x16_bf16 v[192:207], v[148:151], v[104:107], v[192:207]
    v_mfma_f32_32x32x16_bf16 v[192:207], v[152:155], v[104:107], v[192:207]
    v_mfma_f32_32x32x16_bf16 v[192:207], v[156:159], v[104:107], v[192:207]
    v_mfma_f32_32x32x16_bf16 v[192:207], v[160:163], v[104:107], v[192:207]
    v_mfma_f32_32x32x16_bf16 v[192:207], v[164:167], v[104:107], v[192:207]
    v_mfma_f32_32x32x16_bf16 v[192:207], v[168:171], v[104:107], v[192:207]
    v_mfma_f32_32x32x16_bf16 v[192:207], v[172:175], v[104:107], v[192:207]
    v_mfma_f32_32x32x16_bf16 v[192:207], v[176:179], v[104:107], v[192:207]
    v_mfma_f32_32x32x16_bf16 v[192:207], v[180:183], v[104:107], v[192:207]
    v_mfma_f32_32x32x16_bf16 v[192:207], v[184:187], v[104:107], v[192:207]
    v_mfma_f32_32x32x16_bf16 v[192:207], v[188:191], v[104:107], v[192:207]
    s_nop 11
    v_add_f32 v192, v192, v193
    v_add_f32 v192, v192, v194
    v_add_f32 v192, v192, v195
    v_add_f32 v192, v192, v196
    v_add_f32 v192, v192, v197
    v_add_f32 v192, v192, v198
    v_add_f32 v192, v192, v199
    v_add_f32 v192, v192, v200
    v_add_f32 v192, v192, v201
    v_add_f32 v192, v192, v202
    v_add_f32 v192, v192, v203
    v_add_f32 v192, v192, v204
    v_add_f32 v192, v192, v205
    v_add_f32 v192, v192, v206
    v_add_f32 v192, v192, v207
    v_mov_b32 v193, v192
    s_nop 1
    v_permlane32_swap_b32 v192, v193
    v_add_f32 v192, v192, v193
    s_cmp_ge_u32 s45, 30
    s_cbranch_scc1 Lcs_skip_210
    v_and_b32 v100, 15, v1
    v_lshlrev_b32 v100, 2, v100
    s_lshl_b32 s56, s78, 2
    s_add_u32 s56, s56, 65536
    s_mov_b64 s[92:93], exec
    s_mov_b64 exec, 0xffff
    buffer_store_dword v192, v100, s[4:7], s56 offen sc1
    s_mov_b64 exec, s[92:93]
Lcs_skip_210:
Lnotw_209:
Lnl0_208:
    s_cmp_lg_u32 s49, 0
    s_cbranch_scc1 Lnl0_211
    s_waitcnt vmcnt(0)
Lnl0_211:
    s_barrier
    s_cmp_lg_u32 s49, 0
    s_cbranch_scc1 Lnl0_212
    s_cmp_lg_u32 s48, 6
    s_cbranch_scc1 Lnotw_213
    s_add_u32 s56, s87, 2
    v_mov_b32 v20, s56
    s_lshl_b32 s57, s44, 5
    s_add_u32 s57, s57, s45
    s_lshl_b32 s57, s57, 7
    s_add_u32 s57, s57, 32768
    v_mov_b32 v21, 0
    s_mov_b64 s[92:93], exec
    s_mov_b64 exec, 1
    buffer_store_dword v20, v21, s[4:7], s57 offen sc1
    s_mov_b64 exec, s[92:93]
Lnotw_213:
Lnl0_212:
    s_cmp_eq_u32 s74, 1
    s_cbranch_scc1 Lt7_214
    s_mul_i32 s56, s51, 112
    s_mul_i32 s57, s47, 14
    s_add_u32 s56, s56, s57
    s_lshl_b32 s56, s56, 10
    s_add_u32 s56, s56, s50
    s_add_u32 s56, s56, 16777216
    buffer_load_dword v19, v15, s[4:7], s56 offen sc1
    buffer_load_dword v19, v16, s[4:7], s56 offen sc1
    s_branch Ltj_215
Lt7_214:
    s_mul_i32 s56, s51, 112
    s_mul_i32 s57, s47, 14
    s_add_u32 s56, s56, s57
    s_add_u32 s56, s56, 112
    s_lshl_b32 s56, s56, 10
    s_add_u32 s56, s56, s50
    s_add_u32 s56, s56, 16777216
    buffer_load_dword v19, v15, s[4:7], s56 offen sc1
    buffer_load_dword v19, v16, s[4:7], s56 offen sc1
Ltj_215:
    s_barrier
    s_cmp_eq_u32 s74, 1
    s_cbranch_scc1 Lt7_216
    s_lshl_b32 s56, s51, 5
    s_lshl_b32 s57, s47, 2
    s_add_u32 s56, s56, s57
    s_lshl_b32 s56, s56, 10
    s_add_u32 s56, s56, s50
    s_add_u32 s56, s56, 8388608
    buffer_load_dword v19, v13, s[4:7], s56 offen sc1
    s_lshl_b32 s56, s51, 4
    s_lshl_b32 s57, s47, 1
    s_add_u32 s56, s56, s57
    s_lshl_b32 s56, s56, 8
    s_add_u32 s56, s56, s50
    s_add_u32 s56, s56, 25165824
    buffer_load_dword v19, v14, s[4:7], s56 offen sc1
    s_branch Ltj_217
Lt7_216:
    s_lshl_b32 s56, s51, 5
    s_lshl_b32 s57, s47, 2
    s_add_u32 s56, s56, s57
    s_lshl_b32 s56, s56, 10
    s_add_u32 s56, s56, s50
    s_add_u32 s56, s56, 12582912
    buffer_load_dword v19, v13, s[4:7], s56 offen sc1
    s_lshl_b32 s56, s51, 4
    s_lshl_b32 s57, s47, 1
    s_add_u32 s56, s56, s57
    s_lshl_b32 s56, s56, 8
    s_add_u32 s56, s56, s50
    s_add_u32 s56, s56, 25427968
    buffer_load_dword v19, v14, s[4:7], s56 offen sc1
Ltj_217:
    s_barrier
    s_cmp_lg_u32 s49, 0
    s_cbranch_scc1 Lnl0_218
    s_add_u32 s56, s87, 2
    s_cmp_lg_u32 s53, 0
    s_cbranch_scc1 Lpoll_done_220
    s_mov_b32 s86, 0x40000
Lpoll_219:
    buffer_load_dword v22, v9, s[4:7], 0 offen sc1
    s_waitcnt vmcnt(0)
    v_cmp_le_u32 vcc, s56, v22
    s_nop 0
    s_and_b64 vcc, vcc, s[96:97]
    s_cmp_eq_u64 vcc, s[96:97]
    s_cbranch_scc1 Lpoll_done_220
    s_sub_u32 s86, s86, 1
    s_cmp_lg_u32 s86, 0
    s_cbranch_scc1 Lpoll_219
    s_mov_b32 s53, 1
Lpoll_done_220:
Lnl0_218:
    s_cmp_eq_u32 s74, 1
    s_cbranch_scc1 Lt7_221
    s_lshl_b32 s56, s44, 8
    s_add_u32 s56, s56, s45
    s_lshl_b32 s56, s56, 10
    s_add_u32 s56, s56, s50
    s_add_u32 s56, s56, 6291456
    buffer_load_dword v19, v17, s[4:7], s56 offen sc1
    s_branch Ltj_222
Lt7_221:
    s_lshl_b32 s56, s51, 5
    s_lshl_b32 s57, s47, 2
    s_add_u32 s56, s56, s57
    s_lshl_b32 s56, s56, 10
    s_add_u32 s56, s56, s50
    s_add_u32 s56, s56, 10485760
    s_mul_i32 s57, s49, 24117248
    s_add_u32 s56, s56, s57
    buffer_load_dword v19, v13, s[4:7], s56 offen sc1
Ltj_222:
    s_barrier
    s_add_u32 m0, s76, 0
    s_add_u32 s56, s77, 0
    buffer_load_dwordx4 v6, s[4:7], s56 offen offset:0  lds
    buffer_load_dwordx4 v6, s[4:7], s56 offen offset:1024  lds
    buffer_load_dwordx4 v6, s[4:7], s56 offen offset:2048  lds
    buffer_load_dwordx4 v6, s[4:7], s56 offen offset:3072  lds
    s_add_u32 m0, s76, 8192
    s_add_u32 s56, s77, 8192
    buffer_load_dwordx4 v6, s[4:7], s56 offen offset:0  lds
    buffer_load_dwordx4 v6, s[4:7], s56 offen offset:1024  lds
    buffer_load_dwordx4 v6, s[4:7], s56 offen offset:2048  lds
    buffer_load_dwordx4 v6, s[4:7], s56 offen offset:3072  lds
    s_add_u32 m0, s76, 16384
    s_add_u32 s56, s77, 16384
    buffer_load_dwordx4 v6, s[4:7], s56 offen offset:0  lds
    buffer_load_dwordx4 v6, s[4:7], s56 offen offset:1024  lds
    buffer_load_dwordx4 v6, s[4:7], s56 offen offset:2048  lds
    buffer_load_dwordx4 v6, s[4:7], s56 offen offset:3072  lds
    s_add_u32 m0, s76, 24576
    s_add_u32 s56, s77, 24576
    buffer_load_dwordx4 v6, s[4:7], s56 offen offset:0  lds
    buffer_load_dwordx4 v6, s[4:7], s56 offen offset:1024  lds
    buffer_load_dwordx4 v6, s[4:7], s56 offen offset:2048  lds
    buffer_load_dwordx4 v6, s[4:7], s56 offen offset:3072  lds
    s_barrier
    s_add_u32 m0, s76, 32768
    s_add_u32 s56, s77, 32768
    buffer_load_dwordx4 v6, s[4:7], s56 offen offset:0  lds
    buffer_load_dwordx4 v6, s[4:7], s56 offen offset:1024  lds
    buffer_load_dwordx4 v6, s[4:7], s56 offen offset:2048  lds
    buffer_load_dwordx4 v6, s[4:7], s56 offen offset:3072  lds
    s_add_u32 m0, s76, 40960
    s_add_u32 s56, s77, 40960
    buffer_load_dwordx4 v6, s[4:7], s56 offen offset:0  lds
    buffer_load_dwordx4 v6, s[4:7], s56 offen offset:1024  lds
    buffer_load_dwordx4 v6, s[4:7], s56 offen offset:2048  lds
    buffer_load_dwordx4 v6, s[4:7], s56 offen offset:3072  lds
    s_add_u32 m0, s76, 49152
    s_add_u32 s56, s77, 49152
    buffer_load_dwordx4 v6, s[4:7], s56 offen offset:0  lds
    buffer_load_dwordx4 v6, s[4:7], s56 offen offset:1024  lds
    buffer_load_dwordx4 v6, s[4:7], s56 offen offset:2048  lds
    buffer_load_dwordx4 v6, s[4:7], s56 offen offset:3072  lds
    s_add_u32 m0, s76, 57344
    s_add_u32 s56, s77, 57344
    buffer_load_dwordx4 v6, s[4:7], s56 offen offset:0  lds
    buffer_load_dwordx4 v6, s[4:7], s56 offen offset:1024  lds
    buffer_load_dwordx4 v6, s[4:7], s56 offen offset:2048  lds
    buffer_load_dwordx4 v6, s[4:7], s56 offen offset:3072  lds
    s_barrier
    s_add_u32 m0, s76, 65536
    s_add_u32 s56, s77, 65536
    buffer_load_dwordx4 v6, s[4:7], s56 offen offset:0  lds
    buffer_load_dwordx4 v6, s[4:7], s56 offen offset:1024  lds
    buffer_load_dwordx4 v6, s[4:7], s56 offen offset:2048  lds
    buffer_load_dwordx4 v6, s[4:7], s56 offen offset:3072  lds
    s_add_u32 m0, s76, 73728
    s_add_u32 s56, s77, 73728
    buffer_load_dwordx4 v6, s[4:7], s56 offen offset:0  lds
    buffer_load_dwordx4 v6, s[4:7], s56 offen offset:1024  lds
    buffer_load_dwordx4 v6, s[4:7], s56 offen offset:2048  lds
    buffer_load_dwordx4 v6, s[4:7], s56 offen offset:3072  lds
    s_add_u32 m0, s76, 81920
    s_add_u32 s56, s77, 81920
    buffer_load_dwordx4 v6, s[4:7], s56 offen offset:0  lds
    buffer_load_dwordx4 v6, s[4:7], s56 offen offset:1024  lds
    buffer_load_dwordx4 v6, s[4:7], s56 offen offset:2048  lds
    buffer_load_dwordx4 v6, s[4:7], s56 offen offset:3072  lds
    s_waitcnt vmcnt(12)
    s_barrier
    v_mov_b32 v24, 159360
    ds_read_b32 v25, v24
    s_waitcnt lgkmcnt(0)
    v_readfirstlane_b32 s56, v25
    s_nop 0
    s_cmp_eq_u32 s56, 0
    s_cbranch_scc1 Lnoslow_223
    s_barrier
Lnoslow_223:
    s_cmp_lg_u32 s48, 6
    s_cbranch_scc1 Lnotw_224
    s_add_u32 s56, s87, 2
    v_mov_b32 v20, s56
    s_lshl_b32 s57, s44, 8
    s_lshl_b32 s58, s45, 2
    s_add_u32 s57, s57, s58
    v_mov_b32 v21, 0
    s_mov_b64 s[92:93], exec
    s_mov_b64 exec, 1
    s_cmp_eq_u32 s52, 0
    s_cbranch_scc1 Lst_safe_225
    buffer_store_dword v20, v21, s[4:7], s57 offen
    s_branch Lst_done_226
Lst_safe_225:
    buffer_store_dword v20, v21, s[4:7], s57 offen sc1
Lst_done_226:
    s_mov_b64 exec, s[92:93]
Lnotw_224:
    s_barrier
    s_barrier
    s_barrier
    s_add_u32 m0, s76, 0
    s_add_u32 s56, s77, 90112
    buffer_load_dwordx4 v6, s[4:7], s56 offen offset:0  lds
    buffer_load_dwordx4 v6, s[4:7], s56 offen offset:1024  lds
    buffer_load_dwordx4 v6, s[4:7], s56 offen offset:2048  lds
    buffer_load_dwordx4 v6, s[4:7], s56 offen offset:3072  lds
    s_barrier
    s_add_u32 m0, s76, 8192
    s_add_u32 s56, s77, 98304
    buffer_load_dwordx4 v6, s[4:7], s56 offen offset:0  lds
    buffer_load_dwordx4 v6, s[4:7], s56 offen offset:1024  lds
    buffer_load_dwordx4 v6, s[4:7], s56 offen offset:2048  lds
    buffer_load_dwordx4 v6, s[4:7], s56 offen offset:3072  lds
    s_barrier
    s_add_u32 m0, s76, 16384
    s_add_u32 s56, s77, 106496
    buffer_load_dwordx4 v6, s[4:7], s56 offen offset:0  lds
    buffer_load_dwordx4 v6, s[4:7], s56 offen offset:1024  lds
    buffer_load_dwordx4 v6, s[4:7], s56 offen offset:2048  lds
    buffer_load_dwordx4 v6, s[4:7], s56 offen offset:3072  lds
    s_barrier
    s_add_u32 m0, s76, 24576
    s_add_u32 s56, s77, 114688
    buffer_load_dwordx4 v6, s[4:7], s56 offen offset:0  lds
    buffer_load_dwordx4 v6, s[4:7], s56 offen offset:1024  lds
    buffer_load_dwordx4 v6, s[4:7], s56 offen offset:2048  lds
    buffer_load_dwordx4 v6, s[4:7], s56 offen offset:3072  lds
    s_barrier
    s_add_u32 m0, s76, 32768
    s_add_u32 s56, s77, 122880
    buffer_load_dwordx4 v6, s[4:7], s56 offen offset:0  lds
    buffer_load_dwordx4 v6, s[4:7], s56 offen offset:1024  lds
    buffer_load_dwordx4 v6, s[4:7], s56 offen offset:2048  lds
    buffer_load_dwordx4 v6, s[4:7], s56 offen offset:3072  lds
    s_barrier
    s_add_u32 m0, s76, 40960
    s_add_u32 s56, s77, 131072
    buffer_load_dwordx4 v6, s[4:7], s56 offen offset:0  lds
    buffer_load_dwordx4 v6, s[4:7], s56 offen offset:1024  lds
    buffer_load_dwordx4 v6, s[4:7], s56 offen offset:2048  lds
    buffer_load_dwordx4 v6, s[4:7], s56 offen offset:3072  lds
    s_waitcnt vmcnt(4)
    s_barrier
    s_cmp_lg_u32 s48, 6
    s_cbranch_scc1 Lnotw_227
    s_add_u32 s56, s87, 3
    v_mov_b32 v20, s56
    s_lshl_b32 s57, s44, 8
    s_lshl_b32 s58, s45, 2
    s_add_u32 s57, s57, s58
    v_mov_b32 v21, 0
    s_mov_b64 s[92:93], exec
    s_mov_b64 exec, 1
    s_cmp_eq_u32 s52, 0
    s_cbranch_scc1 Lst_safe_228
    buffer_store_dword v20, v21, s[4:7], s57 offen
    s_branch Lst_done_229
Lst_safe_228:
    buffer_store_dword v20, v21, s[4:7], s57 offen sc1
Lst_done_229:
    s_mov_b64 exec, s[92:93]
Lnotw_227:
    s_add_u32 m0, s76, 49152
    s_add_u32 s56, s77, 139264
    buffer_load_dwordx4 v6, s[4:7], s56 offen offset:0  lds
    buffer_load_dwordx4 v6, s[4:7], s56 offen offset:1024  lds
    buffer_load_dwordx4 v6, s[4:7], s56 offen offset:2048  lds
    buffer_load_dwordx4 v6, s[4:7], s56 offen offset:3072  lds
    s_add_u32 m0, s76, 57344
    s_add_u32 s56, s77, 147456
    buffer_load_dwordx4 v6, s[4:7], s56 offen offset:0  lds
    buffer_load_dwordx4 v6, s[4:7], s56 offen offset:1024  lds
    buffer_load_dwordx4 v6, s[4:7], s56 offen offset:2048  lds
    buffer_load_dwordx4 v6, s[4:7], s56 offen offset:3072  lds
    s_barrier
    s_barrier
    s_barrier
    s_add_u32 m0, s76, 65536
    s_add_u32 s56, s77, 155648
    buffer_load_dwordx4 v6, s[4:7], s56 offen offset:0  lds
    buffer_load_dwordx4 v6, s[4:7], s56 offen offset:1024  lds
    buffer_load_dwordx4 v6, s[4:7], s56 offen offset:2048  lds
    buffer_load_dwordx4 v6, s[4:7], s56 offen offset:3072  lds
    s_barrier
    s_add_u32 m0, s76, 73728
    s_add_u32 s56, s77, 163840
    buffer_load_dwordx4 v6, s[4:7], s56 offen offset:0  lds
    buffer_load_dwordx4 v6, s[4:7], s56 offen offset:1024  lds
    buffer_load_dwordx4 v6, s[4:7], s56 offen offset:2048  lds
    buffer_load_dwordx4 v6, s[4:7], s56 offen offset:3072  lds
    s_barrier
    s_add_u32 m0, s76, 81920
    s_add_u32 s56, s77, 172032
    buffer_load_dwordx4 v6, s[4:7], s56 offen offset:0  lds
    buffer_load_dwordx4 v6, s[4:7], s56 offen offset:1024  lds
    buffer_load_dwordx4 v6, s[4:7], s56 offen offset:2048  lds
    buffer_load_dwordx4 v6, s[4:7], s56 offen offset:3072  lds
    s_barrier
    s_add_u32 m0, s76, 0
    s_add_u32 s56, s77, 180224
    buffer_load_dwordx4 v6, s[4:7], s56 offen offset:0  lds
    buffer_load_dwordx4 v6, s[4:7], s56 offen offset:1024  lds
    buffer_load_dwordx4 v6, s[4:7], s56 offen offset:2048  lds
    buffer_load_dwordx4 v6, s[4:7], s56 offen offset:3072  lds
    s_barrier
    s_add_u32 m0, s76, 8192
    s_add_u32 s56, s77, 188416
    buffer_load_dwordx4 v6, s[4:7], s56 offen offset:0  lds
    buffer_load_dwordx4 v6, s[4:7], s56 offen offset:1024  lds
    buffer_load_dwordx4 v6, s[4:7], s56 offen offset:2048  lds
    buffer_load_dwordx4 v6, s[4:7], s56 offen offset:3072  lds
    s_barrier
    s_add_u32 m0, s76, 16384
    s_add_u32 s56, s77, 196608
    buffer_load_dwordx4 v6, s[4:7], s56 offen offset:0  lds
    buffer_load_dwordx4 v6, s[4:7], s56 offen offset:1024  lds
    buffer_load_dwordx4 v6, s[4:7], s56 offen offset:2048  lds
    buffer_load_dwordx4 v6, s[4:7], s56 offen offset:3072  lds
    s_waitcnt vmcnt(4)
    s_barrier
    s_cmp_lg_u32 s48, 6
    s_cbranch_scc1 Lnotw_230
    s_add_u32 s56, s87, 4
    v_mov_b32 v20, s56
    s_lshl_b32 s57, s44, 8
    s_lshl_b32 s58, s45, 2
    s_add_u32 s57, s57, s58
    v_mov_b32 v21, 0
    s_mov_b64 s[92:93], exec
    s_mov_b64 exec, 1
    s_cmp_eq_u32 s52, 0
    s_cbranch_scc1 Lst_safe_231
    buffer_store_dword v20, v21, s[4:7], s57 offen
    s_branch Lst_done_232
Lst_safe_231:
    buffer_store_dword v20, v21, s[4:7], s57 offen sc1
Lst_done_232:
    s_mov_b64 exec, s[92:93]
Lnotw_230:
    s_cmp_lg_u32 s48, 7
    s_cbranch_scc1 Lnotw_233
    s_add_u32 s56, s87, 4
    v_mov_b32 v20, s56
    s_lshl_b32 s57, s44, 5
    s_add_u32 s57, s57, s45
    s_lshl_b32 s57, s57, 7
    s_add_u32 s57, s57, 32768
    v_mov_b32 v21, 0
    s_mov_b64 s[92:93], exec
    s_mov_b64 exec, 1
    buffer_store_dword v20, v21, s[4:7], s57 offen sc1
    s_mov_b64 exec, s[92:93]
Lnotw_233:
    s_add_u32 m0, s76, 24576
    s_add_u32 s56, s77, 204800
    buffer_load_dwordx4 v6, s[4:7], s56 offen offset:0  lds
    buffer_load_dwordx4 v6, s[4:7], s56 offen offset:1024  lds
    buffer_load_dwordx4 v6, s[4:7], s56 offen offset:2048  lds
    buffer_load_dwordx4 v6, s[4:7], s56 offen offset:3072  lds
    s_add_u32 m0, s76, 32768
    s_add_u32 s56, s77, 212992
    buffer_load_dwordx4 v6, s[4:7], s56 offen offset:0  lds
    buffer_load_dwordx4 v6, s[4:7], s56 offen offset:1024  lds
    buffer_load_dwordx4 v6, s[4:7], s56 offen offset:2048  lds
    buffer_load_dwordx4 v6, s[4:7], s56 offen offset:3072  lds
    s_barrier
    s_barrier
    s_barrier
    s_add_u32 m0, s76, 40960
    s_add_u32 s56, s77, 221184
    buffer_load_dwordx4 v6, s[4:7], s56 offen offset:0  lds
    buffer_load_dwordx4 v6, s[4:7], s56 offen offset:1024  lds
    buffer_load_dwordx4 v6, s[4:7], s56 offen offset:2048  lds
    buffer_load_dwordx4 v6, s[4:7], s56 offen offset:3072  lds
    s_barrier
    s_add_u32 m0, s76, 49152
    s_add_u32 s56, s77, 229376
    buffer_load_dwordx4 v6, s[4:7], s56 offen offset:0  lds
    buffer_load_dwordx4 v6, s[4:7], s56 offen offset:1024  lds
    buffer_load_dwordx4 v6, s[4:7], s56 offen offset:2048  lds
    buffer_load_dwordx4 v6, s[4:7], s56 offen offset:3072  lds
    s_barrier
    s_add_u32 m0, s76, 57344
    s_add_u32 s56, s77, 237568
    buffer_load_dwordx4 v6, s[4:7], s56 offen offset:0  lds
    buffer_load_dwordx4 v6, s[4:7], s56 offen offset:1024  lds
    buffer_load_dwordx4 v6, s[4:7], s56 offen offset:2048  lds
    buffer_load_dwordx4 v6, s[4:7], s56 offen offset:3072  lds
    s_barrier
    s_add_u32 m0, s76, 65536
    s_add_u32 s56, s77, 245760
    buffer_load_dwordx4 v6, s[4:7], s56 offen offset:0  lds
    buffer_load_dwordx4 v6, s[4:7], s56 offen offset:1024  lds
    buffer_load_dwordx4 v6, s[4:7], s56 offen offset:2048  lds
    buffer_load_dwordx4 v6, s[4:7], s56 offen offset:3072  lds
    s_barrier
    s_add_u32 m0, s76, 73728
    s_add_u32 s56, s77, 253952
    buffer_load_dwordx4 v6, s[4:7], s56 offen offset:0  lds
    buffer_load_dwordx4 v6, s[4:7], s56 offen offset:1024  lds
    buffer_load_dwordx4 v6, s[4:7], s56 offen offset:2048  lds
    buffer_load_dwordx4 v6, s[4:7], s56 offen offset:3072  lds
    s_barrier
    s_add_u32 m0, s76, 81920
    s_add_u32 s56, s77, 262144
    buffer_load_dwordx4 v6, s[4:7], s56 offen offset:0  lds
    buffer_load_dwordx4 v6, s[4:7], s56 offen offset:1024  lds
    buffer_load_dwordx4 v6, s[4:7], s56 offen offset:2048  lds
    buffer_load_dwordx4 v6, s[4:7], s56 offen offset:3072  lds
    s_barrier
    s_cmp_lg_u32 s48, 6
    s_cbranch_scc1 Lnotw_234
    s_add_u32 s56, s87, 5
    v_mov_b32 v20, s56
    s_lshl_b32 s57, s44, 8
    s_lshl_b32 s58, s45, 2
    s_add_u32 s57, s57, s58
    v_mov_b32 v21, 0
    s_mov_b64 s[92:93], exec
    s_mov_b64 exec, 1
    s_cmp_eq_u32 s52, 0
    s_cbranch_scc1 Lst_safe_235
    buffer_store_dword v20, v21, s[4:7], s57 offen
    s_branch Lst_done_236
Lst_safe_235:
    buffer_store_dword v20, v21, s[4:7], s57 offen sc1
Lst_done_236:
    s_mov_b64 exec, s[92:93]
Lnotw_234:
    s_add_u32 m0, s76, 0
    s_add_u32 s56, s77, 270336
    buffer_load_dwordx4 v6, s[4:7], s56 offen offset:0  lds
    buffer_load_dwordx4 v6, s[4:7], s56 offen offset:1024  lds
    buffer_load_dwordx4 v6, s[4:7], s56 offen offset:2048  lds
    buffer_load_dwordx4 v6, s[4:7], s56 offen offset:3072  lds
    s_add_u32 m0, s76, 8192
    s_add_u32 s56, s77, 278528
    buffer_load_dwordx4 v6, s[4:7], s56 offen offset:0  lds
    buffer_load_dwordx4 v6, s[4:7], s56 offen offset:1024  lds
    buffer_load_dwordx4 v6, s[4:7], s56 offen offset:2048  lds
    buffer_load_dwordx4 v6, s[4:7], s56 offen offset:3072  lds
    s_waitcnt vmcnt(40)
    s_barrier
    s_waitcnt vmcnt(36)
    s_barrier
    s_waitcnt vmcnt(32)
    s_barrier
    s_waitcnt vmcnt(28)
    s_barrier
    s_add_u32 m0, s76, 16384
    s_add_u32 s56, s77, 286720
    buffer_load_dwordx4 v6, s[4:7], s56 offen offset:0  lds
    buffer_load_dwordx4 v6, s[4:7], s56 offen offset:1024  lds
    buffer_load_dwordx4 v6, s[4:7], s56 offen offset:2048  lds
    buffer_load_dwordx4 v6, s[4:7], s56 offen offset:3072  lds
    s_add_u32 m0, s76, 24576
    s_add_u32 s56, s77, 294912
    buffer_load_dwordx4 v6, s[4:7], s56 offen offset:0  lds
    buffer_load_dwordx4 v6, s[4:7], s56 offen offset:1024  lds
    buffer_load_dwordx4 v6, s[4:7], s56 offen offset:2048  lds
    buffer_load_dwordx4 v6, s[4:7], s56 offen offset:3072  lds
    s_waitcnt vmcnt(32)
    s_barrier
    s_add_u32 m0, s76, 32768
    s_add_u32 s56, s77, 303104
    buffer_load_dwordx4 v6, s[4:7], s56 offen offset:0  lds
    buffer_load_dwordx4 v6, s[4:7], s56 offen offset:1024  lds
    buffer_load_dwordx4 v6, s[4:7], s56 offen offset:2048  lds
    buffer_load_dwordx4 v6, s[4:7], s56 offen offset:3072  lds
    s_waitcnt vmcnt(32)
    s_barrier
    s_add_u32 m0, s76, 40960
    s_add_u32 s56, s77, 311296
    buffer_load_dwordx4 v6, s[4:7], s56 offen offset:0  lds
    buffer_load_dwordx4 v6, s[4:7], s56 offen offset:1024  lds
    buffer_load_dwordx4 v6, s[4:7], s56 offen offset:2048  lds
    buffer_load_dwordx4 v6, s[4:7], s56 offen offset:3072  lds
    s_waitcnt vmcnt(32)
    s_barrier
    s_add_u32 m0, s76, 49152
    s_add_u32 s56, s77, 319488
    buffer_load_dwordx4 v6, s[4:7], s56 offen offset:0  lds
    buffer_load_dwordx4 v6, s[4:7], s56 offen offset:1024  lds
    buffer_load_dwordx4 v6, s[4:7], s56 offen offset:2048  lds
    buffer_load_dwordx4 v6, s[4:7], s56 offen offset:3072  lds
    s_waitcnt vmcnt(32)
    s_barrier
    s_add_u32 m0, s76, 57344
    s_add_u32 s56, s77, 327680
    buffer_load_dwordx4 v6, s[4:7], s56 offen offset:0  lds
    buffer_load_dwordx4 v6, s[4:7], s56 offen offset:1024  lds
    buffer_load_dwordx4 v6, s[4:7], s56 offen offset:2048  lds
    buffer_load_dwordx4 v6, s[4:7], s56 offen offset:3072  lds
    s_waitcnt vmcnt(32)
    s_barrier
    s_add_u32 m0, s76, 65536
    s_add_u32 s56, s77, 335872
    buffer_load_dwordx4 v6, s[4:7], s56 offen offset:0  lds
    buffer_load_dwordx4 v6, s[4:7], s56 offen offset:1024  lds
    buffer_load_dwordx4 v6, s[4:7], s56 offen offset:2048  lds
    buffer_load_dwordx4 v6, s[4:7], s56 offen offset:3072  lds
    s_waitcnt vmcnt(32)
    s_barrier
    s_add_u32 m0, s76, 73728
    s_add_u32 s56, s77, 344064
    buffer_load_dwordx4 v6, s[4:7], s56 offen offset:0  lds
    buffer_load_dwordx4 v6, s[4:7], s56 offen offset:1024  lds
    buffer_load_dwordx4 v6, s[4:7], s56 offen offset:2048  lds
    buffer_load_dwordx4 v6, s[4:7], s56 offen offset:3072  lds
    s_waitcnt vmcnt(32)
    s_barrier
    s_add_u32 m0, s76, 81920
    s_add_u32 s56, s77, 352256
    buffer_load_dwordx4 v6, s[4:7], s56 offen offset:0  lds
    buffer_load_dwordx4 v6, s[4:7], s56 offen offset:1024  lds
    buffer_load_dwordx4 v6, s[4:7], s56 offen offset:2048  lds
    buffer_load_dwordx4 v6, s[4:7], s56 offen offset:3072  lds
    s_waitcnt vmcnt(32)
    s_barrier
    s_add_u32 m0, s76, 0
    s_add_u32 s56, s77, 360448
    buffer_load_dwordx4 v6, s[4:7], s56 offen offset:0  lds
    buffer_load_dwordx4 v6, s[4:7], s56 offen offset:1024  lds
    buffer_load_dwordx4 v6, s[4:7], s56 offen offset:2048  lds
    buffer_load_dwordx4 v6, s[4:7], s56 offen offset:3072  lds
    s_waitcnt vmcnt(32)
    s_barrier
    s_add_u32 m0, s76, 8192
    s_add_u32 s56, s77, 368640
    buffer_load_dwordx4 v6, s[4:7], s56 offen offset:0  lds
    buffer_load_dwordx4 v6, s[4:7], s56 offen offset:1024  lds
    buffer_load_dwordx4 v6, s[4:7], s56 offen offset:2048  lds
    buffer_load_dwordx4 v6, s[4:7], s56 offen offset:3072  lds
    s_waitcnt vmcnt(32)
    s_barrier
    s_add_u32 m0, s76, 16384
    s_add_u32 s56, s77, 376832
    buffer_load_dwordx4 v6, s[4:7], s56 offen offset:0  lds
    buffer_load_dwordx4 v6, s[4:7], s56 offen offset:1024  lds
    buffer_load_dwordx4 v6, s[4:7], s56 offen offset:2048  lds
    buffer_load_dwordx4 v6, s[4:7], s56 offen offset:3072  lds
    s_waitcnt vmcnt(32)
    s_barrier
    s_add_u32 m0, s76, 24576
    s_add_u32 s56, s77, 385024
    buffer_load_dwordx4 v6, s[4:7], s56 offen offset:0  lds
    buffer_load_dwordx4 v6, s[4:7], s56 offen offset:1024  lds
    buffer_load_dwordx4 v6, s[4:7], s56 offen offset:2048  lds
    buffer_load_dwordx4 v6, s[4:7], s56 offen offset:3072  lds
    s_waitcnt vmcnt(32)
    s_barrier
    s_add_u32 m0, s76, 32768
    s_add_u32 s56, s77, 393216
    buffer_load_dwordx4 v6, s[4:7], s56 offen offset:0  lds
    buffer_load_dwordx4 v6, s[4:7], s56 offen offset:1024  lds
    buffer_load_dwordx4 v6, s[4:7], s56 offen offset:2048  lds
    buffer_load_dwordx4 v6, s[4:7], s56 offen offset:3072  lds
    s_waitcnt vmcnt(32)
    s_barrier
    s_add_u32 m0, s76, 40960
    s_add_u32 s56, s77, 401408
    buffer_load_dwordx4 v6, s[4:7], s56 offen offset:0  lds
    buffer_load_dwordx4 v6, s[4:7], s56 offen offset:1024  lds
    buffer_load_dwordx4 v6, s[4:7], s56 offen offset:2048  lds
    buffer_load_dwordx4 v6, s[4:7], s56 offen offset:3072  lds
    s_waitcnt vmcnt(32)
    s_barrier
    s_add_u32 m0, s76, 49152
    s_add_u32 s56, s77, 409600
    buffer_load_dwordx4 v6, s[4:7], s56 offen offset:0  lds
    buffer_load_dwordx4 v6, s[4:7], s56 offen offset:1024  lds
    buffer_load_dwordx4 v6, s[4:7], s56 offen offset:2048  lds
    buffer_load_dwordx4 v6, s[4:7], s56 offen offset:3072  lds
    s_waitcnt vmcnt(32)
    s_barrier
    s_add_u32 m0, s76, 57344
    s_add_u32 s56, s77, 417792
    buffer_load_dwordx4 v6, s[4:7], s56 offen offset:0  lds
    buffer_load_dwordx4 v6, s[4:7], s56 offen offset:1024  lds
    buffer_load_dwordx4 v6, s[4:7], s56 offen offset:2048  lds
    buffer_load_dwordx4 v6, s[4:7], s56 offen offset:3072  lds
    s_waitcnt vmcnt(32)
    s_barrier
    s_add_u32 m0, s76, 65536
    s_add_u32 s56, s77, 425984
    buffer_load_dwordx4 v6, s[4:7], s56 offen offset:0  lds
    buffer_load_dwordx4 v6, s[4:7], s56 offen offset:1024  lds
    buffer_load_dwordx4 v6, s[4:7], s56 offen offset:2048  lds
    buffer_load_dwordx4 v6, s[4:7], s56 offen offset:3072  lds
    s_waitcnt vmcnt(32)
    s_barrier
    s_add_u32 m0, s76, 73728
    s_add_u32 s56, s77, 434176
    buffer_load_dwordx4 v6, s[4:7], s56 offen offset:0  lds
    buffer_load_dwordx4 v6, s[4:7], s56 offen offset:1024  lds
    buffer_load_dwordx4 v6, s[4:7], s56 offen offset:2048  lds
    buffer_load_dwordx4 v6, s[4:7], s56 offen offset:3072  lds
    s_waitcnt vmcnt(32)
    s_barrier
    s_add_u32 m0, s76, 81920
    s_add_u32 s56, s77, 442368
    buffer_load_dwordx4 v6, s[4:7], s56 offen offset:0  lds
    buffer_load_dwordx4 v6, s[4:7], s56 offen offset:1024  lds
    buffer_load_dwordx4 v6, s[4:7], s56 offen offset:2048  lds
    buffer_load_dwordx4 v6, s[4:7], s56 offen offset:3072  lds
    s_waitcnt vmcnt(32)
    s_barrier
    s_add_u32 m0, s76, 0
    s_add_u32 s56, s77, 450560
    buffer_load_dwordx4 v6, s[4:7], s56 offen offset:0  lds
    buffer_load_dwordx4 v6, s[4:7], s56 offen offset:1024  lds
    buffer_load_dwordx4 v6, s[4:7], s56 offen offset:2048  lds
    buffer_load_dwordx4 v6, s[4:7], s56 offen offset:3072  lds
    s_waitcnt vmcnt(32)
    s_barrier
    s_add_u32 m0, s76, 8192
    s_add_u32 s56, s77, 458752
    buffer_load_dwordx4 v6, s[4:7], s56 offen offset:0  lds
    buffer_load_dwordx4 v6, s[4:7], s56 offen offset:1024  lds
    buffer_load_dwordx4 v6, s[4:7], s56 offen offset:2048  lds
    buffer_load_dwordx4 v6, s[4:7], s56 offen offset:3072  lds
    s_waitcnt vmcnt(32)
    s_barrier
    s_add_u32 m0, s76, 16384
    s_add_u32 s56, s77, 466944
    buffer_load_dwordx4 v6, s[4:7], s56 offen offset:0  lds
    buffer_load_dwordx4 v6, s[4:7], s56 offen offset:1024  lds
    buffer_load_dwordx4 v6, s[4:7], s56 offen offset:2048  lds
    buffer_load_dwordx4 v6, s[4:7], s56 offen offset:3072  lds
    s_waitcnt vmcnt(32)
    s_barrier
    s_add_u32 m0, s76, 24576
    s_add_u32 s56, s77, 475136
    buffer_load_dwordx4 v6, s[4:7], s56 offen offset:0  lds
    buffer_load_dwordx4 v6, s[4:7], s56 offen offset:1024  lds
    buffer_load_dwordx4 v6, s[4:7], s56 offen offset:2048  lds
    buffer_load_dwordx4 v6, s[4:7], s56 offen offset:3072  lds
    s_waitcnt vmcnt(32)
    s_barrier
    s_add_u32 m0, s76, 32768
    s_add_u32 s56, s77, 483328
    buffer_load_dwordx4 v6, s[4:7], s56 offen offset:0  lds
    buffer_load_dwordx4 v6, s[4:7], s56 offen offset:1024  lds
    buffer_load_dwordx4 v6, s[4:7], s56 offen offset:2048  lds
    buffer_load_dwordx4 v6, s[4:7], s56 offen offset:3072  lds
    s_waitcnt vmcnt(32)
    s_barrier
    s_add_u32 m0, s76, 40960
    s_add_u32 s56, s77, 491520
    buffer_load_dwordx4 v6, s[4:7], s56 offen offset:0  lds
    buffer_load_dwordx4 v6, s[4:7], s56 offen offset:1024  lds
    buffer_load_dwordx4 v6, s[4:7], s56 offen offset:2048  lds
    buffer_load_dwordx4 v6, s[4:7], s56 offen offset:3072  lds
    s_barrier
    s_barrier
    s_cmp_lg_u32 s48, 6
    s_cbranch_scc1 Lnotw_237
    s_add_u32 s56, s87, 6
    v_mov_b32 v20, s56
    s_lshl_b32 s57, s44, 8
    s_lshl_b32 s58, s45, 2
    s_add_u32 s57, s57, s58
    v_mov_b32 v21, 0
    s_mov_b64 s[92:93], exec
    s_mov_b64 exec, 1
    s_cmp_eq_u32 s52, 0
    s_cbranch_scc1 Lst_safe_238
    buffer_store_dword v20, v21, s[4:7], s57 offen
    s_branch Lst_done_239
Lst_safe_238:
    buffer_store_dword v20, v21, s[4:7], s57 offen sc1
Lst_done_239:
    s_mov_b64 exec, s[92:93]
Lnotw_237:
    s_barrier
    s_add_u32 m0, s76, 49152
    s_add_u32 s56, s77, 499712
    buffer_load_dwordx4 v6, s[4:7], s56 offen offset:0  lds
    buffer_load_dwordx4 v6, s[4:7], s56 offen offset:1024  lds
    buffer_load_dwordx4 v6, s[4:7], s56 offen offset:2048  lds
    buffer_load_dwordx4 v6, s[4:7], s56 offen offset:3072  lds
    s_add_u32 m0, s76, 57344
    s_add_u32 s56, s77, 507904
    buffer_load_dwordx4 v6, s[4:7], s56 offen offset:0  lds
    buffer_load_dwordx4 v6, s[4:7], s56 offen offset:1024  lds
    buffer_load_dwordx4 v6, s[4:7], s56 offen offset:2048  lds
    buffer_load_dwordx4 v6, s[4:7], s56 offen offset:3072  lds
    s_waitcnt vmcnt(40)
    s_barrier
    s_waitcnt vmcnt(36)
    s_barrier
    s_waitcnt vmcnt(32)
    s_barrier
    s_add_u32 m0, s76, 65536
    s_add_u32 s56, s77, 573440
    buffer_load_dwordx4 v6, s[4:7], s56 offen offset:0  lds
    buffer_load_dwordx4 v6, s[4:7], s56 offen offset:1024  lds
    buffer_load_dwordx4 v6, s[4:7], s56 offen offset:2048  lds
    buffer_load_dwordx4 v6, s[4:7], s56 offen offset:3072  lds
    s_waitcnt vmcnt(32)
    s_barrier
    s_add_u32 m0, s76, 73728
    s_add_u32 s56, s77, 581632
    buffer_load_dwordx4 v6, s[4:7], s56 offen offset:0  lds
    buffer_load_dwordx4 v6, s[4:7], s56 offen offset:1024  lds
    buffer_load_dwordx4 v6, s[4:7], s56 offen offset:2048  lds
    buffer_load_dwordx4 v6, s[4:7], s56 offen offset:3072  lds
    s_waitcnt vmcnt(32)
    s_barrier
    s_add_u32 m0, s76, 81920
    s_add_u32 s56, s77, 589824
    buffer_load_dwordx4 v6, s[4:7], s56 offen offset:0  lds
    buffer_load_dwordx4 v6, s[4:7], s56 offen offset:1024  lds
    buffer_load_dwordx4 v6, s[4:7], s56 offen offset:2048  lds
    buffer_load_dwordx4 v6, s[4:7], s56 offen offset:3072  lds
    s_waitcnt vmcnt(32)
    s_barrier
    s_add_u32 m0, s76, 0
    s_add_u32 s56, s77, 598016
    buffer_load_dwordx4 v6, s[4:7], s56 offen offset:0  lds
    buffer_load_dwordx4 v6, s[4:7], s56 offen offset:1024  lds
    buffer_load_dwordx4 v6, s[4:7], s56 offen offset:2048  lds
    buffer_load_dwordx4 v6, s[4:7], s56 offen offset:3072  lds
    s_waitcnt vmcnt(32)
    s_barrier
    s_add_u32 m0, s76, 8192
    s_add_u32 s56, s77, 606208
    buffer_load_dwordx4 v6, s[4:7], s56 offen offset:0  lds
    buffer_load_dwordx4 v6, s[4:7], s56 offen offset:1024  lds
    buffer_load_dwordx4 v6, s[4:7], s56 offen offset:2048  lds
    buffer_load_dwordx4 v6, s[4:7], s56 offen offset:3072  lds
    s_waitcnt vmcnt(32)
    s_barrier
    s_add_u32 m0, s76, 16384
    s_add_u32 s56, s77, 614400
    buffer_load_dwordx4 v6, s[4:7], s56 offen offset:0  lds
    buffer_load_dwordx4 v6, s[4:7], s56 offen offset:1024  lds
    buffer_load_dwordx4 v6, s[4:7], s56 offen offset:2048  lds
    buffer_load_dwordx4 v6, s[4:7], s56 offen offset:3072  lds
    s_waitcnt vmcnt(32)
    s_barrier
    s_add_u32 m0, s76, 24576
    s_add_u32 s56, s77, 622592
    buffer_load_dwordx4 v6, s[4:7], s56 offen offset:0  lds
    buffer_load_dwordx4 v6, s[4:7], s56 offen offset:1024  lds
    buffer_load_dwordx4 v6, s[4:7], s56 offen offset:2048  lds
    buffer_load_dwordx4 v6, s[4:7], s56 offen offset:3072  lds
    s_waitcnt vmcnt(32)
    s_barrier
    s_add_u32 m0, s76, 32768
    s_add_u32 s56, s77, 630784
    buffer_load_dwordx4 v6, s[4:7], s56 offen offset:0  lds
    buffer_load_dwordx4 v6, s[4:7], s56 offen offset:1024  lds
    buffer_load_dwordx4 v6, s[4:7], s56 offen offset:2048  lds
    buffer_load_dwordx4 v6, s[4:7], s56 offen offset:3072  lds
    s_waitcnt vmcnt(32)
    s_barrier
    s_add_u32 m0, s76, 40960
    s_add_u32 s56, s77, 638976
    buffer_load_dwordx4 v6, s[4:7], s56 offen offset:0  lds
    buffer_load_dwordx4 v6, s[4:7], s56 offen offset:1024  lds
    buffer_load_dwordx4 v6, s[4:7], s56 offen offset:2048  lds
    buffer_load_dwordx4 v6, s[4:7], s56 offen offset:3072  lds
    s_barrier
    s_add_u32 m0, s76, 49152
    s_add_u32 s56, s77, 647168
    buffer_load_dwordx4 v6, s[4:7], s56 offen offset:0  lds
    buffer_load_dwordx4 v6, s[4:7], s56 offen offset:1024  lds
    buffer_load_dwordx4 v6, s[4:7], s56 offen offset:2048  lds
    buffer_load_dwordx4 v6, s[4:7], s56 offen offset:3072  lds
    s_barrier
    s_barrier
    s_barrier
    s_barrier
    s_barrier
    s_barrier
    s_waitcnt vmcnt(36)
    s_barrier
    s_waitcnt vmcnt(32)
    s_barrier
    s_waitcnt vmcnt(28)
    s_barrier
    s_waitcnt vmcnt(24)
    s_barrier
    s_waitcnt vmcnt(20)
    s_barrier
    s_waitcnt vmcnt(16)
    s_barrier
    s_waitcnt vmcnt(12)
    s_barrier
    s_waitcnt vmcnt(8)
    s_barrier
    s_waitcnt vmcnt(4)
    s_barrier
    s_waitcnt vmcnt(0)
    s_barrier
    s_barrier
    s_cmp_eq_u32 s49, 1
    s_cbranch_scc1 L_LW_FIN
    s_cmp_lg_u32 s48, 6
    s_cbranch_scc1 Lnotw_240
    s_add_u32 s56, s87, 7
    v_mov_b32 v20, s56
    s_lshl_b32 s57, s44, 8
    s_lshl_b32 s58, s45, 2
    s_add_u32 s57, s57, s58
    v_mov_b32 v21, 0
    s_mov_b64 s[92:93], exec
    s_mov_b64 exec, 1
    s_cmp_eq_u32 s52, 0
    s_cbranch_scc1 Lst_safe_241
    buffer_store_dword v20, v21, s[4:7], s57 offen
    s_branch Lst_done_242
Lst_safe_241:
    buffer_store_dword v20, v21, s[4:7], s57 offen sc1
Lst_done_242:
    s_mov_b64 exec, s[92:93]
Lnotw_240:
    s_add_u32 m0, s76, 57344
    s_add_u32 s56, s77, 655360
    buffer_load_dwordx4 v6, s[4:7], s56 offen offset:0  lds
    buffer_load_dwordx4 v6, s[4:7], s56 offen offset:1024  lds
    buffer_load_dwordx4 v6, s[4:7], s56 offen offset:2048  lds
    buffer_load_dwordx4 v6, s[4:7], s56 offen offset:3072  lds
    s_add_u32 m0, s76, 65536
    s_add_u32 s56, s77, 663552
    buffer_load_dwordx4 v6, s[4:7], s56 offen offset:0  lds
    buffer_load_dwordx4 v6, s[4:7], s56 offen offset:1024  lds
    buffer_load_dwordx4 v6, s[4:7], s56 offen offset:2048  lds
    buffer_load_dwordx4 v6, s[4:7], s56 offen offset:3072  lds
    s_add_u32 m0, s76, 73728
    s_add_u32 s56, s77, 671744
    buffer_load_dwordx4 v6, s[4:7], s56 offen offset:0  lds
    buffer_load_dwordx4 v6, s[4:7], s56 offen offset:1024  lds
    buffer_load_dwordx4 v6, s[4:7], s56 offen offset:2048  lds
    buffer_load_dwordx4 v6, s[4:7], s56 offen offset:3072  lds
    s_add_u32 m0, s76, 81920
    s_add_u32 s56, s77, 679936
    buffer_load_dwordx4 v6, s[4:7], s56 offen offset:0  lds
    buffer_load_dwordx4 v6, s[4:7], s56 offen offset:1024  lds
    buffer_load_dwordx4 v6, s[4:7], s56 offen offset:2048  lds
    buffer_load_dwordx4 v6, s[4:7], s56 offen offset:3072  lds
    s_add_u32 m0, s76, 0
    s_add_u32 s56, s77, 688128
    buffer_load_dwordx4 v6, s[4:7], s56 offen offset:0  lds
    buffer_load_dwordx4 v6, s[4:7], s56 offen offset:1024  lds
    buffer_load_dwordx4 v6, s[4:7], s56 offen offset:2048  lds
    buffer_load_dwordx4 v6, s[4:7], s56 offen offset:3072  lds
    s_add_u32 m0, s76, 8192
    s_add_u32 s56, s77, 696320
    buffer_load_dwordx4 v6, s[4:7], s56 offen offset:0  lds
    buffer_load_dwordx4 v6, s[4:7], s56 offen offset:1024  lds
    buffer_load_dwordx4 v6, s[4:7], s56 offen offset:2048  lds
    buffer_load_dwordx4 v6, s[4:7], s56 offen offset:3072  lds
    s_add_u32 m0, s76, 16384
    s_add_u32 s56, s77, 704512
    buffer_load_dwordx4 v6, s[4:7], s56 offen offset:0  lds
    buffer_load_dwordx4 v6, s[4:7], s56 offen offset:1024  lds
    buffer_load_dwordx4 v6, s[4:7], s56 offen offset:2048  lds
    buffer_load_dwordx4 v6, s[4:7], s56 offen offset:3072  lds
    s_add_u32 m0, s76, 24576
    s_add_u32 s56, s77, 712704
    buffer_load_dwordx4 v6, s[4:7], s56 offen offset:0  lds
    buffer_load_dwordx4 v6, s[4:7], s56 offen offset:1024  lds
    buffer_load_dwordx4 v6, s[4:7], s56 offen offset:2048  lds
    buffer_load_dwordx4 v6, s[4:7], s56 offen offset:3072  lds
    s_add_u32 m0, s76, 32768
    s_add_u32 s56, s77, 720896
    buffer_load_dwordx4 v6, s[4:7], s56 offen offset:0  lds
    buffer_load_dwordx4 v6, s[4:7], s56 offen offset:1024  lds
    buffer_load_dwordx4 v6, s[4:7], s56 offen offset:2048  lds
    buffer_load_dwordx4 v6, s[4:7], s56 offen offset:3072  lds
    s_add_u32 m0, s76, 40960
    s_add_u32 s56, s77, 729088
    buffer_load_dwordx4 v6, s[4:7], s56 offen offset:0  lds
    buffer_load_dwordx4 v6, s[4:7], s56 offen offset:1024  lds
    buffer_load_dwordx4 v6, s[4:7], s56 offen offset:2048  lds
    buffer_load_dwordx4 v6, s[4:7], s56 offen offset:3072  lds
    s_add_u32 m0, s76, 49152
    s_add_u32 s56, s77, 737280
    buffer_load_dwordx4 v6, s[4:7], s56 offen offset:0  lds
    buffer_load_dwordx4 v6, s[4:7], s56 offen offset:1024  lds
    buffer_load_dwordx4 v6, s[4:7], s56 offen offset:2048  lds
    buffer_load_dwordx4 v6, s[4:7], s56 offen offset:3072  lds
    s_add_u32 s49, s49, 1
    s_add_u32 s87, s87, 8
    s_branch L_LW
L_LW_FIN:
    s_waitcnt vmcnt(0)
    s_endpgm
L_END:
    s_endpgm
.section .rodata,"a"
.p2align 6
.amdhsa_kernel interleave_layers__softmax_full_mha__mixer_s_mlp__prompt_kernel
  .amdhsa_next_free_vgpr 256
  .amdhsa_next_free_sgpr 102
  .amdhsa_accum_offset 256
  .amdhsa_group_segment_fixed_size 0
  .amdhsa_kernarg_size 88
  .amdhsa_user_sgpr_count 2
  .amdhsa_user_sgpr_kernarg_segment_ptr 1
  .amdhsa_system_sgpr_workgroup_id_x 1
  .amdhsa_float_denorm_mode_32 3
.end_amdhsa_kernel
```
